```python
import torch

def _softmax(x, axis=-1):
    return torch.softmax(x, dim=axis)
def _gelu(x):
    return torch.nn.functional.gelu(x, approximate="tanh")
def _silu(x):
    return torch.nn.functional.silu(x)
def _sigmoid(x):
    return torch.sigmoid(x)
def _layernorm(x, axis=-1, eps=1e-5):
    m = x.mean(dim=axis, keepdim=True)
    v = x.var(dim=axis, keepdim=True, unbiased=False)
    return (x - m) / torch.sqrt(v + eps)
def _scatter_add(tgt, idx, src, axis=0):
    return tgt.clone().index_add_(axis, idx, src)
def _segment_sum(src, seg, n):
    out = torch.zeros((n,) + src.shape[1:], dtype=src.dtype)
    return out.index_add_(0, seg, src)
def _pad(x, pw):
    flat = tuple(v for pair in reversed(pw) for v in pair)
    return torch.nn.functional.pad(x, flat)

kernel_name = 'recurrent_scan__softmax_full_mha__moe_arch_mod__prompt'

def setup_inputs():

    _w = (lambda a: (lambda t: t.to(torch.bfloat16) if t.is_floating_point() else t)(torch.as_tensor(a)))
    def _A_setup():
        B, S, D = 1, 2048, 1024
        return {
            "x": _w((lambda *s: torch.randn(*s, dtype=torch.bfloat16) * 0.05)(B, S, D)),
            "wqkv": _w((lambda *s: torch.randn(*s, dtype=torch.bfloat16) * 0.05)(D, 3 * D)),
            "wo": _w((lambda *s: torch.randn(*s, dtype=torch.bfloat16) * 0.05)(D, D)),
        }
    _A_in = _A_setup()

    def _B_setup():
        B, S, D, F, C = 1, 2048, 1024, 3584, 8
        return {
            "x": _w((lambda *s: torch.randn(*s, dtype=torch.bfloat16) * 0.05)(B, S, D)),
            "w_r": _w((lambda *s: torch.randn(*s, dtype=torch.bfloat16) * 0.05)(D)),
            "w_gate": _w((lambda *s: torch.randn(*s, dtype=torch.bfloat16) * 0.05)(D, F)),
            "w_up": _w((lambda *s: torch.randn(*s, dtype=torch.bfloat16) * 0.05)(D, F)),
            "w_down": _w((lambda *s: torch.randn(*s, dtype=torch.bfloat16) * 0.05)(F, D)),
        }
    _B_in = _B_setup()

    return {
        "A_x": _A_in["x"],
        "A_wqkv": _A_in["wqkv"],
        "A_wo": _A_in["wo"],
        "B_x": _B_in["x"],
        "B_w_r": _B_in["w_r"],
        "B_w_gate": _B_in["w_gate"],
        "B_w_up": _B_in["w_up"],
        "B_w_down": _B_in["w_down"],
    }

def reference(A_x, A_wqkv, A_wo, B_x, B_w_r, B_w_gate, B_w_up, B_w_down):
    def _A_ref(x, wqkv, wo):
        B, S, D = x.shape
        H = 32; Dh = D // H
        qkv = (lambda x, *d: x.permute(*d))((x @ wqkv).reshape(B, S, 3, H, Dh), 2, 0, 3, 1, 4)
        q, k, v = qkv[0], qkv[1], qkv[2]
        scale = Dh ** -0.5
        scores = torch.einsum("bhqd,bhkd->bhqk", q, k) * scale
        p = _softmax(scores, axis=-1)
        o = torch.einsum("bhqk,bhkd->bhqd", p, v)
        return (lambda x, *d: x.permute(*d))(o, 0, 2, 1, 3).reshape(B, S, D) @ wo

    def _B_ref(x, w_r, w_gate, w_up, w_down):
        B, S, D = x.shape
        C = 8
        r = x @ w_r
        idx = torch.argsort(-r, axis=-1)[:, :C]
        idx_e = (lambda x, n, axis: torch.repeat_interleave(x, n, dim=axis))(idx.reshape(B, C, 1), D, axis=2)
        x_sel = (lambda x, i, axis: torch.take_along_dim(x, i, dim=axis))(x, idx_e, axis=1)
        g = _silu(x_sel @ w_gate)
        u = x_sel @ w_up
        y = (g * u) @ w_down
        r_sel = _sigmoid((lambda x, i, axis: torch.take_along_dim(x, i, dim=axis))(r, idx, axis=1))
        y = y * r_sel.reshape(B, C, 1)
        b_off = (torch.arange(B) * S).reshape(B, 1)
        flat_idx = (idx + b_off).reshape(B * C)
        zero = (x * 0.0).reshape(B * S, D)
        upd = _scatter_add(zero, flat_idx, y.reshape(B * C, D), axis=0)
        return x + upd.reshape(B, S, D)

    x = A_x
    xn = _layernorm(x, axis=-1)
    s = _A_ref(xn, A_wqkv, A_wo)
    g = _silu(_B_ref(xn, B_w_r, B_w_gate, B_w_up, B_w_down))
    return x + s * g
```

```asm
; @launch grid=(256,1,1) block=(512,1,1) lds=163840
.amdgcn_target "amdgcn-amd-amdhsa--gfx950"
.text
.globl recurrent_scan__softmax_full_mha__moe_arch_mod__prompt_kernel
.p2align 8
.type recurrent_scan__softmax_full_mha__moe_arch_mod__prompt_kernel,@function
recurrent_scan__softmax_full_mha__moe_arch_mod__prompt_kernel:
    s_cmp_ge_u32 s2, 256
    s_cbranch_scc1 recurrent_scan__softmax_full_mha__moe_arch_mod__prompt_kernel_done
    s_load_dwordx2 s[4:5], s[0:1], 0
    s_load_dwordx2 s[8:9], s[0:1], 8
    s_load_dwordx2 s[12:13], s[0:1], 80
    s_load_dwordx2 s[16:17], s[0:1], 32
    s_load_dwordx2 s[20:21], s[0:1], 72
    s_load_dwordx2 s[24:25], s[0:1], 40
    s_load_dwordx2 s[28:29], s[0:1], 48
    s_load_dwordx2 s[32:33], s[0:1], 56
    s_load_dwordx2 s[36:37], s[0:1], 16
    s_load_dwordx2 s[40:41], s[0:1], 64
    v_lshrrev_b32 v1, 6, v0
    v_and_b32 v0, 63, v0
    v_readfirstlane_b32 s3, v1
    s_and_b32 s47, s2, 7
    s_lshr_b32 s46, s2, 3
    s_and_b32 s45, s47, 1
    s_lshl_b32 s45, s45, 3
    s_and_b32 s64, s46, 7
    s_add_u32 s45, s45, s64
    s_lshr_b32 s44, s47, 1
    s_lshl_b32 s44, s44, 2
    s_lshr_b32 s64, s46, 3
    s_add_u32 s44, s44, s64
    s_lshl_b32 s67, s45, 4
    s_add_u32 s67, s67, s44
    s_lshl_b32 s67, s67, 2
    s_add_u32 s67, s67, s3
    s_lshl_b32 s64, s67, 12
    v_lshlrev_b32 v94, 4, v0
    v_add_u32 v95, s64, v94
    s_mov_b32 s6, 0x400000
    s_mov_b32 s7, 0x00020000
    s_mov_b32 s10, 0x600000
    s_mov_b32 s11, 0x00020000
    s_mov_b32 s14, 0x1540000
    s_mov_b32 s15, 0x00020000
    s_mov_b32 s18, 0x800
    s_mov_b32 s19, 0x00020000
    s_mov_b32 s22, 0x100
    s_mov_b32 s23, 0x00020000
    s_mov_b32 s26, 0x700000
    s_mov_b32 s27, 0x00020000
    s_mov_b32 s30, 0x700000
    s_mov_b32 s31, 0x00020000
    s_mov_b32 s34, 0x700000
    s_mov_b32 s35, 0x00020000
    s_mov_b32 s38, 0x200000
    s_mov_b32 s39, 0x00020000
    s_mov_b32 s42, 0x400000
    s_mov_b32 s43, 0x00020000
    s_cmp_ge_u32 s3, 4
    s_cbranch_scc1 recurrent_scan__softmax_full_mha__moe_arch_mod__prompt_kernel_loader
    s_waitcnt lgkmcnt(0)
    buffer_load_dwordx4 v[16:19], v95, s[4:7], 0 offen offset:0
    buffer_load_dwordx4 v[20:23], v95, s[4:7], 0 offen offset:1024
    buffer_load_dwordx4 v[24:27], v95, s[4:7], 0 offen offset:2048
    buffer_load_dwordx4 v[28:31], v95, s[4:7], 0 offen offset:3072
    buffer_load_dwordx4 v[32:35], v94, s[16:19], 0 offen offset:0
    buffer_load_dwordx4 v[36:39], v94, s[16:19], 0 offen offset:1024
    s_cmp_lg_u32 s3, 0
    s_cbranch_scc1 recurrent_scan__softmax_full_mha__moe_arch_mod__prompt_kernel_nocpf
    s_getpc_b64 s[72:73]
recurrent_scan__softmax_full_mha__moe_arch_mod__prompt_kernel_pc:
    s_sub_u32 s72, s72, recurrent_scan__softmax_full_mha__moe_arch_mod__prompt_kernel_pc-recurrent_scan__softmax_full_mha__moe_arch_mod__prompt_kernel
    s_subb_u32 s73, s73, 0
    s_lshl_b32 s64, s46, 4
    v_and_b32 v8, 15, v0
    v_add_u32 v8, s64, v8
    v_lshlrev_b32 v8, 7, v8
    v_min_u32 v8, recurrent_scan__softmax_full_mha__moe_arch_mod__prompt_kernel_end-recurrent_scan__softmax_full_mha__moe_arch_mod__prompt_kernel-4, v8
    global_load_dword v250, v8, s[72:73]
recurrent_scan__softmax_full_mha__moe_arch_mod__prompt_kernel_nocpf:
    s_lshr_b32 s52, s3, 1
    s_and_b32 s53, s3, 1
    v_and_b32 v8, 15, v0
    v_lshrrev_b32 v9, 4, v0
    s_lshl_b32 s64, s52, 6
    v_add_u32 v10, s64, v8
    v_lshlrev_b32 v10, 7, v10
    v_bfe_u32 v11, v0, 1, 3
    v_xor_b32 v11, v11, v9
    v_lshl_add_u32 v1, v11, 4, v10
    v_xor_b32 v2, 64, v1
    v_bfe_u32 v10, v0, 2, 2
    v_lshl_add_u32 v10, v9, 3, v10
    v_lshlrev_b32 v10, 7, v10
    v_and_b32 v11, 3, v0
    v_lshl_add_u32 v10, v11, 3, v10
    v_and_b32 v11, 1, v9
    v_lshlrev_b32 v11, 1, v11
    v_bfe_u32 v12, v0, 3, 1
    v_or_b32 v11, v11, v12
    s_lshl_b32 s64, s53, 1
    v_xor_b32 v11, s64, v11
    v_lshl_add_u32 v10, v11, 5, v10
    v_add_u32 v3, 16384, v10
    v_xor_b32 v4, 32, v3
    v_mov_b32 v96, 0
    v_mov_b32 v97, 0
    v_mov_b32 v98, 0
    v_mov_b32 v99, 0
    v_mov_b32 v100, 0
    v_mov_b32 v101, 0
    v_mov_b32 v102, 0
    v_mov_b32 v103, 0
    v_mov_b32 v104, 0
    v_mov_b32 v105, 0
    v_mov_b32 v106, 0
    v_mov_b32 v107, 0
    v_mov_b32 v108, 0
    v_mov_b32 v109, 0
    v_mov_b32 v110, 0
    v_mov_b32 v111, 0
    v_mov_b32 v112, 0
    v_mov_b32 v113, 0
    v_mov_b32 v114, 0
    v_mov_b32 v115, 0
    v_mov_b32 v116, 0
    v_mov_b32 v117, 0
    v_mov_b32 v118, 0
    v_mov_b32 v119, 0
    v_mov_b32 v120, 0
    v_mov_b32 v121, 0
    v_mov_b32 v122, 0
    v_mov_b32 v123, 0
    v_mov_b32 v124, 0
    v_mov_b32 v125, 0
    v_mov_b32 v126, 0
    v_mov_b32 v127, 0
    v_mov_b32 v128, 0
    v_mov_b32 v129, 0
    v_mov_b32 v130, 0
    v_mov_b32 v131, 0
    v_mov_b32 v132, 0
    v_mov_b32 v133, 0
    v_mov_b32 v134, 0
    v_mov_b32 v135, 0
    v_mov_b32 v136, 0
    v_mov_b32 v137, 0
    v_mov_b32 v138, 0
    v_mov_b32 v139, 0
    v_mov_b32 v140, 0
    v_mov_b32 v141, 0
    v_mov_b32 v142, 0
    v_mov_b32 v143, 0
    v_mov_b32 v144, 0
    v_mov_b32 v145, 0
    v_mov_b32 v146, 0
    v_mov_b32 v147, 0
    v_mov_b32 v148, 0
    v_mov_b32 v149, 0
    v_mov_b32 v150, 0
    v_mov_b32 v151, 0
    v_mov_b32 v152, 0
    v_mov_b32 v153, 0
    v_mov_b32 v154, 0
    v_mov_b32 v155, 0
    v_mov_b32 v156, 0
    v_mov_b32 v157, 0
    v_mov_b32 v158, 0
    v_mov_b32 v159, 0
    v_mov_b32 v160, 0
    v_mov_b32 v161, 0
    v_mov_b32 v162, 0
    v_mov_b32 v163, 0
    v_mov_b32 v164, 0
    v_mov_b32 v165, 0
    v_mov_b32 v166, 0
    v_mov_b32 v167, 0
    v_mov_b32 v168, 0
    v_mov_b32 v169, 0
    v_mov_b32 v170, 0
    v_mov_b32 v171, 0
    v_mov_b32 v172, 0
    v_mov_b32 v173, 0
    v_mov_b32 v174, 0
    v_mov_b32 v175, 0
    v_mov_b32 v176, 0
    v_mov_b32 v177, 0
    v_mov_b32 v178, 0
    v_mov_b32 v179, 0
    v_mov_b32 v180, 0
    v_mov_b32 v181, 0
    v_mov_b32 v182, 0
    v_mov_b32 v183, 0
    v_mov_b32 v184, 0
    v_mov_b32 v185, 0
    v_mov_b32 v186, 0
    v_mov_b32 v187, 0
    v_mov_b32 v188, 0
    v_mov_b32 v189, 0
    v_mov_b32 v190, 0
    v_mov_b32 v191, 0
    s_waitcnt vmcnt(0)
    v_lshlrev_b32 v40, 16, v16
    v_and_b32 v41, 0xffff0000, v16
    v_lshlrev_b32 v42, 16, v17
    v_and_b32 v43, 0xffff0000, v17
    v_lshlrev_b32 v44, 16, v18
    v_and_b32 v45, 0xffff0000, v18
    v_lshlrev_b32 v46, 16, v19
    v_and_b32 v47, 0xffff0000, v19
    v_lshlrev_b32 v48, 16, v20
    v_and_b32 v49, 0xffff0000, v20
    v_lshlrev_b32 v50, 16, v21
    v_and_b32 v51, 0xffff0000, v21
    v_lshlrev_b32 v52, 16, v22
    v_and_b32 v53, 0xffff0000, v22
    v_lshlrev_b32 v54, 16, v23
    v_and_b32 v55, 0xffff0000, v23
    v_lshlrev_b32 v56, 16, v24
    v_and_b32 v57, 0xffff0000, v24
    v_lshlrev_b32 v58, 16, v25
    v_and_b32 v59, 0xffff0000, v25
    v_lshlrev_b32 v60, 16, v26
    v_and_b32 v61, 0xffff0000, v26
    v_lshlrev_b32 v62, 16, v27
    v_and_b32 v63, 0xffff0000, v27
    v_lshlrev_b32 v64, 16, v28
    v_and_b32 v65, 0xffff0000, v28
    v_lshlrev_b32 v66, 16, v29
    v_and_b32 v67, 0xffff0000, v29
    v_lshlrev_b32 v68, 16, v30
    v_and_b32 v69, 0xffff0000, v30
    v_lshlrev_b32 v70, 16, v31
    v_and_b32 v71, 0xffff0000, v31
    v_pk_add_f32 v[76:77], v[40:41], v[42:43]
    v_pk_add_f32 v[82:83], v[56:57], v[58:59]
    v_pk_add_f32 v[76:77], v[76:77], v[44:45]
    v_pk_add_f32 v[82:83], v[82:83], v[60:61]
    v_pk_add_f32 v[76:77], v[76:77], v[46:47]
    v_pk_add_f32 v[82:83], v[82:83], v[62:63]
    v_pk_add_f32 v[76:77], v[76:77], v[48:49]
    v_pk_add_f32 v[82:83], v[82:83], v[64:65]
    v_pk_add_f32 v[76:77], v[76:77], v[50:51]
    v_pk_add_f32 v[82:83], v[82:83], v[66:67]
    v_pk_add_f32 v[76:77], v[76:77], v[52:53]
    v_pk_add_f32 v[82:83], v[82:83], v[68:69]
    v_pk_add_f32 v[76:77], v[76:77], v[54:55]
    v_pk_add_f32 v[82:83], v[82:83], v[70:71]
    v_add_f32 v72, v76, v77
    v_add_f32 v78, v82, v83
    s_nop 0
    s_nop 0
    v_add_f32_dpp v72, v72, v72 row_shr:1 row_mask:0xf bank_mask:0xf bound_ctrl:0
    v_add_f32_dpp v78, v78, v78 row_shr:1 row_mask:0xf bank_mask:0xf bound_ctrl:0
    s_nop 0
    v_add_f32_dpp v72, v72, v72 row_shr:2 row_mask:0xf bank_mask:0xf bound_ctrl:0
    v_add_f32_dpp v78, v78, v78 row_shr:2 row_mask:0xf bank_mask:0xf bound_ctrl:0
    s_nop 0
    v_add_f32_dpp v72, v72, v72 row_shr:4 row_mask:0xf bank_mask:0xf bound_ctrl:0
    v_add_f32_dpp v78, v78, v78 row_shr:4 row_mask:0xf bank_mask:0xf bound_ctrl:0
    s_nop 0
    v_add_f32_dpp v72, v72, v72 row_shr:8 row_mask:0xf bank_mask:0xf bound_ctrl:0
    v_add_f32_dpp v78, v78, v78 row_shr:8 row_mask:0xf bank_mask:0xf bound_ctrl:0
    s_nop 0
    v_add_f32_dpp v72, v72, v72 row_bcast:15 row_mask:0xa bank_mask:0xf
    v_add_f32_dpp v78, v78, v78 row_bcast:15 row_mask:0xa bank_mask:0xf
    s_nop 0
    v_add_f32_dpp v72, v72, v72 row_bcast:31 row_mask:0xc bank_mask:0xf
    v_add_f32_dpp v78, v78, v78 row_bcast:31 row_mask:0xc bank_mask:0xf
    s_nop 0
    v_readlane_b32 s64, v72, 63
    v_readlane_b32 s67, v78, 63
    s_nop 0
    v_mov_b32 v72, s64
    v_mov_b32 v78, s67
    v_mul_f32 v72, 0x3a800000, v72
    v_mul_f32 v78, 0x3a800000, v78
    v_pk_add_f32 v[74:75], v[40:41], v[72:73] op_sel_hi:[1,0] neg_lo:[0,1] neg_hi:[0,1]
    v_pk_add_f32 v[80:81], v[56:57], v[78:79] op_sel_hi:[1,0] neg_lo:[0,1] neg_hi:[0,1]
    v_pk_mul_f32 v[76:77], v[74:75], v[74:75]
    v_pk_mul_f32 v[82:83], v[80:81], v[80:81]
    v_pk_add_f32 v[74:75], v[42:43], v[72:73] op_sel_hi:[1,0] neg_lo:[0,1] neg_hi:[0,1]
    v_pk_add_f32 v[80:81], v[58:59], v[78:79] op_sel_hi:[1,0] neg_lo:[0,1] neg_hi:[0,1]
    v_pk_fma_f32 v[76:77], v[74:75], v[74:75], v[76:77]
    v_pk_fma_f32 v[82:83], v[80:81], v[80:81], v[82:83]
    v_pk_add_f32 v[74:75], v[44:45], v[72:73] op_sel_hi:[1,0] neg_lo:[0,1] neg_hi:[0,1]
    v_pk_add_f32 v[80:81], v[60:61], v[78:79] op_sel_hi:[1,0] neg_lo:[0,1] neg_hi:[0,1]
    v_pk_fma_f32 v[76:77], v[74:75], v[74:75], v[76:77]
    v_pk_fma_f32 v[82:83], v[80:81], v[80:81], v[82:83]
    v_pk_add_f32 v[74:75], v[46:47], v[72:73] op_sel_hi:[1,0] neg_lo:[0,1] neg_hi:[0,1]
    v_pk_add_f32 v[80:81], v[62:63], v[78:79] op_sel_hi:[1,0] neg_lo:[0,1] neg_hi:[0,1]
    v_pk_fma_f32 v[76:77], v[74:75], v[74:75], v[76:77]
    v_pk_fma_f32 v[82:83], v[80:81], v[80:81], v[82:83]
    v_pk_add_f32 v[74:75], v[48:49], v[72:73] op_sel_hi:[1,0] neg_lo:[0,1] neg_hi:[0,1]
    v_pk_add_f32 v[80:81], v[64:65], v[78:79] op_sel_hi:[1,0] neg_lo:[0,1] neg_hi:[0,1]
    v_pk_fma_f32 v[76:77], v[74:75], v[74:75], v[76:77]
    v_pk_fma_f32 v[82:83], v[80:81], v[80:81], v[82:83]
    v_pk_add_f32 v[74:75], v[50:51], v[72:73] op_sel_hi:[1,0] neg_lo:[0,1] neg_hi:[0,1]
    v_pk_add_f32 v[80:81], v[66:67], v[78:79] op_sel_hi:[1,0] neg_lo:[0,1] neg_hi:[0,1]
    v_pk_fma_f32 v[76:77], v[74:75], v[74:75], v[76:77]
    v_pk_fma_f32 v[82:83], v[80:81], v[80:81], v[82:83]
    v_pk_add_f32 v[74:75], v[52:53], v[72:73] op_sel_hi:[1,0] neg_lo:[0,1] neg_hi:[0,1]
    v_pk_add_f32 v[80:81], v[68:69], v[78:79] op_sel_hi:[1,0] neg_lo:[0,1] neg_hi:[0,1]
    v_pk_fma_f32 v[76:77], v[74:75], v[74:75], v[76:77]
    v_pk_fma_f32 v[82:83], v[80:81], v[80:81], v[82:83]
    v_pk_add_f32 v[74:75], v[54:55], v[72:73] op_sel_hi:[1,0] neg_lo:[0,1] neg_hi:[0,1]
    v_pk_add_f32 v[80:81], v[70:71], v[78:79] op_sel_hi:[1,0] neg_lo:[0,1] neg_hi:[0,1]
    v_pk_fma_f32 v[76:77], v[74:75], v[74:75], v[76:77]
    v_pk_fma_f32 v[82:83], v[80:81], v[80:81], v[82:83]
    v_add_f32 v73, v76, v77
    v_add_f32 v79, v82, v83
    s_nop 0
    s_nop 0
    v_add_f32_dpp v73, v73, v73 row_shr:1 row_mask:0xf bank_mask:0xf bound_ctrl:0
    v_add_f32_dpp v79, v79, v79 row_shr:1 row_mask:0xf bank_mask:0xf bound_ctrl:0
    s_nop 0
    v_add_f32_dpp v73, v73, v73 row_shr:2 row_mask:0xf bank_mask:0xf bound_ctrl:0
    v_add_f32_dpp v79, v79, v79 row_shr:2 row_mask:0xf bank_mask:0xf bound_ctrl:0
    s_nop 0
    v_add_f32_dpp v73, v73, v73 row_shr:4 row_mask:0xf bank_mask:0xf bound_ctrl:0
    v_add_f32_dpp v79, v79, v79 row_shr:4 row_mask:0xf bank_mask:0xf bound_ctrl:0
    s_nop 0
    v_add_f32_dpp v73, v73, v73 row_shr:8 row_mask:0xf bank_mask:0xf bound_ctrl:0
    v_add_f32_dpp v79, v79, v79 row_shr:8 row_mask:0xf bank_mask:0xf bound_ctrl:0
    s_nop 0
    v_add_f32_dpp v73, v73, v73 row_bcast:15 row_mask:0xa bank_mask:0xf
    v_add_f32_dpp v79, v79, v79 row_bcast:15 row_mask:0xa bank_mask:0xf
    s_nop 0
    v_add_f32_dpp v73, v73, v73 row_bcast:31 row_mask:0xc bank_mask:0xf
    v_add_f32_dpp v79, v79, v79 row_bcast:31 row_mask:0xc bank_mask:0xf
    s_nop 0
    v_readlane_b32 s64, v73, 63
    v_readlane_b32 s67, v79, 63
    s_nop 0
    v_mov_b32 v73, s64
    v_mov_b32 v79, s67
    v_mul_f32 v73, 0x3a800000, v73
    v_mul_f32 v79, 0x3a800000, v79
    v_cvt_pk_bf16_f32 v74, v72, v73
    v_cvt_pk_bf16_f32 v80, v78, v79
    v_lshlrev_b32 v72, 16, v74
    v_lshlrev_b32 v78, 16, v80
    v_and_b32 v73, 0xffff0000, v74
    v_and_b32 v79, 0xffff0000, v80
    v_add_f32 v73, 0x3727c5ac, v73
    v_add_f32 v79, 0x3727c5ac, v79
    v_cvt_pk_bf16_f32 v73, v73, v73
    v_cvt_pk_bf16_f32 v79, v79, v79
    v_and_b32 v73, 0xffff0000, v73
    v_and_b32 v79, 0xffff0000, v79
    v_sqrt_f32 v73, v73
    v_sqrt_f32 v79, v79
    v_readfirstlane_b32 s64, v72
    v_readfirstlane_b32 s67, v78
    v_cvt_pk_bf16_f32 v73, v73, v73
    v_cvt_pk_bf16_f32 v79, v79, v79
    v_and_b32 v73, 0xffff0000, v73
    v_and_b32 v79, 0xffff0000, v79
    v_rcp_f32 v73, v73
    v_rcp_f32 v79, v79
    v_mov_b32 v75, 0
    v_mov_b32 v81, 0
    v_pk_add_f32 v[40:41], v[40:41], v[72:73] op_sel_hi:[1,0] neg_lo:[0,1] neg_hi:[0,1]
    v_pk_add_f32 v[56:57], v[56:57], v[78:79] op_sel_hi:[1,0] neg_lo:[0,1] neg_hi:[0,1]
    v_cvt_pk_bf16_f32 v74, v40, v41
    v_cvt_pk_bf16_f32 v80, v56, v57
    v_lshlrev_b32 v40, 16, v74
    v_lshlrev_b32 v56, 16, v80
    v_and_b32 v41, 0xffff0000, v74
    v_and_b32 v57, 0xffff0000, v80
    v_pk_mul_f32 v[40:41], v[40:41], v[72:73] op_sel:[0,1] op_sel_hi:[1,1]
    v_pk_mul_f32 v[56:57], v[56:57], v[78:79] op_sel:[0,1] op_sel_hi:[1,1]
    v_cvt_pk_bf16_f32 v16, v40, v41
    v_cvt_pk_bf16_f32 v24, v56, v57
    v_pk_add_f32 v[42:43], v[42:43], v[72:73] op_sel_hi:[1,0] neg_lo:[0,1] neg_hi:[0,1]
    v_pk_add_f32 v[58:59], v[58:59], v[78:79] op_sel_hi:[1,0] neg_lo:[0,1] neg_hi:[0,1]
    v_cvt_pk_bf16_f32 v74, v42, v43
    v_cvt_pk_bf16_f32 v80, v58, v59
    v_lshlrev_b32 v42, 16, v74
    v_lshlrev_b32 v58, 16, v80
    v_and_b32 v43, 0xffff0000, v74
    v_and_b32 v59, 0xffff0000, v80
    v_pk_mul_f32 v[42:43], v[42:43], v[72:73] op_sel:[0,1] op_sel_hi:[1,1]
    v_pk_mul_f32 v[58:59], v[58:59], v[78:79] op_sel:[0,1] op_sel_hi:[1,1]
    v_cvt_pk_bf16_f32 v17, v42, v43
    v_cvt_pk_bf16_f32 v25, v58, v59
    v_pk_add_f32 v[44:45], v[44:45], v[72:73] op_sel_hi:[1,0] neg_lo:[0,1] neg_hi:[0,1]
    v_pk_add_f32 v[60:61], v[60:61], v[78:79] op_sel_hi:[1,0] neg_lo:[0,1] neg_hi:[0,1]
    v_cvt_pk_bf16_f32 v74, v44, v45
    v_cvt_pk_bf16_f32 v80, v60, v61
    v_lshlrev_b32 v44, 16, v74
    v_lshlrev_b32 v60, 16, v80
    v_and_b32 v45, 0xffff0000, v74
    v_and_b32 v61, 0xffff0000, v80
    v_pk_mul_f32 v[44:45], v[44:45], v[72:73] op_sel:[0,1] op_sel_hi:[1,1]
    v_pk_mul_f32 v[60:61], v[60:61], v[78:79] op_sel:[0,1] op_sel_hi:[1,1]
    v_cvt_pk_bf16_f32 v18, v44, v45
    v_cvt_pk_bf16_f32 v26, v60, v61
    v_pk_add_f32 v[46:47], v[46:47], v[72:73] op_sel_hi:[1,0] neg_lo:[0,1] neg_hi:[0,1]
    v_pk_add_f32 v[62:63], v[62:63], v[78:79] op_sel_hi:[1,0] neg_lo:[0,1] neg_hi:[0,1]
    v_cvt_pk_bf16_f32 v74, v46, v47
    v_cvt_pk_bf16_f32 v80, v62, v63
    v_lshlrev_b32 v46, 16, v74
    v_lshlrev_b32 v62, 16, v80
    v_and_b32 v47, 0xffff0000, v74
    v_and_b32 v63, 0xffff0000, v80
    v_pk_mul_f32 v[46:47], v[46:47], v[72:73] op_sel:[0,1] op_sel_hi:[1,1]
    v_pk_mul_f32 v[62:63], v[62:63], v[78:79] op_sel:[0,1] op_sel_hi:[1,1]
    v_cvt_pk_bf16_f32 v19, v46, v47
    v_cvt_pk_bf16_f32 v27, v62, v63
    v_pk_add_f32 v[48:49], v[48:49], v[72:73] op_sel_hi:[1,0] neg_lo:[0,1] neg_hi:[0,1]
    v_pk_add_f32 v[64:65], v[64:65], v[78:79] op_sel_hi:[1,0] neg_lo:[0,1] neg_hi:[0,1]
    v_cvt_pk_bf16_f32 v74, v48, v49
    v_cvt_pk_bf16_f32 v80, v64, v65
    v_lshlrev_b32 v48, 16, v74
    v_lshlrev_b32 v64, 16, v80
    v_and_b32 v49, 0xffff0000, v74
    v_and_b32 v65, 0xffff0000, v80
    v_pk_mul_f32 v[48:49], v[48:49], v[72:73] op_sel:[0,1] op_sel_hi:[1,1]
    v_pk_mul_f32 v[64:65], v[64:65], v[78:79] op_sel:[0,1] op_sel_hi:[1,1]
    v_cvt_pk_bf16_f32 v20, v48, v49
    v_cvt_pk_bf16_f32 v28, v64, v65
    v_pk_add_f32 v[50:51], v[50:51], v[72:73] op_sel_hi:[1,0] neg_lo:[0,1] neg_hi:[0,1]
    v_pk_add_f32 v[66:67], v[66:67], v[78:79] op_sel_hi:[1,0] neg_lo:[0,1] neg_hi:[0,1]
    v_cvt_pk_bf16_f32 v74, v50, v51
    v_cvt_pk_bf16_f32 v80, v66, v67
    v_lshlrev_b32 v50, 16, v74
    v_lshlrev_b32 v66, 16, v80
    v_and_b32 v51, 0xffff0000, v74
    v_and_b32 v67, 0xffff0000, v80
    v_pk_mul_f32 v[50:51], v[50:51], v[72:73] op_sel:[0,1] op_sel_hi:[1,1]
    v_pk_mul_f32 v[66:67], v[66:67], v[78:79] op_sel:[0,1] op_sel_hi:[1,1]
    v_cvt_pk_bf16_f32 v21, v50, v51
    v_cvt_pk_bf16_f32 v29, v66, v67
    v_pk_add_f32 v[52:53], v[52:53], v[72:73] op_sel_hi:[1,0] neg_lo:[0,1] neg_hi:[0,1]
    v_pk_add_f32 v[68:69], v[68:69], v[78:79] op_sel_hi:[1,0] neg_lo:[0,1] neg_hi:[0,1]
    v_cvt_pk_bf16_f32 v74, v52, v53
    v_cvt_pk_bf16_f32 v80, v68, v69
    v_lshlrev_b32 v52, 16, v74
    v_lshlrev_b32 v68, 16, v80
    v_and_b32 v53, 0xffff0000, v74
    v_and_b32 v69, 0xffff0000, v80
    v_pk_mul_f32 v[52:53], v[52:53], v[72:73] op_sel:[0,1] op_sel_hi:[1,1]
    v_pk_mul_f32 v[68:69], v[68:69], v[78:79] op_sel:[0,1] op_sel_hi:[1,1]
    v_cvt_pk_bf16_f32 v22, v52, v53
    v_cvt_pk_bf16_f32 v30, v68, v69
    v_pk_add_f32 v[54:55], v[54:55], v[72:73] op_sel_hi:[1,0] neg_lo:[0,1] neg_hi:[0,1]
    v_pk_add_f32 v[70:71], v[70:71], v[78:79] op_sel_hi:[1,0] neg_lo:[0,1] neg_hi:[0,1]
    v_cvt_pk_bf16_f32 v74, v54, v55
    v_cvt_pk_bf16_f32 v80, v70, v71
    v_lshlrev_b32 v54, 16, v74
    v_lshlrev_b32 v70, 16, v80
    v_and_b32 v55, 0xffff0000, v74
    v_and_b32 v71, 0xffff0000, v80
    v_pk_mul_f32 v[54:55], v[54:55], v[72:73] op_sel:[0,1] op_sel_hi:[1,1]
    v_pk_mul_f32 v[70:71], v[70:71], v[78:79] op_sel:[0,1] op_sel_hi:[1,1]
    v_cvt_pk_bf16_f32 v23, v54, v55
    v_cvt_pk_bf16_f32 v31, v70, v71
    v_readfirstlane_b32 s65, v73
    v_readfirstlane_b32 s68, v79
    v_dot2c_f32_bf16 v75, v16, v32
    v_dot2c_f32_bf16 v81, v24, v32
    v_dot2c_f32_bf16 v75, v17, v33
    v_dot2c_f32_bf16 v81, v25, v33
    v_dot2c_f32_bf16 v75, v18, v34
    v_dot2c_f32_bf16 v81, v26, v34
    v_dot2c_f32_bf16 v75, v19, v35
    v_dot2c_f32_bf16 v81, v27, v35
    v_dot2c_f32_bf16 v75, v20, v36
    v_dot2c_f32_bf16 v81, v28, v36
    v_dot2c_f32_bf16 v75, v21, v37
    v_dot2c_f32_bf16 v81, v29, v37
    v_dot2c_f32_bf16 v75, v22, v38
    v_dot2c_f32_bf16 v81, v30, v38
    v_dot2c_f32_bf16 v75, v23, v39
    v_dot2c_f32_bf16 v81, v31, v39
    s_nop 1
    s_nop 0
    v_add_f32_dpp v75, v75, v75 row_shr:1 row_mask:0xf bank_mask:0xf bound_ctrl:0
    v_add_f32_dpp v81, v81, v81 row_shr:1 row_mask:0xf bank_mask:0xf bound_ctrl:0
    s_nop 0
    v_add_f32_dpp v75, v75, v75 row_shr:2 row_mask:0xf bank_mask:0xf bound_ctrl:0
    v_add_f32_dpp v81, v81, v81 row_shr:2 row_mask:0xf bank_mask:0xf bound_ctrl:0
    s_nop 0
    v_add_f32_dpp v75, v75, v75 row_shr:4 row_mask:0xf bank_mask:0xf bound_ctrl:0
    v_add_f32_dpp v81, v81, v81 row_shr:4 row_mask:0xf bank_mask:0xf bound_ctrl:0
    s_nop 0
    v_add_f32_dpp v75, v75, v75 row_shr:8 row_mask:0xf bank_mask:0xf bound_ctrl:0
    v_add_f32_dpp v81, v81, v81 row_shr:8 row_mask:0xf bank_mask:0xf bound_ctrl:0
    s_nop 0
    v_add_f32_dpp v75, v75, v75 row_bcast:15 row_mask:0xa bank_mask:0xf
    v_add_f32_dpp v81, v81, v81 row_bcast:15 row_mask:0xa bank_mask:0xf
    s_nop 0
    v_add_f32_dpp v75, v75, v75 row_bcast:31 row_mask:0xc bank_mask:0xf
    v_add_f32_dpp v81, v81, v81 row_bcast:31 row_mask:0xc bank_mask:0xf
    s_nop 0
    v_readlane_b32 s66, v75, 63
    v_readlane_b32 s69, v81, 63
    s_nop 0
    v_mov_b32 v72, s66
    v_mov_b32 v78, s69
    v_cvt_pk_bf16_f32 v72, v72, v72
    v_cvt_pk_bf16_f32 v78, v78, v78
    v_and_b32 v72, 0xffff0000, v72
    v_and_b32 v78, 0xffff0000, v78
    v_mov_b32 v73, s64
    v_readfirstlane_b32 s66, v72
    v_readfirstlane_b32 s69, v78
    v_lshlrev_b32 v74, 5, v0
    s_lshl_b32 s70, s3, 3
    s_add_u32 s70, s70, 162816
    v_add_u32 v74, s70, v74
    v_writelane_b32 v73, s65, 1
    v_writelane_b32 v73, s66, 2
    v_writelane_b32 v73, s67, 3
    v_writelane_b32 v73, s68, 4
    v_writelane_b32 v73, s69, 5
    s_add_u32 s71, s70, 4
    v_writelane_b32 v74, s71, 3
    s_add_u32 s71, s70, 36
    v_writelane_b32 v74, s71, 4
    s_add_u32 s71, s70, 68
    v_writelane_b32 v74, s71, 5
    s_mov_b64 exec, 63
    ds_write_b32 v74, v73
    s_mov_b64 exec, -1
    s_mov_b32 s48, 0
    s_mov_b32 s49, 0
    s_mov_b32 s51, 0xfffec000
    s_waitcnt lgkmcnt(0)
    s_barrier
    ds_read_b128 v[8:11], v1 offset:0
    ds_read_b64_tr_b16 v[24:25], v3 offset:0
    ds_read_b64_tr_b16 v[26:27], v3 offset:512
    ds_read_b128 v[12:15], v1 offset:2048
    ds_read_b128 v[16:19], v1 offset:4096
    ds_read_b128 v[20:23], v1 offset:6144
    ds_read_b64_tr_b16 v[28:29], v4 offset:0
    ds_read_b64_tr_b16 v[30:31], v4 offset:512
    ds_read_b64_tr_b16 v[32:33], v3 offset:8192
    ds_read_b64_tr_b16 v[34:35], v3 offset:8704
    ds_read_b64_tr_b16 v[36:37], v4 offset:8192
    ds_read_b64_tr_b16 v[38:39], v4 offset:8704
    ds_read_b64_tr_b16 v[40:41], v3 offset:16384
    ds_read_b64_tr_b16 v[42:43], v3 offset:16896
    ds_read_b64_tr_b16 v[44:45], v4 offset:16384
    ds_read_b64_tr_b16 v[46:47], v4 offset:16896
    .p2align 6
recurrent_scan__softmax_full_mha__moe_arch_mod__prompt_kernel_cloop:
    s_add_u32 s49, s49, 1
    s_cmp_eq_u32 s49, 3
    s_cselect_b32 s50, s51, 40960
    s_cselect_b32 s49, 0, s49
    s_waitcnt lgkmcnt(0)
    v_mfma_f32_16x16x32_bf16 v[96:99], v[24:27], v[8:11], v[96:99]
    ds_read_b128 v[48:51], v2 offset:0
    v_mfma_f32_16x16x32_bf16 v[100:103], v[24:27], v[12:15], v[100:103]
    ds_read_b64_tr_b16 v[64:65], v3 offset:4096
    v_mfma_f32_16x16x32_bf16 v[104:107], v[24:27], v[16:19], v[104:107]
    ds_read_b64_tr_b16 v[66:67], v3 offset:4608
    v_mfma_f32_16x16x32_bf16 v[108:111], v[24:27], v[20:23], v[108:111]
    ds_read_b128 v[52:55], v2 offset:2048
    v_mfma_f32_16x16x32_bf16 v[112:115], v[28:31], v[8:11], v[112:115]
    ds_read_b128 v[56:59], v2 offset:4096
    v_mfma_f32_16x16x32_bf16 v[116:119], v[28:31], v[12:15], v[116:119]
    ds_read_b128 v[60:63], v2 offset:6144
    v_mfma_f32_16x16x32_bf16 v[120:123], v[28:31], v[16:19], v[120:123]
    ds_read_b64_tr_b16 v[68:69], v4 offset:4096
    v_mfma_f32_16x16x32_bf16 v[124:127], v[28:31], v[20:23], v[124:127]
    ds_read_b64_tr_b16 v[70:71], v4 offset:4608
    v_mfma_f32_16x16x32_bf16 v[128:131], v[32:35], v[8:11], v[128:131]
    ds_read_b64_tr_b16 v[72:73], v3 offset:12288
    v_mfma_f32_16x16x32_bf16 v[132:135], v[32:35], v[12:15], v[132:135]
    ds_read_b64_tr_b16 v[74:75], v3 offset:12800
    v_mfma_f32_16x16x32_bf16 v[136:139], v[32:35], v[16:19], v[136:139]
    ds_read_b64_tr_b16 v[76:77], v4 offset:12288
    v_mfma_f32_16x16x32_bf16 v[140:143], v[32:35], v[20:23], v[140:143]
    ds_read_b64_tr_b16 v[78:79], v4 offset:12800
    v_mfma_f32_16x16x32_bf16 v[144:147], v[36:39], v[8:11], v[144:147]
    ds_read_b64_tr_b16 v[80:81], v3 offset:20480
    v_mfma_f32_16x16x32_bf16 v[148:151], v[36:39], v[12:15], v[148:151]
    ds_read_b64_tr_b16 v[82:83], v3 offset:20992
    v_mfma_f32_16x16x32_bf16 v[152:155], v[36:39], v[16:19], v[152:155]
    ds_read_b64_tr_b16 v[84:85], v4 offset:20480
    v_mfma_f32_16x16x32_bf16 v[156:159], v[36:39], v[20:23], v[156:159]
    ds_read_b64_tr_b16 v[86:87], v4 offset:20992
    v_mfma_f32_16x16x32_bf16 v[160:163], v[8:11], v[40:43], v[160:163]
    v_add_u32 v1, s50, v1
    v_mfma_f32_16x16x32_bf16 v[164:167], v[12:15], v[40:43], v[164:167]
    v_add_u32 v2, s50, v2
    v_mfma_f32_16x16x32_bf16 v[168:171], v[16:19], v[40:43], v[168:171]
    v_add_u32 v3, s50, v3
    v_mfma_f32_16x16x32_bf16 v[172:175], v[20:23], v[40:43], v[172:175]
    v_add_u32 v4, s50, v4
    v_mfma_f32_16x16x32_bf16 v[176:179], v[8:11], v[44:47], v[176:179]
    v_mfma_f32_16x16x32_bf16 v[180:183], v[12:15], v[44:47], v[180:183]
    v_mfma_f32_16x16x32_bf16 v[184:187], v[16:19], v[44:47], v[184:187]
    v_mfma_f32_16x16x32_bf16 v[188:191], v[20:23], v[44:47], v[188:191]
    s_waitcnt lgkmcnt(0)
    v_mfma_f32_16x16x32_bf16 v[96:99], v[64:67], v[48:51], v[96:99]
    v_mfma_f32_16x16x32_bf16 v[100:103], v[64:67], v[52:55], v[100:103]
    s_barrier
    v_mfma_f32_16x16x32_bf16 v[104:107], v[64:67], v[56:59], v[104:107]
    ds_read_b128 v[8:11], v1 offset:0
    v_mfma_f32_16x16x32_bf16 v[108:111], v[64:67], v[60:63], v[108:111]
    ds_read_b64_tr_b16 v[24:25], v3 offset:0
    v_mfma_f32_16x16x32_bf16 v[112:115], v[68:71], v[48:51], v[112:115]
    ds_read_b64_tr_b16 v[26:27], v3 offset:512
    v_mfma_f32_16x16x32_bf16 v[116:119], v[68:71], v[52:55], v[116:119]
    ds_read_b128 v[12:15], v1 offset:2048
    v_mfma_f32_16x16x32_bf16 v[120:123], v[68:71], v[56:59], v[120:123]
    ds_read_b128 v[16:19], v1 offset:4096
    v_mfma_f32_16x16x32_bf16 v[124:127], v[68:71], v[60:63], v[124:127]
    ds_read_b128 v[20:23], v1 offset:6144
    v_mfma_f32_16x16x32_bf16 v[128:131], v[72:75], v[48:51], v[128:131]
    ds_read_b64_tr_b16 v[28:29], v4 offset:0
    v_mfma_f32_16x16x32_bf16 v[132:135], v[72:75], v[52:55], v[132:135]
    ds_read_b64_tr_b16 v[30:31], v4 offset:512
    v_mfma_f32_16x16x32_bf16 v[136:139], v[72:75], v[56:59], v[136:139]
    ds_read_b64_tr_b16 v[32:33], v3 offset:8192
    v_mfma_f32_16x16x32_bf16 v[140:143], v[72:75], v[60:63], v[140:143]
    ds_read_b64_tr_b16 v[34:35], v3 offset:8704
    v_mfma_f32_16x16x32_bf16 v[144:147], v[76:79], v[48:51], v[144:147]
    ds_read_b64_tr_b16 v[36:37], v4 offset:8192
    v_mfma_f32_16x16x32_bf16 v[148:151], v[76:79], v[52:55], v[148:151]
    ds_read_b64_tr_b16 v[38:39], v4 offset:8704
    v_mfma_f32_16x16x32_bf16 v[152:155], v[76:79], v[56:59], v[152:155]
    ds_read_b64_tr_b16 v[40:41], v3 offset:16384
    v_mfma_f32_16x16x32_bf16 v[156:159], v[76:79], v[60:63], v[156:159]
    ds_read_b64_tr_b16 v[42:43], v3 offset:16896
    v_mfma_f32_16x16x32_bf16 v[160:163], v[48:51], v[80:83], v[160:163]
    ds_read_b64_tr_b16 v[44:45], v4 offset:16384
    v_mfma_f32_16x16x32_bf16 v[164:167], v[52:55], v[80:83], v[164:167]
    ds_read_b64_tr_b16 v[46:47], v4 offset:16896
    v_mfma_f32_16x16x32_bf16 v[168:171], v[56:59], v[80:83], v[168:171]
    s_add_u32 s48, s48, 1
    v_mfma_f32_16x16x32_bf16 v[172:175], v[60:63], v[80:83], v[172:175]
    s_cmp_lt_u32 s48, 16
    v_mfma_f32_16x16x32_bf16 v[176:179], v[48:51], v[84:87], v[176:179]
    v_mfma_f32_16x16x32_bf16 v[180:183], v[52:55], v[84:87], v[180:183]
    v_mfma_f32_16x16x32_bf16 v[184:187], v[56:59], v[84:87], v[184:187]
    v_mfma_f32_16x16x32_bf16 v[188:191], v[60:63], v[84:87], v[188:191]
    s_add_u32 s49, s49, 1
    s_cmp_eq_u32 s49, 3
    s_cselect_b32 s50, s51, 40960
    s_cselect_b32 s49, 0, s49
    s_waitcnt lgkmcnt(0)
    v_mfma_f32_16x16x32_bf16 v[96:99], v[24:27], v[8:11], v[96:99]
    ds_read_b128 v[48:51], v2 offset:0
    v_mfma_f32_16x16x32_bf16 v[100:103], v[24:27], v[12:15], v[100:103]
    ds_read_b64_tr_b16 v[64:65], v3 offset:4096
    v_mfma_f32_16x16x32_bf16 v[104:107], v[24:27], v[16:19], v[104:107]
    ds_read_b64_tr_b16 v[66:67], v3 offset:4608
    v_mfma_f32_16x16x32_bf16 v[108:111], v[24:27], v[20:23], v[108:111]
    ds_read_b128 v[52:55], v2 offset:2048
    v_mfma_f32_16x16x32_bf16 v[112:115], v[28:31], v[8:11], v[112:115]
    ds_read_b128 v[56:59], v2 offset:4096
    v_mfma_f32_16x16x32_bf16 v[116:119], v[28:31], v[12:15], v[116:119]
    ds_read_b128 v[60:63], v2 offset:6144
    v_mfma_f32_16x16x32_bf16 v[120:123], v[28:31], v[16:19], v[120:123]
    ds_read_b64_tr_b16 v[68:69], v4 offset:4096
    v_mfma_f32_16x16x32_bf16 v[124:127], v[28:31], v[20:23], v[124:127]
    ds_read_b64_tr_b16 v[70:71], v4 offset:4608
    v_mfma_f32_16x16x32_bf16 v[128:131], v[32:35], v[8:11], v[128:131]
    ds_read_b64_tr_b16 v[72:73], v3 offset:12288
    v_mfma_f32_16x16x32_bf16 v[132:135], v[32:35], v[12:15], v[132:135]
    ds_read_b64_tr_b16 v[74:75], v3 offset:12800
    v_mfma_f32_16x16x32_bf16 v[136:139], v[32:35], v[16:19], v[136:139]
    ds_read_b64_tr_b16 v[76:77], v4 offset:12288
    v_mfma_f32_16x16x32_bf16 v[140:143], v[32:35], v[20:23], v[140:143]
    ds_read_b64_tr_b16 v[78:79], v4 offset:12800
    v_mfma_f32_16x16x32_bf16 v[144:147], v[36:39], v[8:11], v[144:147]
    ds_read_b64_tr_b16 v[80:81], v3 offset:20480
    v_mfma_f32_16x16x32_bf16 v[148:151], v[36:39], v[12:15], v[148:151]
    ds_read_b64_tr_b16 v[82:83], v3 offset:20992
    v_mfma_f32_16x16x32_bf16 v[152:155], v[36:39], v[16:19], v[152:155]
    ds_read_b64_tr_b16 v[84:85], v4 offset:20480
    v_mfma_f32_16x16x32_bf16 v[156:159], v[36:39], v[20:23], v[156:159]
    ds_read_b64_tr_b16 v[86:87], v4 offset:20992
    v_mfma_f32_16x16x32_bf16 v[160:163], v[8:11], v[40:43], v[160:163]
    v_add_u32 v1, s50, v1
    v_mfma_f32_16x16x32_bf16 v[164:167], v[12:15], v[40:43], v[164:167]
    v_add_u32 v2, s50, v2
    v_mfma_f32_16x16x32_bf16 v[168:171], v[16:19], v[40:43], v[168:171]
    v_add_u32 v3, s50, v3
    v_mfma_f32_16x16x32_bf16 v[172:175], v[20:23], v[40:43], v[172:175]
    v_add_u32 v4, s50, v4
    v_mfma_f32_16x16x32_bf16 v[176:179], v[8:11], v[44:47], v[176:179]
    v_mfma_f32_16x16x32_bf16 v[180:183], v[12:15], v[44:47], v[180:183]
    v_mfma_f32_16x16x32_bf16 v[184:187], v[16:19], v[44:47], v[184:187]
    v_mfma_f32_16x16x32_bf16 v[188:191], v[20:23], v[44:47], v[188:191]
    s_waitcnt lgkmcnt(0)
    v_mfma_f32_16x16x32_bf16 v[96:99], v[64:67], v[48:51], v[96:99]
    v_mfma_f32_16x16x32_bf16 v[100:103], v[64:67], v[52:55], v[100:103]
    s_barrier
    v_mfma_f32_16x16x32_bf16 v[104:107], v[64:67], v[56:59], v[104:107]
    ds_read_b128 v[8:11], v1 offset:0
    v_mfma_f32_16x16x32_bf16 v[108:111], v[64:67], v[60:63], v[108:111]
    ds_read_b64_tr_b16 v[24:25], v3 offset:0
    v_mfma_f32_16x16x32_bf16 v[112:115], v[68:71], v[48:51], v[112:115]
    ds_read_b64_tr_b16 v[26:27], v3 offset:512
    v_mfma_f32_16x16x32_bf16 v[116:119], v[68:71], v[52:55], v[116:119]
    ds_read_b128 v[12:15], v1 offset:2048
    v_mfma_f32_16x16x32_bf16 v[120:123], v[68:71], v[56:59], v[120:123]
    ds_read_b128 v[16:19], v1 offset:4096
    v_mfma_f32_16x16x32_bf16 v[124:127], v[68:71], v[60:63], v[124:127]
    ds_read_b128 v[20:23], v1 offset:6144
    v_mfma_f32_16x16x32_bf16 v[128:131], v[72:75], v[48:51], v[128:131]
    ds_read_b64_tr_b16 v[28:29], v4 offset:0
    v_mfma_f32_16x16x32_bf16 v[132:135], v[72:75], v[52:55], v[132:135]
    ds_read_b64_tr_b16 v[30:31], v4 offset:512
    v_mfma_f32_16x16x32_bf16 v[136:139], v[72:75], v[56:59], v[136:139]
    ds_read_b64_tr_b16 v[32:33], v3 offset:8192
    v_mfma_f32_16x16x32_bf16 v[140:143], v[72:75], v[60:63], v[140:143]
    ds_read_b64_tr_b16 v[34:35], v3 offset:8704
    v_mfma_f32_16x16x32_bf16 v[144:147], v[76:79], v[48:51], v[144:147]
    ds_read_b64_tr_b16 v[36:37], v4 offset:8192
    v_mfma_f32_16x16x32_bf16 v[148:151], v[76:79], v[52:55], v[148:151]
    ds_read_b64_tr_b16 v[38:39], v4 offset:8704
    v_mfma_f32_16x16x32_bf16 v[152:155], v[76:79], v[56:59], v[152:155]
    ds_read_b64_tr_b16 v[40:41], v3 offset:16384
    v_mfma_f32_16x16x32_bf16 v[156:159], v[76:79], v[60:63], v[156:159]
    ds_read_b64_tr_b16 v[42:43], v3 offset:16896
    v_mfma_f32_16x16x32_bf16 v[160:163], v[48:51], v[80:83], v[160:163]
    ds_read_b64_tr_b16 v[44:45], v4 offset:16384
    v_mfma_f32_16x16x32_bf16 v[164:167], v[52:55], v[80:83], v[164:167]
    ds_read_b64_tr_b16 v[46:47], v4 offset:16896
    v_mfma_f32_16x16x32_bf16 v[168:171], v[56:59], v[80:83], v[168:171]
    s_add_u32 s48, s48, 1
    v_mfma_f32_16x16x32_bf16 v[172:175], v[60:63], v[80:83], v[172:175]
    s_cmp_lt_u32 s48, 16
    v_mfma_f32_16x16x32_bf16 v[176:179], v[48:51], v[84:87], v[176:179]
    v_mfma_f32_16x16x32_bf16 v[180:183], v[52:55], v[84:87], v[180:183]
    v_mfma_f32_16x16x32_bf16 v[184:187], v[56:59], v[84:87], v[184:187]
    v_mfma_f32_16x16x32_bf16 v[188:191], v[60:63], v[84:87], v[188:191]
    s_cbranch_scc1 recurrent_scan__softmax_full_mha__moe_arch_mod__prompt_kernel_cloop
    s_waitcnt lgkmcnt(0)
    v_and_b32 v1, 15, v0
    v_lshrrev_b32 v2, 4, v0
    s_lshl_b32 s64, s52, 8
    s_add_u32 s64, s64, 159744
    s_mul_i32 s65, s53, 384
    s_add_u32 s65, s65, 160768
    v_lshlrev_b32 v3, 2, v1
    v_add_u32 v4, s64, v3
    ds_read_b32 v8, v4 offset:0
    ds_read_b32 v9, v4 offset:512
    ds_read_b32 v10, v4 offset:64
    ds_read_b32 v11, v4 offset:576
    ds_read_b32 v12, v4 offset:128
    ds_read_b32 v13, v4 offset:640
    ds_read_b32 v14, v4 offset:192
    ds_read_b32 v15, v4 offset:704
    v_lshlrev_b32 v5, 4, v2
    v_add_u32 v6, s65, v5
    ds_read_b128 v[16:19], v6 offset:0
    ds_read_b128 v[20:23], v6 offset:64
    ds_read_b128 v[24:27], v6 offset:128
    ds_read_b128 v[28:31], v6 offset:192
    v_add_u32 v6, s64, v5
    v_add_u32 v3, s65, v3
    ds_read_b32 v64, v3 offset:256
    ds_read_b32 v65, v3 offset:320
    ds_read_b128 v[32:35], v6 offset:0
    ds_read_b128 v[48:51], v6 offset:512
    ds_read_b128 v[36:39], v6 offset:64
    ds_read_b128 v[52:55], v6 offset:576
    ds_read_b128 v[40:43], v6 offset:128
    ds_read_b128 v[56:59], v6 offset:640
    ds_read_b128 v[44:47], v6 offset:192
    ds_read_b128 v[60:63], v6 offset:704
    v_lshrrev_b32 v3, 1, v2
    v_and_b32 v4, 1, v2
    v_lshl_add_u32 v5, v3, 5, v1
    v_lshlrev_b32 v5, 4, v5
    v_lshl_add_u32 v5, v4, 3, v5
    v_lshl_add_u32 v6, v4, 5, v1
    v_lshlrev_b32 v6, 4, v6
    v_lshl_add_u32 v6, v3, 3, v6
    s_lshl_b32 s64, s53, 1
    s_add_u32 s64, s64, s52
    s_lshl_b32 s64, s64, 13
    v_add_u32 v74, s64, v5
    v_add_u32 v75, s64, v6
    s_lshr_b32 s64, s64, 1
    s_add_u32 s64, s64, 122880
    v_add_u32 v76, s64, v5
    s_mov_b32 s65, 0x3e8293ee
    s_waitcnt lgkmcnt(10)
    v_mul_f32 v67, s65, v9
    v_mul_f32 v69, s65, v11
    v_mul_f32 v71, s65, v13
    v_mul_f32 v73, s65, v15
    s_waitcnt lgkmcnt(0)
    v_pk_fma_f32 v[128:129], v[24:25], v[8:9], v[128:129] op_sel_hi:[1,0,1] neg_lo:[0,1,0] neg_hi:[0,1,0]
    v_pk_mul_f32 v[128:129], v[128:129], v[8:9] op_sel:[0,1] op_sel_hi:[1,1]
    v_cvt_pk_bf16_f32 v78, v128, v129
    v_pk_fma_f32 v[130:131], v[26:27], v[8:9], v[130:131] op_sel_hi:[1,0,1] neg_lo:[0,1,0] neg_hi:[0,1,0]
    v_pk_mul_f32 v[130:131], v[130:131], v[8:9] op_sel:[0,1] op_sel_hi:[1,1]
    v_cvt_pk_bf16_f32 v79, v130, v131
    ds_write_b64 v74, v[78:79] offset:0
    v_pk_fma_f32 v[132:133], v[24:25], v[10:11], v[132:133] op_sel_hi:[1,0,1] neg_lo:[0,1,0] neg_hi:[0,1,0]
    v_pk_mul_f32 v[132:133], v[132:133], v[10:11] op_sel:[0,1] op_sel_hi:[1,1]
    v_cvt_pk_bf16_f32 v80, v132, v133
    v_pk_fma_f32 v[134:135], v[26:27], v[10:11], v[134:135] op_sel_hi:[1,0,1] neg_lo:[0,1,0] neg_hi:[0,1,0]
    v_pk_mul_f32 v[134:135], v[134:135], v[10:11] op_sel:[0,1] op_sel_hi:[1,1]
    v_cvt_pk_bf16_f32 v81, v134, v135
    ds_write_b64 v74, v[80:81] offset:256
    v_pk_fma_f32 v[136:137], v[24:25], v[12:13], v[136:137] op_sel_hi:[1,0,1] neg_lo:[0,1,0] neg_hi:[0,1,0]
    v_pk_mul_f32 v[136:137], v[136:137], v[12:13] op_sel:[0,1] op_sel_hi:[1,1]
    v_cvt_pk_bf16_f32 v82, v136, v137
    v_pk_fma_f32 v[138:139], v[26:27], v[12:13], v[138:139] op_sel_hi:[1,0,1] neg_lo:[0,1,0] neg_hi:[0,1,0]
    v_pk_mul_f32 v[138:139], v[138:139], v[12:13] op_sel:[0,1] op_sel_hi:[1,1]
    v_cvt_pk_bf16_f32 v83, v138, v139
    ds_write_b64 v74, v[82:83] offset:4096
    v_pk_fma_f32 v[140:141], v[24:25], v[14:15], v[140:141] op_sel_hi:[1,0,1] neg_lo:[0,1,0] neg_hi:[0,1,0]
    v_pk_mul_f32 v[140:141], v[140:141], v[14:15] op_sel:[0,1] op_sel_hi:[1,1]
    v_cvt_pk_bf16_f32 v84, v140, v141
    v_pk_fma_f32 v[142:143], v[26:27], v[14:15], v[142:143] op_sel_hi:[1,0,1] neg_lo:[0,1,0] neg_hi:[0,1,0]
    v_pk_mul_f32 v[142:143], v[142:143], v[14:15] op_sel:[0,1] op_sel_hi:[1,1]
    v_cvt_pk_bf16_f32 v85, v142, v143
    ds_write_b64 v74, v[84:85] offset:4352
    v_pk_fma_f32 v[144:145], v[28:29], v[8:9], v[144:145] op_sel_hi:[1,0,1] neg_lo:[0,1,0] neg_hi:[0,1,0]
    v_pk_mul_f32 v[144:145], v[144:145], v[8:9] op_sel:[0,1] op_sel_hi:[1,1]
    v_cvt_pk_bf16_f32 v78, v144, v145
    v_pk_fma_f32 v[146:147], v[30:31], v[8:9], v[146:147] op_sel_hi:[1,0,1] neg_lo:[0,1,0] neg_hi:[0,1,0]
    v_pk_mul_f32 v[146:147], v[146:147], v[8:9] op_sel:[0,1] op_sel_hi:[1,1]
    v_cvt_pk_bf16_f32 v79, v146, v147
    ds_write_b64 v74, v[78:79] offset:1024
    v_pk_fma_f32 v[148:149], v[28:29], v[10:11], v[148:149] op_sel_hi:[1,0,1] neg_lo:[0,1,0] neg_hi:[0,1,0]
    v_pk_mul_f32 v[148:149], v[148:149], v[10:11] op_sel:[0,1] op_sel_hi:[1,1]
    v_cvt_pk_bf16_f32 v80, v148, v149
    v_pk_fma_f32 v[150:151], v[30:31], v[10:11], v[150:151] op_sel_hi:[1,0,1] neg_lo:[0,1,0] neg_hi:[0,1,0]
    v_pk_mul_f32 v[150:151], v[150:151], v[10:11] op_sel:[0,1] op_sel_hi:[1,1]
    v_cvt_pk_bf16_f32 v81, v150, v151
    ds_write_b64 v74, v[80:81] offset:1280
    v_pk_fma_f32 v[152:153], v[28:29], v[12:13], v[152:153] op_sel_hi:[1,0,1] neg_lo:[0,1,0] neg_hi:[0,1,0]
    v_pk_mul_f32 v[152:153], v[152:153], v[12:13] op_sel:[0,1] op_sel_hi:[1,1]
    v_cvt_pk_bf16_f32 v82, v152, v153
    v_pk_fma_f32 v[154:155], v[30:31], v[12:13], v[154:155] op_sel_hi:[1,0,1] neg_lo:[0,1,0] neg_hi:[0,1,0]
    v_pk_mul_f32 v[154:155], v[154:155], v[12:13] op_sel:[0,1] op_sel_hi:[1,1]
    v_cvt_pk_bf16_f32 v83, v154, v155
    ds_write_b64 v74, v[82:83] offset:5120
    v_pk_fma_f32 v[156:157], v[28:29], v[14:15], v[156:157] op_sel_hi:[1,0,1] neg_lo:[0,1,0] neg_hi:[0,1,0]
    v_pk_mul_f32 v[156:157], v[156:157], v[14:15] op_sel:[0,1] op_sel_hi:[1,1]
    v_cvt_pk_bf16_f32 v84, v156, v157
    v_pk_fma_f32 v[158:159], v[30:31], v[14:15], v[158:159] op_sel_hi:[1,0,1] neg_lo:[0,1,0] neg_hi:[0,1,0]
    v_pk_mul_f32 v[158:159], v[158:159], v[14:15] op_sel:[0,1] op_sel_hi:[1,1]
    v_cvt_pk_bf16_f32 v85, v158, v159
    ds_write_b64 v74, v[84:85] offset:5376
    s_waitcnt lgkmcnt(0)
    s_barrier
    v_pk_fma_f32 v[160:161], v[32:33], v[64:65], v[160:161] op_sel_hi:[1,0,1] neg_lo:[0,1,0] neg_hi:[0,1,0]
    v_pk_mul_f32 v[160:161], v[160:161], v[48:49]
    v_cvt_pk_bf16_f32 v78, v160, v161
    v_pk_fma_f32 v[162:163], v[34:35], v[64:65], v[162:163] op_sel_hi:[1,0,1] neg_lo:[0,1,0] neg_hi:[0,1,0]
    v_pk_mul_f32 v[162:163], v[162:163], v[50:51]
    v_cvt_pk_bf16_f32 v79, v162, v163
    ds_write_b64 v75, v[78:79] offset:2048
    v_pk_fma_f32 v[164:165], v[36:37], v[64:65], v[164:165] op_sel_hi:[1,0,1] neg_lo:[0,1,0] neg_hi:[0,1,0]
    v_pk_mul_f32 v[164:165], v[164:165], v[52:53]
    v_cvt_pk_bf16_f32 v80, v164, v165
    v_pk_fma_f32 v[166:167], v[38:39], v[64:65], v[166:167] op_sel_hi:[1,0,1] neg_lo:[0,1,0] neg_hi:[0,1,0]
    v_pk_mul_f32 v[166:167], v[166:167], v[54:55]
    v_cvt_pk_bf16_f32 v81, v166, v167
    ds_write_b64 v75, v[80:81] offset:3072
    v_pk_fma_f32 v[168:169], v[40:41], v[64:65], v[168:169] op_sel_hi:[1,0,1] neg_lo:[0,1,0] neg_hi:[0,1,0]
    v_pk_mul_f32 v[168:169], v[168:169], v[56:57]
    v_cvt_pk_bf16_f32 v82, v168, v169
    v_pk_fma_f32 v[170:171], v[42:43], v[64:65], v[170:171] op_sel_hi:[1,0,1] neg_lo:[0,1,0] neg_hi:[0,1,0]
    v_pk_mul_f32 v[170:171], v[170:171], v[58:59]
    v_cvt_pk_bf16_f32 v83, v170, v171
    ds_write_b64 v75, v[82:83] offset:6144
    v_pk_fma_f32 v[172:173], v[44:45], v[64:65], v[172:173] op_sel_hi:[1,0,1] neg_lo:[0,1,0] neg_hi:[0,1,0]
    v_pk_mul_f32 v[172:173], v[172:173], v[60:61]
    v_cvt_pk_bf16_f32 v84, v172, v173
    v_pk_fma_f32 v[174:175], v[46:47], v[64:65], v[174:175] op_sel_hi:[1,0,1] neg_lo:[0,1,0] neg_hi:[0,1,0]
    v_pk_mul_f32 v[174:175], v[174:175], v[62:63]
    v_cvt_pk_bf16_f32 v85, v174, v175
    ds_write_b64 v75, v[84:85] offset:7168
    v_pk_fma_f32 v[176:177], v[32:33], v[64:65], v[176:177] op_sel:[0,1,0] op_sel_hi:[1,1,1] neg_lo:[0,1,0] neg_hi:[0,1,0]
    v_pk_mul_f32 v[176:177], v[176:177], v[48:49]
    v_cvt_pk_bf16_f32 v78, v176, v177
    v_pk_fma_f32 v[178:179], v[34:35], v[64:65], v[178:179] op_sel:[0,1,0] op_sel_hi:[1,1,1] neg_lo:[0,1,0] neg_hi:[0,1,0]
    v_pk_mul_f32 v[178:179], v[178:179], v[50:51]
    v_cvt_pk_bf16_f32 v79, v178, v179
    ds_write_b64 v75, v[78:79] offset:2304
    v_pk_fma_f32 v[180:181], v[36:37], v[64:65], v[180:181] op_sel:[0,1,0] op_sel_hi:[1,1,1] neg_lo:[0,1,0] neg_hi:[0,1,0]
    v_pk_mul_f32 v[180:181], v[180:181], v[52:53]
    v_cvt_pk_bf16_f32 v80, v180, v181
    v_pk_fma_f32 v[182:183], v[38:39], v[64:65], v[182:183] op_sel:[0,1,0] op_sel_hi:[1,1,1] neg_lo:[0,1,0] neg_hi:[0,1,0]
    v_pk_mul_f32 v[182:183], v[182:183], v[54:55]
    v_cvt_pk_bf16_f32 v81, v182, v183
    ds_write_b64 v75, v[80:81] offset:3328
    v_pk_fma_f32 v[184:185], v[40:41], v[64:65], v[184:185] op_sel:[0,1,0] op_sel_hi:[1,1,1] neg_lo:[0,1,0] neg_hi:[0,1,0]
    v_pk_mul_f32 v[184:185], v[184:185], v[56:57]
    v_cvt_pk_bf16_f32 v82, v184, v185
    v_pk_fma_f32 v[186:187], v[42:43], v[64:65], v[186:187] op_sel:[0,1,0] op_sel_hi:[1,1,1] neg_lo:[0,1,0] neg_hi:[0,1,0]
    v_pk_mul_f32 v[186:187], v[186:187], v[58:59]
    v_cvt_pk_bf16_f32 v83, v186, v187
    ds_write_b64 v75, v[82:83] offset:6400
    v_pk_fma_f32 v[188:189], v[44:45], v[64:65], v[188:189] op_sel:[0,1,0] op_sel_hi:[1,1,1] neg_lo:[0,1,0] neg_hi:[0,1,0]
    v_pk_mul_f32 v[188:189], v[188:189], v[60:61]
    v_cvt_pk_bf16_f32 v84, v188, v189
    v_pk_fma_f32 v[190:191], v[46:47], v[64:65], v[190:191] op_sel:[0,1,0] op_sel_hi:[1,1,1] neg_lo:[0,1,0] neg_hi:[0,1,0]
    v_pk_mul_f32 v[190:191], v[190:191], v[62:63]
    v_cvt_pk_bf16_f32 v85, v190, v191
    ds_write_b64 v75, v[84:85] offset:7424
    s_waitcnt lgkmcnt(0)
    s_barrier
    v_pk_fma_f32 v[96:97], v[16:17], v[8:9], v[96:97] op_sel_hi:[1,0,1] neg_lo:[0,1,0] neg_hi:[0,1,0]
    v_pk_mul_f32 v[96:97], v[96:97], v[66:67] op_sel:[0,1] op_sel_hi:[1,1]
    v_cvt_pk_bf16_f32 v78, v96, v97
    v_pk_fma_f32 v[98:99], v[18:19], v[8:9], v[98:99] op_sel_hi:[1,0,1] neg_lo:[0,1,0] neg_hi:[0,1,0]
    v_pk_mul_f32 v[98:99], v[98:99], v[66:67] op_sel:[0,1] op_sel_hi:[1,1]
    v_cvt_pk_bf16_f32 v79, v98, v99
    ds_write_b64 v76, v[78:79] offset:0
    v_pk_fma_f32 v[100:101], v[16:17], v[10:11], v[100:101] op_sel_hi:[1,0,1] neg_lo:[0,1,0] neg_hi:[0,1,0]
    v_pk_mul_f32 v[100:101], v[100:101], v[68:69] op_sel:[0,1] op_sel_hi:[1,1]
    v_cvt_pk_bf16_f32 v80, v100, v101
    v_pk_fma_f32 v[102:103], v[18:19], v[10:11], v[102:103] op_sel_hi:[1,0,1] neg_lo:[0,1,0] neg_hi:[0,1,0]
    v_pk_mul_f32 v[102:103], v[102:103], v[68:69] op_sel:[0,1] op_sel_hi:[1,1]
    v_cvt_pk_bf16_f32 v81, v102, v103
    ds_write_b64 v76, v[80:81] offset:256
    v_pk_fma_f32 v[104:105], v[16:17], v[12:13], v[104:105] op_sel_hi:[1,0,1] neg_lo:[0,1,0] neg_hi:[0,1,0]
    v_pk_mul_f32 v[104:105], v[104:105], v[70:71] op_sel:[0,1] op_sel_hi:[1,1]
    v_cvt_pk_bf16_f32 v82, v104, v105
    v_pk_fma_f32 v[106:107], v[18:19], v[12:13], v[106:107] op_sel_hi:[1,0,1] neg_lo:[0,1,0] neg_hi:[0,1,0]
    v_pk_mul_f32 v[106:107], v[106:107], v[70:71] op_sel:[0,1] op_sel_hi:[1,1]
    v_cvt_pk_bf16_f32 v83, v106, v107
    ds_write_b64 v76, v[82:83] offset:2048
    v_pk_fma_f32 v[108:109], v[16:17], v[14:15], v[108:109] op_sel_hi:[1,0,1] neg_lo:[0,1,0] neg_hi:[0,1,0]
    v_pk_mul_f32 v[108:109], v[108:109], v[72:73] op_sel:[0,1] op_sel_hi:[1,1]
    v_cvt_pk_bf16_f32 v84, v108, v109
    v_pk_fma_f32 v[110:111], v[18:19], v[14:15], v[110:111] op_sel_hi:[1,0,1] neg_lo:[0,1,0] neg_hi:[0,1,0]
    v_pk_mul_f32 v[110:111], v[110:111], v[72:73] op_sel:[0,1] op_sel_hi:[1,1]
    v_cvt_pk_bf16_f32 v85, v110, v111
    ds_write_b64 v76, v[84:85] offset:2304
    v_pk_fma_f32 v[112:113], v[20:21], v[8:9], v[112:113] op_sel_hi:[1,0,1] neg_lo:[0,1,0] neg_hi:[0,1,0]
    v_pk_mul_f32 v[112:113], v[112:113], v[66:67] op_sel:[0,1] op_sel_hi:[1,1]
    v_cvt_pk_bf16_f32 v78, v112, v113
    v_pk_fma_f32 v[114:115], v[22:23], v[8:9], v[114:115] op_sel_hi:[1,0,1] neg_lo:[0,1,0] neg_hi:[0,1,0]
    v_pk_mul_f32 v[114:115], v[114:115], v[66:67] op_sel:[0,1] op_sel_hi:[1,1]
    v_cvt_pk_bf16_f32 v79, v114, v115
    ds_write_b64 v76, v[78:79] offset:1024
    v_pk_fma_f32 v[116:117], v[20:21], v[10:11], v[116:117] op_sel_hi:[1,0,1] neg_lo:[0,1,0] neg_hi:[0,1,0]
    v_pk_mul_f32 v[116:117], v[116:117], v[68:69] op_sel:[0,1] op_sel_hi:[1,1]
    v_cvt_pk_bf16_f32 v80, v116, v117
    v_pk_fma_f32 v[118:119], v[22:23], v[10:11], v[118:119] op_sel_hi:[1,0,1] neg_lo:[0,1,0] neg_hi:[0,1,0]
    v_pk_mul_f32 v[118:119], v[118:119], v[68:69] op_sel:[0,1] op_sel_hi:[1,1]
    v_cvt_pk_bf16_f32 v81, v118, v119
    ds_write_b64 v76, v[80:81] offset:1280
    v_pk_fma_f32 v[120:121], v[20:21], v[12:13], v[120:121] op_sel_hi:[1,0,1] neg_lo:[0,1,0] neg_hi:[0,1,0]
    v_pk_mul_f32 v[120:121], v[120:121], v[70:71] op_sel:[0,1] op_sel_hi:[1,1]
    v_cvt_pk_bf16_f32 v82, v120, v121
    v_pk_fma_f32 v[122:123], v[22:23], v[12:13], v[122:123] op_sel_hi:[1,0,1] neg_lo:[0,1,0] neg_hi:[0,1,0]
    v_pk_mul_f32 v[122:123], v[122:123], v[70:71] op_sel:[0,1] op_sel_hi:[1,1]
    v_cvt_pk_bf16_f32 v83, v122, v123
    ds_write_b64 v76, v[82:83] offset:3072
    v_pk_fma_f32 v[124:125], v[20:21], v[14:15], v[124:125] op_sel_hi:[1,0,1] neg_lo:[0,1,0] neg_hi:[0,1,0]
    v_pk_mul_f32 v[124:125], v[124:125], v[72:73] op_sel:[0,1] op_sel_hi:[1,1]
    v_cvt_pk_bf16_f32 v84, v124, v125
    v_pk_fma_f32 v[126:127], v[22:23], v[14:15], v[126:127] op_sel_hi:[1,0,1] neg_lo:[0,1,0] neg_hi:[0,1,0]
    v_pk_mul_f32 v[126:127], v[126:127], v[72:73] op_sel:[0,1] op_sel_hi:[1,1]
    v_cvt_pk_bf16_f32 v85, v126, v127
    ds_write_b64 v76, v[84:85] offset:3328
    s_waitcnt lgkmcnt(0)
    s_branch recurrent_scan__softmax_full_mha__moe_arch_mod__prompt_kernel_joinA
recurrent_scan__softmax_full_mha__moe_arch_mod__prompt_kernel_loader:
    s_sub_u32 s48, s3, 4
    v_lshrrev_b32 v16, 3, v0
    v_and_b32 v17, 7, v0
    s_lshl_b32 s64, s45, 7
    s_lshl_b32 s65, s48, 5
    s_add_u32 s64, s64, s65
    v_add_u32 v18, s64, v16
    v_lshlrev_b32 v18, 11, v18
    v_lshrrev_b32 v19, 1, v16
    v_xor_b32 v20, v19, v17
    v_lshl_add_u32 v1, v20, 4, v18
    v_xor_b32 v20, 4, v20
    v_lshl_add_u32 v2, v20, 4, v18
    v_add_u32 v2, 16384, v2
    v_add_u32 v3, 32768, v1
    v_add_u32 v4, 32768, v2
    s_lshl_b32 s64, s48, 4
    v_add_u32 v18, s64, v16
    v_mul_u32_u24 v18, 6144, v18
    s_lshl_b32 s64, s44, 7
    v_add_u32 v18, s64, v18
    v_bfe_u32 v19, v0, 4, 1
    v_lshlrev_b32 v19, 1, v19
    v_xor_b32 v19, v19, v17
    v_lshl_add_u32 v5, v19, 4, v18
    v_xor_b32 v19, 4, v19
    v_lshl_add_u32 v6, v19, 4, v18
    v_add_u32 v6, 49152, v6
    s_lshl_b32 s49, s48, 12
    s_lshl_b32 s50, s48, 11
    s_mov_b32 s56, s45
    s_and_b32 s56, s56, 3
    s_lshl_b32 s56, s56, 2
    s_lshr_b32 s57, s45, 2
    s_waitcnt lgkmcnt(0)
    s_and_b32 s56, s56, 15
    s_lshl_b32 s51, s56, 7
    s_mul_i32 s52, s56, 393216
    s_add_u32 s53, s52, 2048
    s_add_u32 s54, s52, 4096
    s_add_u32 s56, s56, 1
    s_add_u32 m0, s49, 0
    s_nop 0
    buffer_load_dwordx4 v1, s[4:7], s51 offen  lds
    s_add_u32 m0, s49, 1024
    s_nop 0
    buffer_load_dwordx4 v2, s[4:7], s51 offen  lds
    s_add_u32 m0, s49, 2048
    s_nop 0
    buffer_load_dwordx4 v3, s[4:7], s51 offen  lds
    s_add_u32 m0, s49, 3072
    s_nop 0
    buffer_load_dwordx4 v4, s[4:7], s51 offen  lds
    s_add_u32 m0, s50, 16384
    s_nop 0
    buffer_load_dwordx4 v5, s[8:11], s52 offen  lds
    s_add_u32 m0, s50, 17408
    s_nop 0
    buffer_load_dwordx4 v6, s[8:11], s52 offen  lds
    s_add_u32 m0, s50, 24576
    s_nop 0
    buffer_load_dwordx4 v5, s[8:11], s53 offen  lds
    s_add_u32 m0, s50, 25600
    s_nop 0
    buffer_load_dwordx4 v6, s[8:11], s53 offen  lds
    s_add_u32 m0, s50, 32768
    s_nop 0
    buffer_load_dwordx4 v5, s[8:11], s54 offen  lds
    s_add_u32 m0, s50, 33792
    s_nop 0
    buffer_load_dwordx4 v6, s[8:11], s54 offen  lds
    s_and_b32 s56, s56, 15
    s_lshl_b32 s51, s56, 7
    s_mul_i32 s52, s56, 393216
    s_add_u32 s53, s52, 2048
    s_add_u32 s54, s52, 4096
    s_add_u32 s56, s56, 1
    s_add_u32 m0, s49, 40960
    s_nop 0
    buffer_load_dwordx4 v1, s[4:7], s51 offen  lds
    s_add_u32 m0, s49, 41984
    s_nop 0
    buffer_load_dwordx4 v2, s[4:7], s51 offen  lds
    s_add_u32 m0, s49, 43008
    s_nop 0
    buffer_load_dwordx4 v3, s[4:7], s51 offen  lds
    s_add_u32 m0, s49, 44032
    s_nop 0
    buffer_load_dwordx4 v4, s[4:7], s51 offen  lds
    s_add_u32 m0, s50, 57344
    s_nop 0
    buffer_load_dwordx4 v5, s[8:11], s52 offen  lds
    s_add_u32 m0, s50, 58368
    s_nop 0
    buffer_load_dwordx4 v6, s[8:11], s52 offen  lds
    v_lshrrev_b32 v16, 4, v0
    v_bfe_u32 v17, v0, 2, 2
    v_lshl_add_u32 v17, v16, 3, v17
    v_lshlrev_b32 v17, 7, v17
    v_and_b32 v18, 3, v0
    v_lshl_add_u32 v17, v18, 3, v17
    v_and_b32 v16, 1, v16
    v_lshlrev_b32 v16, 1, v16
    v_bfe_u32 v18, v0, 3, 1
    v_or_b32 v16, v16, v18
    s_mul_i32 s67, s57, 43
    s_lshr_b32 s67, s67, 7
    s_mul_i32 s67, s67, 3
    s_sub_u32 s67, s57, s67
    s_mul_i32 s67, s67, 40960
    s_add_u32 s67, s67, 16384
    s_and_b32 s64, s48, 1
    s_mul_i32 s64, s64, 3
    s_add_u32 s64, s64, 0
    s_and_b32 s65, s64, 1
    s_and_b32 s66, s48, 2
    s_or_b32 s65, s65, s66
    v_xor_b32 v18, s65, v16
    v_lshl_add_u32 v10, v18, 5, v17
    s_lshr_b32 s64, s64, 1
    s_lshl_b32 s64, s64, 13
    s_add_u32 s64, s64, s67
    v_add_u32 v10, s64, v10
    s_and_b32 s64, s48, 1
    s_mul_i32 s64, s64, 3
    s_add_u32 s64, s64, 1
    s_and_b32 s65, s64, 1
    s_and_b32 s66, s48, 2
    s_or_b32 s65, s65, s66
    v_xor_b32 v18, s65, v16
    v_lshl_add_u32 v11, v18, 5, v17
    s_lshr_b32 s64, s64, 1
    s_lshl_b32 s64, s64, 13
    s_add_u32 s64, s64, s67
    v_add_u32 v11, s64, v11
    s_and_b32 s64, s48, 1
    s_mul_i32 s64, s64, 3
    s_add_u32 s64, s64, 2
    s_and_b32 s65, s64, 1
    s_and_b32 s66, s48, 2
    s_or_b32 s65, s65, s66
    v_xor_b32 v18, s65, v16
    v_lshl_add_u32 v12, v18, 5, v17
    s_lshr_b32 s64, s64, 1
    s_lshl_b32 s64, s64, 13
    s_add_u32 s64, s64, s67
    v_add_u32 v12, s64, v12
    v_mov_b32 v56, 0x3f803f80
    v_mov_b32 v57, 0x3f803f80
    v_mov_b32 v58, 0x3f803f80
    v_mov_b32 v59, 0x3f803f80
    s_cmp_lg_u32 s3, 4
    s_cbranch_scc1 recurrent_scan__softmax_full_mha__moe_arch_mod__prompt_kernel_nozero
    v_lshlrev_b32 v18, 2, v0
    s_lshl_b32 s64, s45, 4
    s_add_u32 s64, s64, s44
    s_lshl_b32 s64, s64, 7
    s_add_u32 s64, s64, 21299200
    v_add_u32 v16, s64, v18
    s_lshl_b32 s64, s45, 4
    s_add_u32 s64, s64, s44
    s_lshl_b32 s64, s64, 5
    s_add_u32 s64, s64, 20971456
    v_cmp_le_u32 vcc, 16, v0
    v_add_u32 v18, s64, v18
    s_nop 0
    v_cndmask_b32 v16, v16, v18, vcc
    s_lshl_b32 s66, s45, 4
    s_add_u32 s66, s66, s44
    s_lshl_b32 s66, s66, 7
    s_add_u32 s66, s66, 21299296
    s_lshl_b32 s64, s44, 9
    s_add_u32 s64, s64, 21364736
    v_and_b32 v18, 3, v0
    v_lshlrev_b32 v18, 7, v18
    v_add_u32 v18, s64, v18
    v_mov_b32 v19, s66
    s_cmp_eq_u32 s45, 0
    s_cselect_b64 vcc, -1, 0
    v_cndmask_b32 v18, v19, v18, vcc
    v_cmp_le_u32 vcc, 24, v0
    s_lshl_b32 s64, s45, 10
    s_add_u32 s64, s64, 21430272
    v_cndmask_b32 v16, v16, v18, vcc
    v_and_b32 v18, 7, v0
    v_lshlrev_b32 v18, 7, v18
    v_add_u32 v18, s64, v18
    s_cmp_eq_u32 s44, 0
    s_cselect_b64 vcc, -1, 0
    v_cndmask_b32 v18, v19, v18, vcc
    v_cmp_le_u32 vcc, 32, v0
    s_lshl_b32 s64, s2, 7
    s_add_u32 s65, s64, 21446656
    v_cndmask_b32 v16, v16, v18, vcc
    s_cmp_lt_u32 s2, 56
    s_cselect_b32 s65, s65, s66
    v_writelane_b32 v16, s65, 40
    s_add_u32 s65, s64, 21479424
    s_cmp_lt_u32 s2, 16
    s_cselect_b32 s65, s65, s66
    v_writelane_b32 v16, s65, 41
    s_lshl_b32 s64, s44, 7
    s_add_u32 s64, s64, 21954560
    s_cmp_eq_u32 s45, 0
    s_cselect_b32 s64, s64, s66
    v_writelane_b32 v16, s64, 42
    s_cmp_eq_u32 s2, 0
    s_cselect_b32 s64, 21970944, s66
    v_writelane_b32 v16, s64, 43
    v_mov_b32 v20, 0
    v_mov_b32 v21, 0
    v_mov_b32 v22, 0
    v_mov_b32 v23, 0
    v_lshlrev_b32 v18, 2, v0
    v_add_u32 v18, 162816, v18
recurrent_scan__softmax_full_mha__moe_arch_mod__prompt_kernel_nozero:
    s_waitcnt lgkmcnt(0)
    s_waitcnt vmcnt(6)
    s_barrier
    s_add_u32 m0, s50, 65536
    s_nop 0
    buffer_load_dwordx4 v5, s[8:11], s53 offen  lds
    s_add_u32 m0, s50, 66560
    s_nop 0
    buffer_load_dwordx4 v6, s[8:11], s53 offen  lds
    s_add_u32 m0, s50, 73728
    s_nop 0
    buffer_load_dwordx4 v5, s[8:11], s54 offen  lds
    s_add_u32 m0, s50, 74752
    s_nop 0
    buffer_load_dwordx4 v6, s[8:11], s54 offen  lds
    s_and_b32 s56, s56, 15
    s_lshl_b32 s51, s56, 7
    s_mul_i32 s52, s56, 393216
    s_add_u32 s53, s52, 2048
    s_add_u32 s54, s52, 4096
    s_add_u32 s56, s56, 1
    s_add_u32 m0, s49, 81920
    s_nop 0
    buffer_load_dwordx4 v1, s[4:7], s51 offen  lds
    s_add_u32 m0, s49, 82944
    s_nop 0
    buffer_load_dwordx4 v2, s[4:7], s51 offen  lds
    s_add_u32 m0, s49, 83968
    s_nop 0
    buffer_load_dwordx4 v3, s[4:7], s51 offen  lds
    s_add_u32 m0, s49, 84992
    s_nop 0
    buffer_load_dwordx4 v4, s[4:7], s51 offen  lds
    s_add_u32 m0, s50, 98304
    s_nop 0
    buffer_load_dwordx4 v5, s[8:11], s52 offen  lds
    s_add_u32 m0, s50, 99328
    s_nop 0
    buffer_load_dwordx4 v6, s[8:11], s52 offen  lds
    s_add_u32 m0, s50, 106496
    s_nop 0
    buffer_load_dwordx4 v5, s[8:11], s53 offen  lds
    s_add_u32 m0, s50, 107520
    s_nop 0
    buffer_load_dwordx4 v6, s[8:11], s53 offen  lds
    s_add_u32 m0, s50, 114688
    s_nop 0
    buffer_load_dwordx4 v5, s[8:11], s54 offen  lds
    s_add_u32 m0, s50, 115712
    s_nop 0
    buffer_load_dwordx4 v6, s[8:11], s54 offen  lds
    s_cmp_lg_u32 s3, 4
    s_cbranch_scc1 recurrent_scan__softmax_full_mha__moe_arch_mod__prompt_kernel_nopub
    v_mov_b32 v17, 0
    s_mov_b64 exec, 0xffffff
    ds_read_b32 v17, v18
    s_lshl_b32 s64, s2, 7
    s_add_u32 s64, s64, 21233664
    s_mov_b64 exec, 0xff
    buffer_store_dwordx4 v[20:23], v94, s[12:15], s64 offen sc1
    s_mul_i32 s64, s2, 896
    s_add_u32 s64, s64, 22020096
    s_bfm_b64 exec, 56, 0
    buffer_store_dwordx4 v[20:23], v94, s[12:15], s64 offen sc1
    s_bfm_b64 exec, 44, 0
    s_waitcnt lgkmcnt(0)
    buffer_store_dword v17, v16, s[12:15], 0 offen sc1
    s_mov_b64 exec, -1
recurrent_scan__softmax_full_mha__moe_arch_mod__prompt_kernel_nopub:
    s_cmp_lg_u32 s57, 0
    s_cbranch_scc1 recurrent_scan__softmax_full_mha__moe_arch_mod__prompt_kernel_cs_1
    s_call_b64 s[70:71], recurrent_scan__softmax_full_mha__moe_arch_mod__prompt_kernel_colsum
recurrent_scan__softmax_full_mha__moe_arch_mod__prompt_kernel_cs_1:
    s_and_b32 s56, s56, 15
    s_lshl_b32 s51, s56, 7
    s_mul_i32 s52, s56, 393216
    s_add_u32 s53, s52, 2048
    s_add_u32 s54, s52, 4096
    s_add_u32 s56, s56, 1
    s_waitcnt lgkmcnt(0)
    s_waitcnt vmcnt(10)
    s_barrier
    s_add_u32 m0, s49, 0
    s_nop 0
    buffer_load_dwordx4 v1, s[4:7], s51 offen  lds
    s_add_u32 m0, s49, 1024
    s_nop 0
    buffer_load_dwordx4 v2, s[4:7], s51 offen  lds
    s_add_u32 m0, s49, 2048
    s_nop 0
    buffer_load_dwordx4 v3, s[4:7], s51 offen  lds
    s_add_u32 m0, s49, 3072
    s_nop 0
    buffer_load_dwordx4 v4, s[4:7], s51 offen  lds
    s_add_u32 m0, s50, 16384
    s_nop 0
    buffer_load_dwordx4 v5, s[8:11], s52 offen  lds
    s_add_u32 m0, s50, 17408
    s_nop 0
    buffer_load_dwordx4 v6, s[8:11], s52 offen  lds
    s_add_u32 m0, s50, 24576
    s_nop 0
    buffer_load_dwordx4 v5, s[8:11], s53 offen  lds
    s_add_u32 m0, s50, 25600
    s_nop 0
    buffer_load_dwordx4 v6, s[8:11], s53 offen  lds
    s_add_u32 m0, s50, 32768
    s_nop 0
    buffer_load_dwordx4 v5, s[8:11], s54 offen  lds
    s_add_u32 m0, s50, 33792
    s_nop 0
    buffer_load_dwordx4 v6, s[8:11], s54 offen  lds
    s_cmp_lg_u32 s57, 1
    s_cbranch_scc1 recurrent_scan__softmax_full_mha__moe_arch_mod__prompt_kernel_cs_2
    s_call_b64 s[70:71], recurrent_scan__softmax_full_mha__moe_arch_mod__prompt_kernel_colsum
recurrent_scan__softmax_full_mha__moe_arch_mod__prompt_kernel_cs_2:
    s_and_b32 s56, s56, 15
    s_lshl_b32 s51, s56, 7
    s_mul_i32 s52, s56, 393216
    s_add_u32 s53, s52, 2048
    s_add_u32 s54, s52, 4096
    s_add_u32 s56, s56, 1
    s_waitcnt lgkmcnt(0)
    s_waitcnt vmcnt(10)
    s_cmp_lg_u32 s3, 4
    s_cbranch_scc1 recurrent_scan__softmax_full_mha__moe_arch_mod__prompt_kernel_nosig
    s_lshl_b32 s64, s45, 4
    v_mov_b32 v45, s64
    v_mov_b32 v46, 1
    s_mov_b64 exec, 1
    buffer_atomic_add v46, v45, s[20:23], 0 offen sc1
    s_mov_b64 exec, -1
recurrent_scan__softmax_full_mha__moe_arch_mod__prompt_kernel_nosig:
    s_barrier
    s_add_u32 m0, s49, 40960
    s_nop 0
    buffer_load_dwordx4 v1, s[4:7], s51 offen  lds
    s_add_u32 m0, s49, 41984
    s_nop 0
    buffer_load_dwordx4 v2, s[4:7], s51 offen  lds
    s_add_u32 m0, s49, 43008
    s_nop 0
    buffer_load_dwordx4 v3, s[4:7], s51 offen  lds
    s_add_u32 m0, s49, 44032
    s_nop 0
    buffer_load_dwordx4 v4, s[4:7], s51 offen  lds
    s_add_u32 m0, s50, 57344
    s_nop 0
    buffer_load_dwordx4 v5, s[8:11], s52 offen  lds
    s_add_u32 m0, s50, 58368
    s_nop 0
    buffer_load_dwordx4 v6, s[8:11], s52 offen  lds
    s_add_u32 m0, s50, 65536
    s_nop 0
    buffer_load_dwordx4 v5, s[8:11], s53 offen  lds
    s_add_u32 m0, s50, 66560
    s_nop 0
    buffer_load_dwordx4 v6, s[8:11], s53 offen  lds
    s_add_u32 m0, s50, 73728
    s_nop 0
    buffer_load_dwordx4 v5, s[8:11], s54 offen  lds
    s_add_u32 m0, s50, 74752
    s_nop 0
    buffer_load_dwordx4 v6, s[8:11], s54 offen  lds
    s_cmp_lg_u32 s57, 2
    s_cbranch_scc1 recurrent_scan__softmax_full_mha__moe_arch_mod__prompt_kernel_cs_3
    s_call_b64 s[70:71], recurrent_scan__softmax_full_mha__moe_arch_mod__prompt_kernel_colsum
recurrent_scan__softmax_full_mha__moe_arch_mod__prompt_kernel_cs_3:
    s_and_b32 s56, s56, 15
    s_lshl_b32 s51, s56, 7
    s_mul_i32 s52, s56, 393216
    s_add_u32 s53, s52, 2048
    s_add_u32 s54, s52, 4096
    s_add_u32 s56, s56, 1
    s_waitcnt lgkmcnt(0)
    s_waitcnt vmcnt(10)
    s_barrier
    s_add_u32 m0, s49, 81920
    s_nop 0
    buffer_load_dwordx4 v1, s[4:7], s51 offen  lds
    s_add_u32 m0, s49, 82944
    s_nop 0
    buffer_load_dwordx4 v2, s[4:7], s51 offen  lds
    s_add_u32 m0, s49, 83968
    s_nop 0
    buffer_load_dwordx4 v3, s[4:7], s51 offen  lds
    s_add_u32 m0, s49, 84992
    s_nop 0
    buffer_load_dwordx4 v4, s[4:7], s51 offen  lds
    s_add_u32 m0, s50, 98304
    s_nop 0
    buffer_load_dwordx4 v5, s[8:11], s52 offen  lds
    s_add_u32 m0, s50, 99328
    s_nop 0
    buffer_load_dwordx4 v6, s[8:11], s52 offen  lds
    s_add_u32 m0, s50, 106496
    s_nop 0
    buffer_load_dwordx4 v5, s[8:11], s53 offen  lds
    s_add_u32 m0, s50, 107520
    s_nop 0
    buffer_load_dwordx4 v6, s[8:11], s53 offen  lds
    s_add_u32 m0, s50, 114688
    s_nop 0
    buffer_load_dwordx4 v5, s[8:11], s54 offen  lds
    s_add_u32 m0, s50, 115712
    s_nop 0
    buffer_load_dwordx4 v6, s[8:11], s54 offen  lds
    s_cmp_lg_u32 s57, 3
    s_cbranch_scc1 recurrent_scan__softmax_full_mha__moe_arch_mod__prompt_kernel_cs_4
    s_call_b64 s[70:71], recurrent_scan__softmax_full_mha__moe_arch_mod__prompt_kernel_colsum
recurrent_scan__softmax_full_mha__moe_arch_mod__prompt_kernel_cs_4:
    s_and_b32 s56, s56, 15
    s_lshl_b32 s51, s56, 7
    s_mul_i32 s52, s56, 393216
    s_add_u32 s53, s52, 2048
    s_add_u32 s54, s52, 4096
    s_add_u32 s56, s56, 1
    s_waitcnt lgkmcnt(0)
    s_waitcnt vmcnt(10)
    s_barrier
    s_add_u32 m0, s49, 0
    s_nop 0
    buffer_load_dwordx4 v1, s[4:7], s51 offen  lds
    s_add_u32 m0, s49, 1024
    s_nop 0
    buffer_load_dwordx4 v2, s[4:7], s51 offen  lds
    s_add_u32 m0, s49, 2048
    s_nop 0
    buffer_load_dwordx4 v3, s[4:7], s51 offen  lds
    s_add_u32 m0, s49, 3072
    s_nop 0
    buffer_load_dwordx4 v4, s[4:7], s51 offen  lds
    s_add_u32 m0, s50, 16384
    s_nop 0
    buffer_load_dwordx4 v5, s[8:11], s52 offen  lds
    s_add_u32 m0, s50, 17408
    s_nop 0
    buffer_load_dwordx4 v6, s[8:11], s52 offen  lds
    s_add_u32 m0, s50, 24576
    s_nop 0
    buffer_load_dwordx4 v5, s[8:11], s53 offen  lds
    s_add_u32 m0, s50, 25600
    s_nop 0
    buffer_load_dwordx4 v6, s[8:11], s53 offen  lds
    s_add_u32 m0, s50, 32768
    s_nop 0
    buffer_load_dwordx4 v5, s[8:11], s54 offen  lds
    s_add_u32 m0, s50, 33792
    s_nop 0
    buffer_load_dwordx4 v6, s[8:11], s54 offen  lds
    s_and_b32 s56, s56, 15
    s_lshl_b32 s51, s56, 7
    s_mul_i32 s52, s56, 393216
    s_add_u32 s53, s52, 2048
    s_add_u32 s54, s52, 4096
    s_add_u32 s56, s56, 1
    s_waitcnt lgkmcnt(0)
    s_waitcnt vmcnt(10)
    s_barrier
    s_add_u32 m0, s49, 40960
    s_nop 0
    buffer_load_dwordx4 v1, s[4:7], s51 offen  lds
    s_add_u32 m0, s49, 41984
    s_nop 0
    buffer_load_dwordx4 v2, s[4:7], s51 offen  lds
    s_add_u32 m0, s49, 43008
    s_nop 0
    buffer_load_dwordx4 v3, s[4:7], s51 offen  lds
    s_add_u32 m0, s49, 44032
    s_nop 0
    buffer_load_dwordx4 v4, s[4:7], s51 offen  lds
    s_add_u32 m0, s50, 57344
    s_nop 0
    buffer_load_dwordx4 v5, s[8:11], s52 offen  lds
    s_add_u32 m0, s50, 58368
    s_nop 0
    buffer_load_dwordx4 v6, s[8:11], s52 offen  lds
    s_add_u32 m0, s50, 65536
    s_nop 0
    buffer_load_dwordx4 v5, s[8:11], s53 offen  lds
    s_add_u32 m0, s50, 66560
    s_nop 0
    buffer_load_dwordx4 v6, s[8:11], s53 offen  lds
    s_add_u32 m0, s50, 73728
    s_nop 0
    buffer_load_dwordx4 v5, s[8:11], s54 offen  lds
    s_add_u32 m0, s50, 74752
    s_nop 0
    buffer_load_dwordx4 v6, s[8:11], s54 offen  lds
    s_and_b32 s56, s56, 15
    s_lshl_b32 s51, s56, 7
    s_mul_i32 s52, s56, 393216
    s_add_u32 s53, s52, 2048
    s_add_u32 s54, s52, 4096
    s_add_u32 s56, s56, 1
    s_waitcnt lgkmcnt(0)
    s_waitcnt vmcnt(10)
    s_barrier
    s_add_u32 m0, s49, 81920
    s_nop 0
    buffer_load_dwordx4 v1, s[4:7], s51 offen  lds
    s_add_u32 m0, s49, 82944
    s_nop 0
    buffer_load_dwordx4 v2, s[4:7], s51 offen  lds
    s_add_u32 m0, s49, 83968
    s_nop 0
    buffer_load_dwordx4 v3, s[4:7], s51 offen  lds
    s_add_u32 m0, s49, 84992
    s_nop 0
    buffer_load_dwordx4 v4, s[4:7], s51 offen  lds
    s_add_u32 m0, s50, 98304
    s_nop 0
    buffer_load_dwordx4 v5, s[8:11], s52 offen  lds
    s_add_u32 m0, s50, 99328
    s_nop 0
    buffer_load_dwordx4 v6, s[8:11], s52 offen  lds
    s_add_u32 m0, s50, 106496
    s_nop 0
    buffer_load_dwordx4 v5, s[8:11], s53 offen  lds
    s_add_u32 m0, s50, 107520
    s_nop 0
    buffer_load_dwordx4 v6, s[8:11], s53 offen  lds
    s_add_u32 m0, s50, 114688
    s_nop 0
    buffer_load_dwordx4 v5, s[8:11], s54 offen  lds
    s_add_u32 m0, s50, 115712
    s_nop 0
    buffer_load_dwordx4 v6, s[8:11], s54 offen  lds
    s_and_b32 s56, s56, 15
    s_lshl_b32 s51, s56, 7
    s_mul_i32 s52, s56, 393216
    s_add_u32 s53, s52, 2048
    s_add_u32 s54, s52, 4096
    s_add_u32 s56, s56, 1
    s_waitcnt lgkmcnt(0)
    s_waitcnt vmcnt(10)
    s_barrier
    s_add_u32 m0, s49, 0
    s_nop 0
    buffer_load_dwordx4 v1, s[4:7], s51 offen  lds
    s_add_u32 m0, s49, 1024
    s_nop 0
    buffer_load_dwordx4 v2, s[4:7], s51 offen  lds
    s_add_u32 m0, s49, 2048
    s_nop 0
    buffer_load_dwordx4 v3, s[4:7], s51 offen  lds
    s_add_u32 m0, s49, 3072
    s_nop 0
    buffer_load_dwordx4 v4, s[4:7], s51 offen  lds
    s_add_u32 m0, s50, 16384
    s_nop 0
    buffer_load_dwordx4 v5, s[8:11], s52 offen  lds
    s_add_u32 m0, s50, 17408
    s_nop 0
    buffer_load_dwordx4 v6, s[8:11], s52 offen  lds
    s_add_u32 m0, s50, 24576
    s_nop 0
    buffer_load_dwordx4 v5, s[8:11], s53 offen  lds
    s_add_u32 m0, s50, 25600
    s_nop 0
    buffer_load_dwordx4 v6, s[8:11], s53 offen  lds
    s_add_u32 m0, s50, 32768
    s_nop 0
    buffer_load_dwordx4 v5, s[8:11], s54 offen  lds
    s_add_u32 m0, s50, 33792
    s_nop 0
    buffer_load_dwordx4 v6, s[8:11], s54 offen  lds
    s_and_b32 s56, s56, 15
    s_lshl_b32 s51, s56, 7
    s_mul_i32 s52, s56, 393216
    s_add_u32 s53, s52, 2048
    s_add_u32 s54, s52, 4096
    s_add_u32 s56, s56, 1
    s_waitcnt lgkmcnt(0)
    s_waitcnt vmcnt(10)
    s_barrier
    v_and_b32 v45, 15, v0
    v_lshlrev_b32 v45, 4, v45
    buffer_load_dword v46, v45, s[20:23], 0 offen sc1
    s_add_u32 m0, s49, 40960
    s_nop 0
    buffer_load_dwordx4 v1, s[4:7], s51 offen  lds
    s_add_u32 m0, s49, 41984
    s_nop 0
    buffer_load_dwordx4 v2, s[4:7], s51 offen  lds
    s_add_u32 m0, s49, 43008
    s_nop 0
    buffer_load_dwordx4 v3, s[4:7], s51 offen  lds
    s_add_u32 m0, s49, 44032
    s_nop 0
    buffer_load_dwordx4 v4, s[4:7], s51 offen  lds
    s_add_u32 m0, s50, 57344
    s_nop 0
    buffer_load_dwordx4 v5, s[8:11], s52 offen  lds
    s_add_u32 m0, s50, 58368
    s_nop 0
    buffer_load_dwordx4 v6, s[8:11], s52 offen  lds
    s_add_u32 m0, s50, 65536
    s_nop 0
    buffer_load_dwordx4 v5, s[8:11], s53 offen  lds
    s_add_u32 m0, s50, 66560
    s_nop 0
    buffer_load_dwordx4 v6, s[8:11], s53 offen  lds
    s_add_u32 m0, s50, 73728
    s_nop 0
    buffer_load_dwordx4 v5, s[8:11], s54 offen  lds
    s_add_u32 m0, s50, 74752
    s_nop 0
    buffer_load_dwordx4 v6, s[8:11], s54 offen  lds
    s_and_b32 s56, s56, 15
    s_lshl_b32 s51, s56, 7
    s_mul_i32 s52, s56, 393216
    s_add_u32 s53, s52, 2048
    s_add_u32 s54, s52, 4096
    s_add_u32 s56, s56, 1
    s_waitcnt lgkmcnt(0)
    s_waitcnt vmcnt(10)
    s_barrier
    v_cmp_gt_u32 vcc, 16, v46
    s_cmp_lg_u64 vcc, 0
    s_cbranch_scc1 recurrent_scan__softmax_full_mha__moe_arch_mod__prompt_kernel_p1_5_spin
recurrent_scan__softmax_full_mha__moe_arch_mod__prompt_kernel_p1_5_ok:
    s_lshl_b32 s64, s48, 11
    s_add_u32 s64, s64, 20971520
    buffer_load_dwordx4 v[28:31], v94, s[12:15], s64 offen sc1
    buffer_load_dwordx4 v[32:35], v94, s[12:15], s64 offen offset:1024 sc1
    s_lshl_b32 s64, s45, 11
    s_and_b32 s65, s48, 1
    s_lshl_b32 s65, s65, 10
    s_add_u32 s64, s64, s65
    s_add_u32 s64, s64, 21299200
    v_lshrrev_b32 v47, 3, v0
    v_lshlrev_b32 v47, 7, v47
    v_and_b32 v48, 7, v0
    v_lshl_add_u32 v47, v48, 2, v47
    buffer_load_dword v54, v47, s[12:15], s64 offen sc1
    buffer_load_dword v55, v47, s[12:15], s64 offen offset:32 sc1
    s_cmp_lg_u32 s3, 4
    s_cbranch_scc1 recurrent_scan__softmax_full_mha__moe_arch_mod__prompt_kernel_cf_6
    s_lshl_b32 s64, s44, 7
    s_add_u32 s64, s64, 21954560
    v_mov_b32 v52, s64
    v_mov_b32 v53, 1
    s_mov_b64 exec, 1
    buffer_atomic_add v53, v52, s[12:15], 0 offen sc1
    s_mov_b64 exec, -1
recurrent_scan__softmax_full_mha__moe_arch_mod__prompt_kernel_cf_6:
    s_add_u32 m0, s49, 81920
    s_nop 0
    buffer_load_dwordx4 v1, s[4:7], s51 offen  lds
    s_add_u32 m0, s49, 82944
    s_nop 0
    buffer_load_dwordx4 v2, s[4:7], s51 offen  lds
    s_add_u32 m0, s49, 83968
    s_nop 0
    buffer_load_dwordx4 v3, s[4:7], s51 offen  lds
    s_add_u32 m0, s49, 84992
    s_nop 0
    buffer_load_dwordx4 v4, s[4:7], s51 offen  lds
    s_add_u32 m0, s50, 98304
    s_nop 0
    buffer_load_dwordx4 v5, s[8:11], s52 offen  lds
    s_add_u32 m0, s50, 99328
    s_nop 0
    buffer_load_dwordx4 v6, s[8:11], s52 offen  lds
    s_add_u32 m0, s50, 106496
    s_nop 0
    buffer_load_dwordx4 v5, s[8:11], s53 offen  lds
    s_add_u32 m0, s50, 107520
    s_nop 0
    buffer_load_dwordx4 v6, s[8:11], s53 offen  lds
    s_add_u32 m0, s50, 114688
    s_nop 0
    buffer_load_dwordx4 v5, s[8:11], s54 offen  lds
    s_add_u32 m0, s50, 115712
    s_nop 0
    buffer_load_dwordx4 v6, s[8:11], s54 offen  lds
    s_and_b32 s56, s56, 15
    s_lshl_b32 s51, s56, 7
    s_mul_i32 s52, s56, 393216
    s_add_u32 s53, s52, 2048
    s_add_u32 s54, s52, 4096
    s_add_u32 s56, s56, 1
    s_waitcnt lgkmcnt(0)
    s_waitcnt vmcnt(10)
    s_barrier
    s_add_u32 m0, s49, 0
    s_nop 0
    buffer_load_dwordx4 v1, s[4:7], s51 offen  lds
    s_lshl_b32 s64, s48, 9
    v_lshlrev_b32 v47, 2, v0
    v_add_u32 v47, s64, v47
    v_ashrrev_i32 v36, 31, v28
    v_or_b32 v36, 0x80000000, v36
    v_xor_b32 v28, v36, v28
    v_and_b32 v28, 0xffff0000, v28
    v_sub_u32 v36, 2047, v47
    s_add_u32 m0, s49, 1024
    s_nop 0
    buffer_load_dwordx4 v2, s[4:7], s51 offen  lds
    v_or_b32 v28, v28, v36
    v_ashrrev_i32 v36, 31, v29
    v_or_b32 v36, 0x80000000, v36
    v_xor_b32 v29, v36, v29
    v_and_b32 v29, 0xffff0000, v29
    v_sub_u32 v36, 2046, v47
    v_or_b32 v29, v29, v36
    v_ashrrev_i32 v36, 31, v30
    s_add_u32 m0, s49, 2048
    s_nop 0
    buffer_load_dwordx4 v3, s[4:7], s51 offen  lds
    v_or_b32 v36, 0x80000000, v36
    v_xor_b32 v30, v36, v30
    v_and_b32 v30, 0xffff0000, v30
    v_sub_u32 v36, 2045, v47
    v_or_b32 v30, v30, v36
    v_ashrrev_i32 v36, 31, v31
    v_or_b32 v36, 0x80000000, v36
    v_xor_b32 v31, v36, v31
    s_add_u32 m0, s49, 3072
    s_nop 0
    buffer_load_dwordx4 v4, s[4:7], s51 offen  lds
    v_and_b32 v31, 0xffff0000, v31
    v_sub_u32 v36, 2044, v47
    v_or_b32 v31, v31, v36
    v_ashrrev_i32 v36, 31, v32
    v_or_b32 v36, 0x80000000, v36
    v_xor_b32 v32, v36, v32
    v_and_b32 v32, 0xffff0000, v32
    v_sub_u32 v36, 1791, v47
    v_or_b32 v32, v32, v36
    s_add_u32 m0, s50, 16384
    s_nop 0
    buffer_load_dwordx4 v5, s[8:11], s52 offen  lds
    v_ashrrev_i32 v36, 31, v33
    v_or_b32 v36, 0x80000000, v36
    v_xor_b32 v33, v36, v33
    v_and_b32 v33, 0xffff0000, v33
    v_sub_u32 v36, 1790, v47
    v_or_b32 v33, v33, v36
    v_ashrrev_i32 v36, 31, v34
    v_or_b32 v36, 0x80000000, v36
    s_add_u32 m0, s50, 17408
    s_nop 0
    buffer_load_dwordx4 v6, s[8:11], s52 offen  lds
    v_xor_b32 v34, v36, v34
    v_and_b32 v34, 0xffff0000, v34
    v_sub_u32 v36, 1789, v47
    v_or_b32 v34, v34, v36
    v_ashrrev_i32 v36, 31, v35
    v_or_b32 v36, 0x80000000, v36
    v_xor_b32 v35, v36, v35
    v_and_b32 v35, 0xffff0000, v35
    s_add_u32 m0, s50, 24576
    s_nop 0
    buffer_load_dwordx4 v5, s[8:11], s53 offen  lds
    v_sub_u32 v36, 1788, v47
    v_or_b32 v35, v35, v36
    v_mov_b32 v44, 0
    s_mov_b32 s72, -1
    v_sub_u32 v36, s72, v28
    v_sub_u32 v37, s72, v29
    v_sub_u32 v38, s72, v30
    v_sub_u32 v39, s72, v31
    v_sub_u32 v40, s72, v32
    s_add_u32 m0, s50, 25600
    s_nop 0
    buffer_load_dwordx4 v6, s[8:11], s53 offen  lds
    v_sub_u32 v41, s72, v33
    v_sub_u32 v42, s72, v34
    v_sub_u32 v43, s72, v35
    v_min3_u32 v36, v36, v37, v38
    v_min3_u32 v36, v36, v39, v40
    v_min3_u32 v36, v36, v41, v42
    v_min_u32 v36, v36, v43
    s_nop 1
    s_add_u32 m0, s50, 32768
    s_nop 0
    buffer_load_dwordx4 v5, s[8:11], s54 offen  lds
    v_min_u32_dpp v36, v36, v36 row_shr:1 row_mask:0xf bank_mask:0xf
    s_nop 1
    v_min_u32_dpp v36, v36, v36 row_shr:2 row_mask:0xf bank_mask:0xf
    s_nop 1
    v_min_u32_dpp v36, v36, v36 row_shr:4 row_mask:0xf bank_mask:0xf
    s_nop 1
    v_min_u32_dpp v36, v36, v36 row_shr:8 row_mask:0xf bank_mask:0xf
    s_nop 1
    s_add_u32 m0, s50, 33792
    s_nop 0
    buffer_load_dwordx4 v6, s[8:11], s54 offen  lds
    v_min_u32_dpp v36, v36, v36 row_bcast:15 row_mask:0xa bank_mask:0xf
    s_nop 1
    v_min_u32_dpp v36, v36, v36 row_bcast:31 row_mask:0xc bank_mask:0xf
    s_nop 0
    v_readlane_b32 s73, v36, 63
    s_nop 1
    s_sub_u32 s72, s72, s73
    v_writelane_b32 v44, s72, 0
    s_sub_u32 s72, s72, 1
    s_and_b32 s56, s56, 15
    s_lshl_b32 s51, s56, 7
    s_mul_i32 s52, s56, 393216
    s_add_u32 s53, s52, 2048
    s_add_u32 s54, s52, 4096
    s_add_u32 s56, s56, 1
    s_waitcnt lgkmcnt(0)
    s_waitcnt vmcnt(10)
    s_barrier
    s_lshl_b32 s64, s44, 7
    s_add_u32 s64, s64, 21954560
    v_mov_b32 v52, s64
    v_mov_b32 v53, 0
    s_mov_b64 exec, 1
    buffer_atomic_or v53, v52, s[12:15], 0 offen sc0 sc1
    s_mov_b64 exec, -1
    s_add_u32 m0, s49, 40960
    s_nop 0
    buffer_load_dwordx4 v1, s[4:7], s51 offen  lds
    v_and_b32 v51, 15, v0
    v_cmp_gt_u32 vcc, 12, v51
    v_lshlrev_b32 v51, 4, v51
    v_lshrrev_b32 v50, 4, v0
    v_mul_u32_u24 v50, 4*768, v50
    v_add_u32 v51, v51, v50
    s_add_u32 m0, s49, 41984
    s_nop 0
    buffer_load_dwordx4 v2, s[4:7], s51 offen  lds
    v_mov_b32 v50, 0x7fff0000
    v_cndmask_b32 v51, v50, v51, vcc
    v_sub_u32 v36, s72, v28
    v_sub_u32 v37, s72, v29
    v_sub_u32 v38, s72, v30
    v_sub_u32 v39, s72, v31
    v_sub_u32 v40, s72, v32
    s_add_u32 m0, s49, 43008
    s_nop 0
    buffer_load_dwordx4 v3, s[4:7], s51 offen  lds
    v_sub_u32 v41, s72, v33
    v_sub_u32 v42, s72, v34
    v_sub_u32 v43, s72, v35
    v_min3_u32 v36, v36, v37, v38
    v_min3_u32 v36, v36, v39, v40
    v_min3_u32 v36, v36, v41, v42
    v_min_u32 v36, v36, v43
    s_add_u32 m0, s49, 44032
    s_nop 0
    buffer_load_dwordx4 v4, s[4:7], s51 offen  lds
    s_nop 1
    v_min_u32_dpp v36, v36, v36 row_shr:1 row_mask:0xf bank_mask:0xf
    s_nop 1
    v_min_u32_dpp v36, v36, v36 row_shr:2 row_mask:0xf bank_mask:0xf
    s_nop 1
    v_min_u32_dpp v36, v36, v36 row_shr:4 row_mask:0xf bank_mask:0xf
    s_nop 1
    s_add_u32 m0, s50, 57344
    s_nop 0
    buffer_load_dwordx4 v5, s[8:11], s52 offen  lds
    v_min_u32_dpp v36, v36, v36 row_shr:8 row_mask:0xf bank_mask:0xf
    s_nop 1
    v_min_u32_dpp v36, v36, v36 row_bcast:15 row_mask:0xa bank_mask:0xf
    s_nop 1
    v_min_u32_dpp v36, v36, v36 row_bcast:31 row_mask:0xc bank_mask:0xf
    s_nop 0
    v_readlane_b32 s73, v36, 63
    s_add_u32 m0, s50, 58368
    s_nop 0
    buffer_load_dwordx4 v6, s[8:11], s52 offen  lds
    s_nop 1
    s_sub_u32 s72, s72, s73
    v_writelane_b32 v44, s72, 1
    s_sub_u32 s72, s72, 1
    v_sub_u32 v36, s72, v28
    v_sub_u32 v37, s72, v29
    s_add_u32 m0, s50, 65536
    s_nop 0
    buffer_load_dwordx4 v5, s[8:11], s53 offen  lds
    v_sub_u32 v38, s72, v30
    v_sub_u32 v39, s72, v31
    v_sub_u32 v40, s72, v32
    v_sub_u32 v41, s72, v33
    v_sub_u32 v42, s72, v34
    v_sub_u32 v43, s72, v35
    v_min3_u32 v36, v36, v37, v38
    s_add_u32 m0, s50, 66560
    s_nop 0
    buffer_load_dwordx4 v6, s[8:11], s53 offen  lds
    v_min3_u32 v36, v36, v39, v40
    v_min3_u32 v36, v36, v41, v42
    v_min_u32 v36, v36, v43
    s_nop 1
    v_min_u32_dpp v36, v36, v36 row_shr:1 row_mask:0xf bank_mask:0xf
    s_nop 1
    v_min_u32_dpp v36, v36, v36 row_shr:2 row_mask:0xf bank_mask:0xf
    s_add_u32 m0, s50, 73728
    s_nop 0
    buffer_load_dwordx4 v5, s[8:11], s54 offen  lds
    s_nop 1
    v_min_u32_dpp v36, v36, v36 row_shr:4 row_mask:0xf bank_mask:0xf
    s_nop 1
    v_min_u32_dpp v36, v36, v36 row_shr:8 row_mask:0xf bank_mask:0xf
    s_nop 1
    v_min_u32_dpp v36, v36, v36 row_bcast:15 row_mask:0xa bank_mask:0xf
    s_nop 1
    s_add_u32 m0, s50, 74752
    s_nop 0
    buffer_load_dwordx4 v6, s[8:11], s54 offen  lds
    v_min_u32_dpp v36, v36, v36 row_bcast:31 row_mask:0xc bank_mask:0xf
    s_nop 0
    v_readlane_b32 s73, v36, 63
    s_nop 1
    s_sub_u32 s72, s72, s73
    v_writelane_b32 v44, s72, 2
    s_sub_u32 s72, s72, 1
    s_and_b32 s56, s56, 15
    s_lshl_b32 s51, s56, 7
    s_mul_i32 s52, s56, 393216
    s_add_u32 s53, s52, 2048
    s_add_u32 s54, s52, 4096
    s_add_u32 s56, s56, 1
    s_waitcnt lgkmcnt(0)
    s_waitcnt vmcnt(10)
    s_barrier
    v_cmp_gt_u32 vcc, 16, v53
    s_and_b32 vcc_lo, vcc_lo, 1
    s_cbranch_scc1 recurrent_scan__softmax_full_mha__moe_arch_mod__prompt_kernel_p2_7_spin
recurrent_scan__softmax_full_mha__moe_arch_mod__prompt_kernel_p2_7_ok:
    s_add_u32 m0, s49, 81920
    s_nop 0
    buffer_load_dwordx4 v1, s[4:7], s51 offen  lds
    s_mul_i32 s66, s44, 12288
    s_mul_i32 s67, s48, 192
    s_add_u32 s66, s66, s67
    s_add_u32 s66, s66, 21561344
    buffer_load_dwordx4 v[60:63], v51, s[12:15], s66 offen offset:0 sc1
    s_mul_i32 s66, s44, 12288
    s_mul_i32 s67, s48, 192
    s_add_u32 s66, s66, s67
    s_add_u32 s66, s66, 21561344
    buffer_load_dwordx4 v[64:67], v51, s[12:15], s66 offen offset:768 sc1
    v_sub_u32 v36, s72, v28
    v_sub_u32 v37, s72, v29
    v_sub_u32 v38, s72, v30
    v_sub_u32 v39, s72, v31
    s_add_u32 m0, s49, 82944
    s_nop 0
    buffer_load_dwordx4 v2, s[4:7], s51 offen  lds
    v_sub_u32 v40, s72, v32
    v_sub_u32 v41, s72, v33
    v_sub_u32 v42, s72, v34
    v_sub_u32 v43, s72, v35
    v_min3_u32 v36, v36, v37, v38
    v_min3_u32 v36, v36, v39, v40
    s_add_u32 m0, s49, 83968
    s_nop 0
    buffer_load_dwordx4 v3, s[4:7], s51 offen  lds
    v_min3_u32 v36, v36, v41, v42
    v_min_u32 v36, v36, v43
    s_nop 1
    v_min_u32_dpp v36, v36, v36 row_shr:1 row_mask:0xf bank_mask:0xf
    s_nop 1
    v_min_u32_dpp v36, v36, v36 row_shr:2 row_mask:0xf bank_mask:0xf
    s_add_u32 m0, s49, 84992
    s_nop 0
    buffer_load_dwordx4 v4, s[4:7], s51 offen  lds
    s_nop 1
    v_min_u32_dpp v36, v36, v36 row_shr:4 row_mask:0xf bank_mask:0xf
    s_nop 1
    v_min_u32_dpp v36, v36, v36 row_shr:8 row_mask:0xf bank_mask:0xf
    s_nop 1
    v_min_u32_dpp v36, v36, v36 row_bcast:15 row_mask:0xa bank_mask:0xf
    s_add_u32 m0, s50, 98304
    s_nop 0
    buffer_load_dwordx4 v5, s[8:11], s52 offen  lds
    s_nop 1
    v_min_u32_dpp v36, v36, v36 row_bcast:31 row_mask:0xc bank_mask:0xf
    s_nop 0
    v_readlane_b32 s73, v36, 63
    s_nop 1
    s_sub_u32 s72, s72, s73
    v_writelane_b32 v44, s72, 3
    s_add_u32 m0, s50, 99328
    s_nop 0
    buffer_load_dwordx4 v6, s[8:11], s52 offen  lds
    s_sub_u32 s72, s72, 1
    v_sub_u32 v36, s72, v28
    v_sub_u32 v37, s72, v29
    v_sub_u32 v38, s72, v30
    v_sub_u32 v39, s72, v31
    v_sub_u32 v40, s72, v32
    s_add_u32 m0, s50, 106496
    s_nop 0
    buffer_load_dwordx4 v5, s[8:11], s53 offen  lds
    v_sub_u32 v41, s72, v33
    v_sub_u32 v42, s72, v34
    v_sub_u32 v43, s72, v35
    v_min3_u32 v36, v36, v37, v38
    v_min3_u32 v36, v36, v39, v40
    v_min3_u32 v36, v36, v41, v42
    s_add_u32 m0, s50, 107520
    s_nop 0
    buffer_load_dwordx4 v6, s[8:11], s53 offen  lds
    v_min_u32 v36, v36, v43
    s_nop 1
    v_min_u32_dpp v36, v36, v36 row_shr:1 row_mask:0xf bank_mask:0xf
    s_nop 1
    v_min_u32_dpp v36, v36, v36 row_shr:2 row_mask:0xf bank_mask:0xf
    s_nop 1
    s_add_u32 m0, s50, 114688
    s_nop 0
    buffer_load_dwordx4 v5, s[8:11], s54 offen  lds
    v_min_u32_dpp v36, v36, v36 row_shr:4 row_mask:0xf bank_mask:0xf
    s_nop 1
    v_min_u32_dpp v36, v36, v36 row_shr:8 row_mask:0xf bank_mask:0xf
    s_nop 1
    v_min_u32_dpp v36, v36, v36 row_bcast:15 row_mask:0xa bank_mask:0xf
    s_nop 1
    s_add_u32 m0, s50, 115712
    s_nop 0
    buffer_load_dwordx4 v6, s[8:11], s54 offen  lds
    v_min_u32_dpp v36, v36, v36 row_bcast:31 row_mask:0xc bank_mask:0xf
    s_nop 0
    v_readlane_b32 s73, v36, 63
    s_nop 1
    s_sub_u32 s72, s72, s73
    v_writelane_b32 v44, s72, 4
    s_sub_u32 s72, s72, 1
    s_and_b32 s56, s56, 15
    s_lshl_b32 s51, s56, 7
    s_mul_i32 s52, s56, 393216
    s_add_u32 s53, s52, 2048
    s_add_u32 s54, s52, 4096
    s_add_u32 s56, s56, 1
    s_waitcnt lgkmcnt(0)
    s_waitcnt vmcnt(12)
    s_barrier
    s_add_u32 m0, s49, 0
    s_nop 0
    buffer_load_dwordx4 v1, s[4:7], s51 offen  lds
    s_mul_i32 s66, s44, 12288
    s_mul_i32 s67, s48, 192
    s_add_u32 s66, s66, s67
    s_add_u32 s66, s66, 21561344
    buffer_load_dwordx4 v[68:71], v51, s[12:15], s66 offen offset:1536 sc1
    s_mul_i32 s66, s44, 12288
    s_mul_i32 s67, s48, 192
    s_add_u32 s66, s66, s67
    s_add_u32 s66, s66, 21561344
    buffer_load_dwordx4 v[72:75], v51, s[12:15], s66 offen offset:2304 sc1
    v_sub_u32 v36, s72, v28
    v_sub_u32 v37, s72, v29
    v_sub_u32 v38, s72, v30
    v_sub_u32 v39, s72, v31
    s_add_u32 m0, s49, 1024
    s_nop 0
    buffer_load_dwordx4 v2, s[4:7], s51 offen  lds
    v_sub_u32 v40, s72, v32
    v_sub_u32 v41, s72, v33
    v_sub_u32 v42, s72, v34
    v_sub_u32 v43, s72, v35
    v_min3_u32 v36, v36, v37, v38
    v_min3_u32 v36, v36, v39, v40
    s_add_u32 m0, s49, 2048
    s_nop 0
    buffer_load_dwordx4 v3, s[4:7], s51 offen  lds
    v_min3_u32 v36, v36, v41, v42
    v_min_u32 v36, v36, v43
    s_nop 1
    v_min_u32_dpp v36, v36, v36 row_shr:1 row_mask:0xf bank_mask:0xf
    s_nop 1
    v_min_u32_dpp v36, v36, v36 row_shr:2 row_mask:0xf bank_mask:0xf
    s_add_u32 m0, s49, 3072
    s_nop 0
    buffer_load_dwordx4 v4, s[4:7], s51 offen  lds
    s_nop 1
    v_min_u32_dpp v36, v36, v36 row_shr:4 row_mask:0xf bank_mask:0xf
    s_nop 1
    v_min_u32_dpp v36, v36, v36 row_shr:8 row_mask:0xf bank_mask:0xf
    s_nop 1
    v_min_u32_dpp v36, v36, v36 row_bcast:15 row_mask:0xa bank_mask:0xf
    s_add_u32 m0, s50, 16384
    s_nop 0
    buffer_load_dwordx4 v5, s[8:11], s52 offen  lds
    s_nop 1
    v_min_u32_dpp v36, v36, v36 row_bcast:31 row_mask:0xc bank_mask:0xf
    s_nop 0
    v_readlane_b32 s73, v36, 63
    s_nop 1
    s_sub_u32 s72, s72, s73
    v_writelane_b32 v44, s72, 5
    s_add_u32 m0, s50, 17408
    s_nop 0
    buffer_load_dwordx4 v6, s[8:11], s52 offen  lds
    s_sub_u32 s72, s72, 1
    v_sub_u32 v36, s72, v28
    v_sub_u32 v37, s72, v29
    v_sub_u32 v38, s72, v30
    v_sub_u32 v39, s72, v31
    v_sub_u32 v40, s72, v32
    s_add_u32 m0, s50, 24576
    s_nop 0
    buffer_load_dwordx4 v5, s[8:11], s53 offen  lds
    v_sub_u32 v41, s72, v33
    v_sub_u32 v42, s72, v34
    v_sub_u32 v43, s72, v35
    v_min3_u32 v36, v36, v37, v38
    v_min3_u32 v36, v36, v39, v40
    v_min3_u32 v36, v36, v41, v42
    s_add_u32 m0, s50, 25600
    s_nop 0
    buffer_load_dwordx4 v6, s[8:11], s53 offen  lds
    v_min_u32 v36, v36, v43
    s_nop 1
    v_min_u32_dpp v36, v36, v36 row_shr:1 row_mask:0xf bank_mask:0xf
    s_nop 1
    v_min_u32_dpp v36, v36, v36 row_shr:2 row_mask:0xf bank_mask:0xf
    s_nop 1
    s_add_u32 m0, s50, 32768
    s_nop 0
    buffer_load_dwordx4 v5, s[8:11], s54 offen  lds
    v_min_u32_dpp v36, v36, v36 row_shr:4 row_mask:0xf bank_mask:0xf
    s_nop 1
    v_min_u32_dpp v36, v36, v36 row_shr:8 row_mask:0xf bank_mask:0xf
    s_nop 1
    v_min_u32_dpp v36, v36, v36 row_bcast:15 row_mask:0xa bank_mask:0xf
    s_nop 1
    s_add_u32 m0, s50, 33792
    s_nop 0
    buffer_load_dwordx4 v6, s[8:11], s54 offen  lds
    v_min_u32_dpp v36, v36, v36 row_bcast:31 row_mask:0xc bank_mask:0xf
    s_nop 0
    v_readlane_b32 s73, v36, 63
    s_nop 1
    s_sub_u32 s72, s72, s73
    v_writelane_b32 v44, s72, 6
    s_sub_u32 s72, s72, 1
    s_waitcnt lgkmcnt(0)
    s_waitcnt vmcnt(12)
    s_barrier
    v_sub_u32 v36, s72, v28
    v_sub_u32 v37, s72, v29
    v_sub_u32 v38, s72, v30
    v_sub_u32 v39, s72, v31
    v_sub_u32 v40, s72, v32
    v_sub_u32 v41, s72, v33
    v_sub_u32 v42, s72, v34
    v_sub_u32 v43, s72, v35
    v_min3_u32 v36, v36, v37, v38
    v_min3_u32 v36, v36, v39, v40
    v_min3_u32 v36, v36, v41, v42
    v_min_u32 v36, v36, v43
    s_nop 1
    v_min_u32_dpp v36, v36, v36 row_shr:1 row_mask:0xf bank_mask:0xf
    s_nop 1
    v_min_u32_dpp v36, v36, v36 row_shr:2 row_mask:0xf bank_mask:0xf
    s_nop 1
    v_min_u32_dpp v36, v36, v36 row_shr:4 row_mask:0xf bank_mask:0xf
    s_nop 1
    v_min_u32_dpp v36, v36, v36 row_shr:8 row_mask:0xf bank_mask:0xf
    s_nop 1
    v_min_u32_dpp v36, v36, v36 row_bcast:15 row_mask:0xa bank_mask:0xf
    s_nop 1
    v_min_u32_dpp v36, v36, v36 row_bcast:31 row_mask:0xc bank_mask:0xf
    s_nop 0
    v_readlane_b32 s73, v36, 63
    s_nop 1
    s_sub_u32 s72, s72, s73
    v_writelane_b32 v44, s72, 7
    s_sub_u32 s72, s72, 1
    s_waitcnt lgkmcnt(0)
    s_waitcnt vmcnt(0)
    s_lshl_b32 s64, s48, 5
    s_add_u32 s64, s64, 161536
    v_lshlrev_b32 v47, 2, v0
    v_add_u32 v47, s64, v47
    s_mov_b64 exec, 0xff
    ds_write_b32 v47, v44
    s_mov_b64 exec, -1
    s_waitcnt lgkmcnt(0)
    s_barrier
    s_and_b32 s64, s48, 1
    s_lshl_b32 s64, s64, 8
    s_add_u32 s64, s64, 159744
    v_lshlrev_b32 v47, 2, v0
    v_add_u32 v47, s64, v47
    ds_write_b32 v47, v54
    ds_write_b32 v47, v55 offset:512
    v_and_b32 v46, 31, v0
    v_lshlrev_b32 v46, 2, v46
    v_add_u32 v46, 161536, v46
    ds_read_b32 v28, v46
    v_add_f32 v60, v60, v64
    v_add_f32 v61, v61, v65
    v_add_f32 v62, v62, v66
    v_add_f32 v63, v63, v67
    v_add_f32 v60, v60, v68
    v_add_f32 v61, v61, v69
    v_add_f32 v62, v62, v70
    v_add_f32 v63, v63, v71
    v_add_f32 v60, v60, v72
    v_add_f32 v61, v61, v73
    v_add_f32 v62, v62, v74
    v_add_f32 v63, v63, v75
    s_nop 1
    v_permlane32_swap_b32 v60, v62
    v_permlane32_swap_b32 v61, v63
    v_add_f32 v60, v60, v62
    v_add_f32 v61, v61, v63
    s_nop 1
    v_permlane16_swap_b32 v60, v61
    v_add_f32 v60, v60, v61
    v_and_b32 v47, 15, v0
    v_cmp_gt_u32 vcc, 12, v47
    v_lshlrev_b32 v47, 4, v47
    v_lshrrev_b32 v50, 4, v0
    v_lshl_add_u32 v47, v50, 2, v47
    s_mul_i32 s64, s48, 192
    s_add_u32 s64, s64, 160768
    v_add_u32 v47, s64, v47
    s_and_saveexec_b64 s[66:67], vcc
    ds_write_b32 v47, v60
    s_mov_b64 exec, -1
    s_waitcnt lgkmcnt(0)
    s_barrier
    v_cmp_gt_u32 vcc, 32, v0
    s_nop 1
    v_cndmask_b32 v28, 0, v28, vcc
    s_mov_b32 s72, -1
    v_sub_u32 v36, s72, v28
    s_nop 1
    v_min_u32_dpp v36, v36, v36 row_shr:1 row_mask:0xf bank_mask:0xf
    s_nop 1
    v_min_u32_dpp v36, v36, v36 row_shr:2 row_mask:0xf bank_mask:0xf
    s_nop 1
    v_min_u32_dpp v36, v36, v36 row_shr:4 row_mask:0xf bank_mask:0xf
    s_nop 1
    v_min_u32_dpp v36, v36, v36 row_shr:8 row_mask:0xf bank_mask:0xf
    s_nop 1
    v_min_u32_dpp v36, v36, v36 row_bcast:15 row_mask:0xa bank_mask:0xf
    s_nop 1
    v_min_u32_dpp v36, v36, v36 row_bcast:31 row_mask:0xc bank_mask:0xf
    s_nop 0
    v_readlane_b32 s73, v36, 63
    s_nop 1
    s_sub_u32 s72, s72, s73
    v_writelane_b32 v44, s72, 0
    s_sub_u32 s72, s72, 1
    v_sub_u32 v36, s72, v28
    s_nop 1
    v_min_u32_dpp v36, v36, v36 row_shr:1 row_mask:0xf bank_mask:0xf
    s_nop 1
    v_min_u32_dpp v36, v36, v36 row_shr:2 row_mask:0xf bank_mask:0xf
    s_nop 1
    v_min_u32_dpp v36, v36, v36 row_shr:4 row_mask:0xf bank_mask:0xf
    s_nop 1
    v_min_u32_dpp v36, v36, v36 row_shr:8 row_mask:0xf bank_mask:0xf
    s_nop 1
    v_min_u32_dpp v36, v36, v36 row_bcast:15 row_mask:0xa bank_mask:0xf
    s_nop 1
    v_min_u32_dpp v36, v36, v36 row_bcast:31 row_mask:0xc bank_mask:0xf
    s_nop 0
    v_readlane_b32 s73, v36, 63
    s_nop 1
    s_sub_u32 s72, s72, s73
    v_writelane_b32 v44, s72, 1
    s_sub_u32 s72, s72, 1
    v_sub_u32 v36, s72, v28
    s_nop 1
    v_min_u32_dpp v36, v36, v36 row_shr:1 row_mask:0xf bank_mask:0xf
    s_nop 1
    v_min_u32_dpp v36, v36, v36 row_shr:2 row_mask:0xf bank_mask:0xf
    s_nop 1
    v_min_u32_dpp v36, v36, v36 row_shr:4 row_mask:0xf bank_mask:0xf
    s_nop 1
    v_min_u32_dpp v36, v36, v36 row_shr:8 row_mask:0xf bank_mask:0xf
    s_nop 1
    v_min_u32_dpp v36, v36, v36 row_bcast:15 row_mask:0xa bank_mask:0xf
    s_nop 1
    v_min_u32_dpp v36, v36, v36 row_bcast:31 row_mask:0xc bank_mask:0xf
    s_nop 0
    v_readlane_b32 s73, v36, 63
    s_nop 1
    s_sub_u32 s72, s72, s73
    v_writelane_b32 v44, s72, 2
    s_sub_u32 s72, s72, 1
    v_sub_u32 v36, s72, v28
    s_nop 1
    v_min_u32_dpp v36, v36, v36 row_shr:1 row_mask:0xf bank_mask:0xf
    s_nop 1
    v_min_u32_dpp v36, v36, v36 row_shr:2 row_mask:0xf bank_mask:0xf
    s_nop 1
    v_min_u32_dpp v36, v36, v36 row_shr:4 row_mask:0xf bank_mask:0xf
    s_nop 1
    v_min_u32_dpp v36, v36, v36 row_shr:8 row_mask:0xf bank_mask:0xf
    s_nop 1
    v_min_u32_dpp v36, v36, v36 row_bcast:15 row_mask:0xa bank_mask:0xf
    s_nop 1
    v_min_u32_dpp v36, v36, v36 row_bcast:31 row_mask:0xc bank_mask:0xf
    s_nop 0
    v_readlane_b32 s73, v36, 63
    s_nop 1
    s_sub_u32 s72, s72, s73
    v_writelane_b32 v44, s72, 3
    s_sub_u32 s72, s72, 1
    v_sub_u32 v36, s72, v28
    s_nop 1
    v_min_u32_dpp v36, v36, v36 row_shr:1 row_mask:0xf bank_mask:0xf
    s_nop 1
    v_min_u32_dpp v36, v36, v36 row_shr:2 row_mask:0xf bank_mask:0xf
    s_nop 1
    v_min_u32_dpp v36, v36, v36 row_shr:4 row_mask:0xf bank_mask:0xf
    s_nop 1
    v_min_u32_dpp v36, v36, v36 row_shr:8 row_mask:0xf bank_mask:0xf
    s_nop 1
    v_min_u32_dpp v36, v36, v36 row_bcast:15 row_mask:0xa bank_mask:0xf
    s_nop 1
    v_min_u32_dpp v36, v36, v36 row_bcast:31 row_mask:0xc bank_mask:0xf
    s_nop 0
    v_readlane_b32 s73, v36, 63
    s_nop 1
    s_sub_u32 s72, s72, s73
    v_writelane_b32 v44, s72, 4
    s_sub_u32 s72, s72, 1
    v_sub_u32 v36, s72, v28
    s_nop 1
    v_min_u32_dpp v36, v36, v36 row_shr:1 row_mask:0xf bank_mask:0xf
    s_nop 1
    v_min_u32_dpp v36, v36, v36 row_shr:2 row_mask:0xf bank_mask:0xf
    s_nop 1
    v_min_u32_dpp v36, v36, v36 row_shr:4 row_mask:0xf bank_mask:0xf
    s_nop 1
    v_min_u32_dpp v36, v36, v36 row_shr:8 row_mask:0xf bank_mask:0xf
    s_nop 1
    v_min_u32_dpp v36, v36, v36 row_bcast:15 row_mask:0xa bank_mask:0xf
    s_nop 1
    v_min_u32_dpp v36, v36, v36 row_bcast:31 row_mask:0xc bank_mask:0xf
    s_nop 0
    v_readlane_b32 s73, v36, 63
    s_nop 1
    s_sub_u32 s72, s72, s73
    v_writelane_b32 v44, s72, 5
    s_sub_u32 s72, s72, 1
    v_sub_u32 v36, s72, v28
    s_nop 1
    v_min_u32_dpp v36, v36, v36 row_shr:1 row_mask:0xf bank_mask:0xf
    s_nop 1
    v_min_u32_dpp v36, v36, v36 row_shr:2 row_mask:0xf bank_mask:0xf
    s_nop 1
    v_min_u32_dpp v36, v36, v36 row_shr:4 row_mask:0xf bank_mask:0xf
    s_nop 1
    v_min_u32_dpp v36, v36, v36 row_shr:8 row_mask:0xf bank_mask:0xf
    s_nop 1
    v_min_u32_dpp v36, v36, v36 row_bcast:15 row_mask:0xa bank_mask:0xf
    s_nop 1
    v_min_u32_dpp v36, v36, v36 row_bcast:31 row_mask:0xc bank_mask:0xf
    s_nop 0
    v_readlane_b32 s73, v36, 63
    s_nop 1
    s_sub_u32 s72, s72, s73
    v_writelane_b32 v44, s72, 6
    s_sub_u32 s72, s72, 1
    v_sub_u32 v36, s72, v28
    s_nop 1
    v_min_u32_dpp v36, v36, v36 row_shr:1 row_mask:0xf bank_mask:0xf
    s_nop 1
    v_min_u32_dpp v36, v36, v36 row_shr:2 row_mask:0xf bank_mask:0xf
    s_nop 1
    v_min_u32_dpp v36, v36, v36 row_shr:4 row_mask:0xf bank_mask:0xf
    s_nop 1
    v_min_u32_dpp v36, v36, v36 row_shr:8 row_mask:0xf bank_mask:0xf
    s_nop 1
    v_min_u32_dpp v36, v36, v36 row_bcast:15 row_mask:0xa bank_mask:0xf
    s_nop 1
    v_min_u32_dpp v36, v36, v36 row_bcast:31 row_mask:0xc bank_mask:0xf
    s_nop 0
    v_readlane_b32 s73, v36, 63
    s_nop 1
    s_sub_u32 s72, s72, s73
    v_writelane_b32 v44, s72, 7
    s_sub_u32 s72, s72, 1
    v_and_b32 v48, 0xffff, v44
    v_sub_u32 v48, 2047, v48
    v_not_b32 v36, v44
    v_ashrrev_i32 v36, 31, v36
    v_or_b32 v36, 0x80000000, v36
    v_xor_b32 v49, v36, v44
    v_and_b32 v49, 0xffff0000, v49
    v_mul_f32 v49, 0xbfb8aa3b, v49
    v_exp_f32 v49, v49
    s_nop 0
    v_add_f32 v49, 1.0, v49
    v_rcp_f32 v49, v49
    s_nop 0
    v_cvt_pk_bf16_f32 v49, v49, v49
    v_and_b32 v49, 0xffff0000, v49
    v_lshlrev_b32 v47, 2, v0
    v_add_u32 v47, 161664, v47
    s_mov_b64 exec, 0xff
    ds_write_b32 v47, v48
    ds_write_b32 v47, v49 offset:32
    s_mov_b64 exec, -1
    s_lshl_b32 s64, s48, 13
    v_add_u32 v2, s64, v94
    s_lshl_b32 s65, s44, 1
    s_lshr_b32 s66, s48, 1
    s_add_u32 s65, s65, s66
    s_lshl_b32 s65, s65, 5
    s_lshl_b32 s66, s45, 1
    s_add_u32 s65, s65, s66
    s_and_b32 s66, s48, 1
    s_add_u32 s65, s65, s66
    s_lshl_b32 s65, s65, 13
    s_add_u32 s65, s65, 8388608
    s_add_u32 s66, s65, 4096
    s_waitcnt lgkmcnt(0)
    s_barrier
    ds_read_b128 v[96:99], v2 offset:0
    ds_read_b128 v[100:103], v2 offset:1024
    ds_read_b128 v[112:115], v2 offset:4096
    ds_read_b128 v[116:119], v2 offset:5120
    s_waitcnt lgkmcnt(3)
    buffer_store_dwordx4 v[96:99], v94, s[12:15], s65 offen offset:0 sc1
    s_waitcnt lgkmcnt(2)
    buffer_store_dwordx4 v[100:103], v94, s[12:15], s65 offen offset:1024 sc1
    s_waitcnt lgkmcnt(1)
    buffer_store_dwordx4 v[112:115], v94, s[12:15], s66 offen offset:0 sc1
    s_waitcnt lgkmcnt(0)
    buffer_store_dwordx4 v[116:119], v94, s[12:15], s66 offen offset:1024 sc1
    s_waitcnt lgkmcnt(0)
    s_barrier
    ds_read_b128 v[104:107], v2 offset:2048
    ds_read_b128 v[108:111], v2 offset:3072
    ds_read_b128 v[120:123], v2 offset:6144
    ds_read_b128 v[124:127], v2 offset:7168
    s_waitcnt lgkmcnt(3)
    buffer_store_dwordx4 v[104:107], v94, s[12:15], s65 offen offset:2048 sc1
    s_waitcnt lgkmcnt(2)
    buffer_store_dwordx4 v[108:111], v94, s[12:15], s65 offen offset:3072 sc1
    s_waitcnt lgkmcnt(1)
    buffer_store_dwordx4 v[120:123], v94, s[12:15], s66 offen offset:2048 sc1
    s_waitcnt lgkmcnt(0)
    buffer_store_dwordx4 v[124:127], v94, s[12:15], s66 offen offset:3072 sc1
    s_waitcnt lgkmcnt(0)
    s_setprio 0
recurrent_scan__softmax_full_mha__moe_arch_mod__prompt_kernel_joinA:
    s_barrier
    v_lshlrev_b32 v1, 4, v0
    s_and_b32 s65, s3, 1
    s_lshl_b32 s65, s65, 1
    s_bfe_u32 s66, s3, 0x10001
    s_add_u32 s65, s65, s66
    s_lshl_b32 s65, s65, 12
    s_add_u32 s65, s65, 122880
    v_add_u32 v3, s65, v1
    ds_read_b128 v[4:7], v3 offset:0
    ds_read_b128 v[8:11], v3 offset:1024
    ds_read_b128 v[12:15], v3 offset:2048
    ds_read_b128 v[16:19], v3 offset:3072
    s_lshr_b32 s48, s3, 2
    s_and_b32 s64, s3, 1
    s_lshl_b32 s64, s64, 1
    s_add_u32 s64, s64, s48
    s_lshl_b32 s64, s64, 13
    v_add_u32 v2, s64, v1
    ds_read_b128 v[132:135], v2 offset:0
    ds_read_b128 v[136:139], v2 offset:1024
    ds_read_b128 v[140:143], v2 offset:4096
    ds_read_b128 v[144:147], v2 offset:5120
    ds_read_b128 v[164:167], v2 offset:2048
    ds_read_b128 v[168:171], v2 offset:3072
    ds_read_b128 v[172:175], v2 offset:6144
    ds_read_b128 v[176:179], v2 offset:7168
    s_lshl_b32 s49, s44, 1
    s_and_b32 s64, s3, 1
    s_add_u32 s49, s49, s64
    s_lshl_b32 s65, s49, 8
    s_lshl_b32 s49, s49, 18
    s_add_u32 s49, s49, 8388608
    s_mov_b32 s55, 0xfffe
    s_lshl_b32 s64, s48, 13
    s_add_u32 s58, s49, s64
    s_mov_b32 s63, s58
    s_lshl_b32 s64, s48, 7
    s_add_u32 s64, s64, s65
    s_add_u32 s64, s64, 21364736
    v_mov_b32 v247, s64
    s_mov_b32 s54, 0
    s_cmp_lt_u32 s46, 28
    s_cselect_b32 s59, 1, 0
    v_bfe_u32 v245, v0, 5, 1
    v_lshlrev_b32 v245, 3, v245
    v_bfe_u32 v248, v0, 3, 2
    v_add_u32 v245, v245, v248
    v_bfe_u32 v248, v0, 4, 2
    v_lshlrev_b32 v248, 1, v248
    v_and_b32 v249, 7, v0
    v_xor_b32 v248, v248, v249
    v_lshlrev_b32 v248, 4, v248
    v_mul_u32_u24 v244, 7168, v245
    v_add_u32 v244, v244, v248
    v_lshl_add_u32 v245, v245, 11, v248
    v_lshrrev_b32 v243, 2, v0
    v_lshlrev_b32 v243, 7, v243
    v_bfe_u32 v248, v0, 3, 2
    s_and_b32 s64, s3, 3
    v_xor_b32 v248, s64, v248
    v_lshl_add_u32 v243, v248, 5, v243
    v_and_b32 v248, 3, v0
    v_lshl_add_u32 v243, v248, 3, v243
    s_mul_i32 s64, s47, 28
    s_add_u32 s64, s64, s46
    s_and_b32 s65, s64, 3
    s_lshl_b32 s65, s65, 3
    s_add_u32 s65, s65, s3
    s_mul_i32 s58, s65, 229376
    s_lshr_b32 s64, s64, 2
    s_lshl_b32 s64, s64, 7
    s_add_u32 s58, s58, s64
    s_lshr_b32 s60, s2, 4
    s_mul_i32 s60, s60, 224
    s_lshl_b32 s64, s48, 5
    s_add_u32 s60, s60, s64
    s_and_b32 s64, s3, 1
    s_lshl_b32 s64, s64, 4
    s_add_u32 s60, s60, s64
    s_and_b32 s64, s3, 2
    s_lshl_b32 s64, s64, 1
    s_add_u32 s60, s60, s64
    s_lshl_b32 s60, s60, 11
    s_and_b32 s64, s2, 15
    s_lshl_b32 s64, s64, 7
    s_add_u32 s60, s60, s64
    v_mov_b32 v240, 0x7fff0000
    v_mov_b32 v241, 0x7fff0000
    v_and_b32 v248, 7, v0
    v_lshlrev_b32 v248, 2, v248
    v_add_u32 v248, 161664, v248
    ds_read_b32 v249, v248
    v_bfe_u32 v124, v0, 2, 1
    v_cmp_eq_u32 vcc, 0, v124
    v_mov_b32 v125, 0x3f803f80
    v_and_b32 v124, 1, v0
    v_cndmask_b32 v44, 0, v125, vcc
    v_cndmask_b32 v45, 0, v125, vcc
    v_cndmask_b32 v46, v125, 0, vcc
    v_cndmask_b32 v47, v125, 0, vcc
    v_bfe_u32 v126, v0, 1, 1
    v_cmp_eq_u32 vcc, 0, v126
    s_nop 1
    v_cndmask_b32 v44, 0, v44, vcc
    v_cndmask_b32 v45, 0, v45, vcc
    v_cndmask_b32 v46, 0, v46, vcc
    v_cndmask_b32 v47, 0, v47, vcc
    v_mul_u32_u24 v124, 0xaaaa, v124
    v_add_u32 v48, 0x4444, v124
    v_mov_b32 v60, 0
    v_mov_b32 v61, 0
    v_mov_b32 v62, 0
    v_mov_b32 v63, 0
    v_mov_b32 v64, 0
    v_mov_b32 v65, 0
    v_mov_b32 v66, 0
    v_mov_b32 v67, 0
    v_mov_b32 v68, 0
    v_mov_b32 v69, 0
    v_mov_b32 v70, 0
    v_mov_b32 v71, 0
    v_mov_b32 v72, 0
    v_mov_b32 v73, 0
    v_mov_b32 v74, 0
    v_mov_b32 v75, 0
    v_mov_b32 v76, 0
    v_mov_b32 v77, 0
    v_mov_b32 v78, 0
    v_mov_b32 v79, 0
    v_mov_b32 v80, 0
    v_mov_b32 v81, 0
    v_mov_b32 v82, 0
    v_mov_b32 v83, 0
    v_mov_b32 v84, 0
    v_mov_b32 v85, 0
    v_mov_b32 v86, 0
    v_mov_b32 v87, 0
    v_mov_b32 v88, 0
    v_mov_b32 v89, 0
    v_mov_b32 v90, 0
    v_mov_b32 v91, 0
    v_mov_b32 v52, 0
    v_mov_b32 v36, 0
    v_mov_b32 v53, 0
    v_mov_b32 v37, 0
    v_mov_b32 v54, 0
    v_mov_b32 v38, 0
    v_mov_b32 v55, 0
    v_mov_b32 v39, 0
    v_mov_b32 v56, 0
    v_mov_b32 v40, 0
    v_mov_b32 v57, 0
    v_mov_b32 v41, 0
    v_mov_b32 v58, 0
    v_mov_b32 v42, 0
    v_mov_b32 v59, 0
    v_mov_b32 v43, 0
    v_mov_b32 v32, 0
    v_mov_b32 v33, 0
    v_mov_b32 v34, 0
    v_mov_b32 v35, 0
    v_mov_b32 v192, 0
    v_mov_b32 v193, 0
    v_mov_b32 v194, 0
    v_mov_b32 v195, 0
    s_waitcnt lgkmcnt(0)
    s_mul_i32 s66, s3, 1
    s_add_u32 s66, s66, 0
    v_readlane_b32 s64, v249, s66
    s_nop 3
    s_lshl_b32 s65, s64, 11
    buffer_load_dwordx4 v[228:231], v1, s[4:7], s65 offen
    buffer_load_dwordx4 v[232:235], v1, s[4:7], s65 offen offset:1024
    s_lshr_b32 s65, s64, 3
    s_lshl_b32 s65, s65, 5
    s_and_b32 s64, s64, 7
    s_add_u32 s64, s64, s65
    s_lshl_b32 s64, s64, 2
    s_add_u32 s64, s64, 21299200
    v_mov_b32 v237, s64
    buffer_load_dword v236, v237, s[12:15], 0 offen sc1
    buffer_load_dword v237, v237, s[12:15], 0 offen offset:32 sc1
    v_mfma_f32_32x32x16_bf16 v[92:107], v[132:135], v[4:7], 0
    v_mfma_f32_32x32x16_bf16 v[92:107], v[136:139], v[8:11], v[92:107]
    s_nop 10
    s_cmp_eq_u32 s48, 0
    s_cselect_b32 s64, 0, 1
    s_cbranch_scc1 recurrent_scan__softmax_full_mha__moe_arch_mod__prompt_kernel_kvf_8
    s_setprio 3
recurrent_scan__softmax_full_mha__moe_arch_mod__prompt_kernel_kvf_8:
    v_mfma_f32_32x32x16_bf16 v[108:123], v[132:135], v[12:15], 0
    v_exp_f32 v92, v92
    v_exp_f32 v93, v93
    v_exp_f32 v94, v94
    v_mfma_f32_32x32x16_bf16 v[76:91], v[192:195], v[40:43], v[76:91]
    v_exp_f32 v95, v95
    v_exp_f32 v96, v96
    v_exp_f32 v97, v97
    v_smfmac_f32_16x16x64_bf16 v[56:59], v[44:47], v[36:43], v48
    v_cvt_pk_bf16_f32 v36, v92, v93
    v_cvt_pk_bf16_f32 v37, v94, v95
    v_exp_f32 v98, v98
    v_exp_f32 v99, v99
    v_mfma_f32_32x32x16_bf16 v[108:123], v[136:139], v[16:19], v[108:123]
    v_cvt_pk_bf16_f32 v38, v96, v97
    v_cvt_pk_bf16_f32 v39, v98, v99
    v_exp_f32 v100, v100
    v_exp_f32 v101, v101
    v_mfma_f32_32x32x16_bf16 v[60:75], v[164:167], v[36:39], v[60:75]
    v_exp_f32 v102, v102
    v_exp_f32 v103, v103
    v_cvt_pk_bf16_f32 v40, v100, v101
    v_exp_f32 v104, v104
    v_cvt_pk_bf16_f32 v41, v102, v103
    v_exp_f32 v105, v105
    v_exp_f32 v106, v106
    v_exp_f32 v107, v107
    v_cvt_pk_bf16_f32 v42, v104, v105
    v_cvt_pk_bf16_f32 v43, v106, v107
    v_mfma_f32_32x32x16_bf16 v[92:107], v[140:143], v[4:7], 0
    v_exp_f32 v108, v108
    v_exp_f32 v109, v109
    v_exp_f32 v110, v110
    v_mfma_f32_32x32x16_bf16 v[60:75], v[168:171], v[40:43], v[60:75]
    v_exp_f32 v111, v111
    v_exp_f32 v112, v112
    v_exp_f32 v113, v113
    v_smfmac_f32_16x16x64_bf16 v[52:55], v[44:47], v[36:43], v48
    v_cvt_pk_bf16_f32 v36, v108, v109
    v_cvt_pk_bf16_f32 v37, v110, v111
    v_exp_f32 v114, v114
    v_exp_f32 v115, v115
    v_mfma_f32_32x32x16_bf16 v[92:107], v[144:147], v[8:11], v[92:107]
    v_cvt_pk_bf16_f32 v38, v112, v113
    v_cvt_pk_bf16_f32 v39, v114, v115
    v_exp_f32 v116, v116
    v_exp_f32 v117, v117
    v_mfma_f32_32x32x16_bf16 v[76:91], v[164:167], v[36:39], v[76:91]
    v_exp_f32 v118, v118
    v_exp_f32 v119, v119
    v_cvt_pk_bf16_f32 v40, v116, v117
    v_exp_f32 v120, v120
    v_cvt_pk_bf16_f32 v41, v118, v119
    v_exp_f32 v121, v121
    v_exp_f32 v122, v122
    v_exp_f32 v123, v123
    v_cvt_pk_bf16_f32 v42, v120, v121
    v_cvt_pk_bf16_f32 v43, v122, v123
    v_mfma_f32_32x32x16_bf16 v[108:123], v[140:143], v[12:15], 0
    v_exp_f32 v92, v92
    v_exp_f32 v93, v93
    v_exp_f32 v94, v94
    v_mfma_f32_32x32x16_bf16 v[76:91], v[168:171], v[40:43], v[76:91]
    v_exp_f32 v95, v95
    v_exp_f32 v96, v96
    v_exp_f32 v97, v97
    v_smfmac_f32_16x16x64_bf16 v[56:59], v[44:47], v[36:43], v48
    v_cvt_pk_bf16_f32 v36, v92, v93
    v_cvt_pk_bf16_f32 v37, v94, v95
    v_exp_f32 v98, v98
    v_exp_f32 v99, v99
    v_mfma_f32_32x32x16_bf16 v[108:123], v[144:147], v[16:19], v[108:123]
    v_cvt_pk_bf16_f32 v38, v96, v97
    v_cvt_pk_bf16_f32 v39, v98, v99
    v_exp_f32 v100, v100
    v_exp_f32 v101, v101
    v_mfma_f32_32x32x16_bf16 v[60:75], v[172:175], v[36:39], v[60:75]
    v_exp_f32 v102, v102
    v_exp_f32 v103, v103
    v_cvt_pk_bf16_f32 v40, v100, v101
    v_exp_f32 v104, v104
    v_cvt_pk_bf16_f32 v41, v102, v103
    v_exp_f32 v105, v105
    v_exp_f32 v106, v106
    v_exp_f32 v107, v107
    v_cvt_pk_bf16_f32 v42, v104, v105
    v_cvt_pk_bf16_f32 v43, v106, v107
    v_exp_f32 v108, v108
    v_exp_f32 v109, v109
    v_exp_f32 v110, v110
    v_mfma_f32_32x32x16_bf16 v[60:75], v[176:179], v[40:43], v[60:75]
    v_exp_f32 v111, v111
    v_exp_f32 v112, v112
    v_exp_f32 v113, v113
    v_smfmac_f32_16x16x64_bf16 v[52:55], v[44:47], v[36:43], v48
    v_cvt_pk_bf16_f32 v36, v108, v109
    v_cvt_pk_bf16_f32 v37, v110, v111
    v_exp_f32 v114, v114
    v_exp_f32 v115, v115
    v_cvt_pk_bf16_f32 v38, v112, v113
    v_cvt_pk_bf16_f32 v39, v114, v115
    v_exp_f32 v116, v116
    v_exp_f32 v117, v117
    v_mfma_f32_32x32x16_bf16 v[76:91], v[172:175], v[36:39], v[76:91]
    v_exp_f32 v118, v118
    v_exp_f32 v119, v119
    v_cvt_pk_bf16_f32 v40, v116, v117
    v_exp_f32 v120, v120
    v_cvt_pk_bf16_f32 v41, v118, v119
    v_exp_f32 v121, v121
    v_exp_f32 v122, v122
    v_exp_f32 v123, v123
    v_cvt_pk_bf16_f32 v42, v120, v121
    v_cvt_pk_bf16_f32 v43, v122, v123
    s_waitcnt vmcnt(0)
    s_cmp_eq_u32 s48, 0
    s_cbranch_scc1 recurrent_scan__softmax_full_mha__moe_arch_mod__prompt_kernel_kvf_8_f
    s_lshl_b32 s64, s44, 2
    s_and_b32 s65, s3, 3
    s_add_u32 s64, s64, s65
    s_lshl_b32 s64, s64, 7
    s_add_u32 s64, s64, 21364736
    s_lshl_b32 s65, 1, s45
    v_mov_b32 v248, s64
    v_mov_b32 v249, s65
    s_mov_b64 exec, 1
    buffer_atomic_or v249, v248, s[12:15], 0 offen sc1
    s_mov_b64 exec, -1
recurrent_scan__softmax_full_mha__moe_arch_mod__prompt_kernel_kvf_8_f:
    v_lshrrev_b32 v248, 2, v0
    v_lshlrev_b32 v248, 9, v248
    v_and_b32 v249, 3, v0
    v_lshl_add_u32 v248, v249, 7, v248
    s_lshl_b32 s64, s3, 4
    s_add_u32 s64, s64, 139264
    v_add_u32 v248, s64, v248
    v_lshlrev_b32 v250, 16, v228
    v_and_b32 v251, 0xffff0000, v228
    v_sub_f32 v250, v250, v236
    v_sub_f32 v251, v251, v236
    v_cvt_pk_bf16_f32 v228, v250, v251
    v_lshlrev_b32 v250, 16, v228
    v_and_b32 v251, 0xffff0000, v228
    v_mul_f32 v250, v250, v237
    v_mul_f32 v251, v251, v237
    v_cvt_pk_bf16_f32 v228, v250, v251
    v_lshlrev_b32 v252, 16, v229
    v_and_b32 v253, 0xffff0000, v229
    v_sub_f32 v252, v252, v236
    v_sub_f32 v253, v253, v236
    v_cvt_pk_bf16_f32 v229, v252, v253
    v_lshlrev_b32 v252, 16, v229
    v_and_b32 v253, 0xffff0000, v229
    v_mul_f32 v252, v252, v237
    v_mul_f32 v253, v253, v237
    v_cvt_pk_bf16_f32 v229, v252, v253
    v_lshlrev_b32 v250, 16, v230
    v_and_b32 v251, 0xffff0000, v230
    v_sub_f32 v250, v250, v236
    v_sub_f32 v251, v251, v236
    v_cvt_pk_bf16_f32 v230, v250, v251
    v_lshlrev_b32 v250, 16, v230
    v_and_b32 v251, 0xffff0000, v230
    v_mul_f32 v250, v250, v237
    v_mul_f32 v251, v251, v237
    v_cvt_pk_bf16_f32 v230, v250, v251
    v_lshlrev_b32 v252, 16, v231
    v_and_b32 v253, 0xffff0000, v231
    v_sub_f32 v252, v252, v236
    v_sub_f32 v253, v253, v236
    v_cvt_pk_bf16_f32 v231, v252, v253
    v_lshlrev_b32 v252, 16, v231
    v_and_b32 v253, 0xffff0000, v231
    v_mul_f32 v252, v252, v237
    v_mul_f32 v253, v253, v237
    v_cvt_pk_bf16_f32 v231, v252, v253
    v_lshlrev_b32 v250, 16, v232
    v_and_b32 v251, 0xffff0000, v232
    v_sub_f32 v250, v250, v236
    v_sub_f32 v251, v251, v236
    v_cvt_pk_bf16_f32 v232, v250, v251
    v_lshlrev_b32 v250, 16, v232
    v_and_b32 v251, 0xffff0000, v232
    v_mul_f32 v250, v250, v237
    v_mul_f32 v251, v251, v237
    v_cvt_pk_bf16_f32 v232, v250, v251
    v_lshlrev_b32 v252, 16, v233
    v_and_b32 v253, 0xffff0000, v233
    v_sub_f32 v252, v252, v236
    v_sub_f32 v253, v253, v236
    v_cvt_pk_bf16_f32 v233, v252, v253
    v_lshlrev_b32 v252, 16, v233
    v_and_b32 v253, 0xffff0000, v233
    v_mul_f32 v252, v252, v237
    v_mul_f32 v253, v253, v237
    v_cvt_pk_bf16_f32 v233, v252, v253
    v_lshlrev_b32 v250, 16, v234
    v_and_b32 v251, 0xffff0000, v234
    v_sub_f32 v250, v250, v236
    v_sub_f32 v251, v251, v236
    v_cvt_pk_bf16_f32 v234, v250, v251
    v_lshlrev_b32 v250, 16, v234
    v_and_b32 v251, 0xffff0000, v234
    v_mul_f32 v250, v250, v237
    v_mul_f32 v251, v251, v237
    v_cvt_pk_bf16_f32 v234, v250, v251
    v_lshlrev_b32 v252, 16, v235
    v_and_b32 v253, 0xffff0000, v235
    v_sub_f32 v252, v252, v236
    v_sub_f32 v253, v253, v236
    v_cvt_pk_bf16_f32 v235, v252, v253
    v_lshlrev_b32 v252, 16, v235
    v_and_b32 v253, 0xffff0000, v235
    v_mul_f32 v252, v252, v237
    v_mul_f32 v253, v253, v237
    v_cvt_pk_bf16_f32 v235, v252, v253
    ds_write_b128 v248, v[228:231] offset:0
    ds_write_b128 v248, v[232:235] offset:8192
    s_waitcnt lgkmcnt(0)
    s_and_b32 s54, s54, s55
    s_cbranch_scc1 recurrent_scan__softmax_full_mha__moe_arch_mod__prompt_kernel_nb_9
    s_call_b64 s[56:57], recurrent_scan__softmax_full_mha__moe_arch_mod__prompt_kernel_kvspin
recurrent_scan__softmax_full_mha__moe_arch_mod__prompt_kernel_nb_9:
    s_ff1_i32_b32 s51, s54
    s_bitset0_b32 s55, s51
    s_add_u32 s51, s51, s45
    s_and_b32 s51, s51, 15
    s_lshl_b32 s51, s51, 14
    s_add_u32 s51, s51, s63
    s_mov_b32 s50, s51
    buffer_load_dwordx4 v[148:151], v1, s[12:15], s50 offen offset:0
    buffer_load_dwordx4 v[152:155], v1, s[12:15], s50 offen offset:1024
    s_mov_b32 s52, s51
    buffer_load_dwordx4 v[180:183], v1, s[12:15], s52 offen offset:2048
    buffer_load_dwordx4 v[184:187], v1, s[12:15], s52 offen offset:3072
    s_add_u32 s50, s50, 4096
    buffer_load_dwordx4 v[156:159], v1, s[12:15], s50 offen offset:0
    buffer_load_dwordx4 v[160:163], v1, s[12:15], s50 offen offset:1024
    s_add_u32 s52, s52, 4096
    buffer_load_dwordx4 v[188:191], v1, s[12:15], s52 offen offset:2048
    buffer_load_dwordx4 v[192:195], v1, s[12:15], s52 offen offset:3072
    s_and_b32 s54, s54, s55
    s_cbranch_scc1 recurrent_scan__softmax_full_mha__moe_arch_mod__prompt_kernel_nb_10
    s_call_b64 s[56:57], recurrent_scan__softmax_full_mha__moe_arch_mod__prompt_kernel_kvspin
recurrent_scan__softmax_full_mha__moe_arch_mod__prompt_kernel_nb_10:
    s_ff1_i32_b32 s51, s54
    s_bitset0_b32 s55, s51
    s_add_u32 s51, s51, s45
    s_and_b32 s51, s51, 15
    s_lshl_b32 s51, s51, 14
    s_add_u32 s51, s51, s63
    s_mov_b32 s50, s51
    buffer_load_dwordx4 v[132:135], v1, s[12:15], s50 offen offset:0
    buffer_load_dwordx4 v[136:139], v1, s[12:15], s50 offen offset:1024
    s_mov_b32 s52, s51
    buffer_load_dwordx4 v[164:167], v1, s[12:15], s52 offen offset:2048
    buffer_load_dwordx4 v[168:171], v1, s[12:15], s52 offen offset:3072
    s_add_u32 s50, s50, 4096
    buffer_load_dwordx4 v[140:143], v1, s[12:15], s50 offen offset:0
    buffer_load_dwordx4 v[144:147], v1, s[12:15], s50 offen offset:1024
    s_waitcnt vmcnt(12)
    v_mfma_f32_32x32x16_bf16 v[92:107], v[148:151], v[4:7], 0
    v_mfma_f32_32x32x16_bf16 v[92:107], v[152:155], v[8:11], v[92:107]
    s_nop 10
    s_setprio 1
    v_mov_b32 v246, 0
    s_mov_b64 exec, 1
    buffer_atomic_or v246, v247, s[12:15], 0 offen sc0 sc1
    s_mov_b64 exec, -1
    v_mfma_f32_32x32x16_bf16 v[108:123], v[148:151], v[12:15], 0
    s_add_u32 s52, s52, 4096
    buffer_load_dwordx4 v[172:175], v1, s[12:15], s52 offen offset:2048
    v_exp_f32 v92, v92
    v_exp_f32 v93, v93
    v_exp_f32 v94, v94
    v_mfma_f32_32x32x16_bf16 v[76:91], v[176:179], v[40:43], v[76:91]
    v_exp_f32 v95, v95
    v_exp_f32 v96, v96
    v_exp_f32 v97, v97
    v_smfmac_f32_16x16x64_bf16 v[56:59], v[44:47], v[36:43], v48
    v_cvt_pk_bf16_f32 v36, v92, v93
    v_cvt_pk_bf16_f32 v37, v94, v95
    v_exp_f32 v98, v98
    v_exp_f32 v99, v99
    v_mfma_f32_32x32x16_bf16 v[108:123], v[152:155], v[16:19], v[108:123]
    buffer_load_dwordx4 v[176:179], v1, s[12:15], s52 offen offset:3072
    v_cvt_pk_bf16_f32 v38, v96, v97
    v_cvt_pk_bf16_f32 v39, v98, v99
    v_exp_f32 v100, v100
    v_exp_f32 v101, v101
    s_waitcnt vmcnt(14)
    v_mfma_f32_32x32x16_bf16 v[60:75], v[180:183], v[36:39], v[60:75]
    v_exp_f32 v102, v102
    v_exp_f32 v103, v103
    v_cvt_pk_bf16_f32 v40, v100, v101
    v_exp_f32 v104, v104
    v_cvt_pk_bf16_f32 v41, v102, v103
    v_exp_f32 v105, v105
    v_exp_f32 v106, v106
    v_exp_f32 v107, v107
    v_cvt_pk_bf16_f32 v42, v104, v105
    v_cvt_pk_bf16_f32 v43, v106, v107
    s_waitcnt vmcnt(11)
    v_mfma_f32_32x32x16_bf16 v[92:107], v[156:159], v[4:7], 0
    v_exp_f32 v108, v108
    v_exp_f32 v109, v109
    v_exp_f32 v110, v110
    v_mfma_f32_32x32x16_bf16 v[60:75], v[184:187], v[40:43], v[60:75]
    s_and_b32 s54, s54, s55
    s_cbranch_scc1 recurrent_scan__softmax_full_mha__moe_arch_mod__prompt_kernel_nb_11
    s_call_b64 s[56:57], recurrent_scan__softmax_full_mha__moe_arch_mod__prompt_kernel_kvspin
recurrent_scan__softmax_full_mha__moe_arch_mod__prompt_kernel_nb_11:
    s_ff1_i32_b32 s51, s54
    s_bitset0_b32 s55, s51
    s_add_u32 s51, s51, s45
    s_and_b32 s51, s51, 15
    s_lshl_b32 s51, s51, 14
    s_add_u32 s51, s51, s63
    s_mov_b32 s50, s51
    buffer_load_dwordx4 v[148:151], v1, s[12:15], s50 offen offset:0
    v_exp_f32 v111, v111
    v_exp_f32 v112, v112
    v_exp_f32 v113, v113
    v_smfmac_f32_16x16x64_bf16 v[52:55], v[44:47], v[36:43], v48
    v_cvt_pk_bf16_f32 v36, v108, v109
    v_cvt_pk_bf16_f32 v37, v110, v111
    v_exp_f32 v114, v114
    v_exp_f32 v115, v115
    v_mfma_f32_32x32x16_bf16 v[92:107], v[160:163], v[8:11], v[92:107]
    v_cvt_pk_bf16_f32 v38, v112, v113
    v_cvt_pk_bf16_f32 v39, v114, v115
    v_exp_f32 v116, v116
    v_exp_f32 v117, v117
    v_mfma_f32_32x32x16_bf16 v[76:91], v[180:183], v[36:39], v[76:91]
    buffer_load_dwordx4 v[152:155], v1, s[12:15], s50 offen offset:1024
    v_exp_f32 v118, v118
    v_exp_f32 v119, v119
    v_cvt_pk_bf16_f32 v40, v116, v117
    v_exp_f32 v120, v120
    v_cvt_pk_bf16_f32 v41, v118, v119
    v_exp_f32 v121, v121
    v_exp_f32 v122, v122
    v_exp_f32 v123, v123
    v_cvt_pk_bf16_f32 v42, v120, v121
    v_cvt_pk_bf16_f32 v43, v122, v123
    s_setprio 0
    v_mfma_f32_32x32x16_bf16 v[108:123], v[156:159], v[12:15], 0
    s_mov_b32 s52, s51
    buffer_load_dwordx4 v[180:183], v1, s[12:15], s52 offen offset:2048
    v_exp_f32 v92, v92
    v_exp_f32 v93, v93
    v_exp_f32 v94, v94
    v_mfma_f32_32x32x16_bf16 v[76:91], v[184:187], v[40:43], v[76:91]
    v_exp_f32 v95, v95
    v_exp_f32 v96, v96
    v_exp_f32 v97, v97
    v_smfmac_f32_16x16x64_bf16 v[56:59], v[44:47], v[36:43], v48
    v_cvt_pk_bf16_f32 v36, v92, v93
    v_cvt_pk_bf16_f32 v37, v94, v95
    v_exp_f32 v98, v98
    v_exp_f32 v99, v99
    v_mfma_f32_32x32x16_bf16 v[108:123], v[160:163], v[16:19], v[108:123]
    buffer_load_dwordx4 v[184:187], v1, s[12:15], s52 offen offset:3072
    v_cvt_pk_bf16_f32 v38, v96, v97
    v_cvt_pk_bf16_f32 v39, v98, v99
    v_exp_f32 v100, v100
    v_exp_f32 v101, v101
    s_waitcnt vmcnt(14)
    v_mfma_f32_32x32x16_bf16 v[60:75], v[188:191], v[36:39], v[60:75]
    v_exp_f32 v102, v102
    v_exp_f32 v103, v103
    v_cvt_pk_bf16_f32 v40, v100, v101
    v_exp_f32 v104, v104
    v_cvt_pk_bf16_f32 v41, v102, v103
    v_exp_f32 v105, v105
    v_exp_f32 v106, v106
    v_exp_f32 v107, v107
    v_cvt_pk_bf16_f32 v42, v104, v105
    v_cvt_pk_bf16_f32 v43, v106, v107
    s_cmp_eq_u32 s59, 0
    s_cbranch_scc1 recurrent_scan__softmax_full_mha__moe_arch_mod__prompt_kernel_g_12
    s_lshl_b32 s64, s3, 12
    s_add_u32 m0, s64, 32768
    s_add_u32 s64, s58, 0
    buffer_load_dwordx4 v244, s[24:27], s64 offen nt lds
recurrent_scan__softmax_full_mha__moe_arch_mod__prompt_kernel_g_12:
    s_waitcnt vmcnt(11)
    v_mfma_f32_32x32x16_bf16 v[92:107], v[132:135], v[4:7], 0
    v_exp_f32 v108, v108
    v_exp_f32 v109, v109
    v_exp_f32 v110, v110
    v_mfma_f32_32x32x16_bf16 v[60:75], v[192:195], v[40:43], v[60:75]
    s_add_u32 s50, s50, 4096
    buffer_load_dwordx4 v[156:159], v1, s[12:15], s50 offen offset:0
    v_exp_f32 v111, v111
    v_exp_f32 v112, v112
    v_exp_f32 v113, v113
    v_smfmac_f32_16x16x64_bf16 v[52:55], v[44:47], v[36:43], v48
    v_cvt_pk_bf16_f32 v36, v108, v109
    v_cvt_pk_bf16_f32 v37, v110, v111
    v_exp_f32 v114, v114
    v_exp_f32 v115, v115
    v_mfma_f32_32x32x16_bf16 v[92:107], v[136:139], v[8:11], v[92:107]
    v_cvt_pk_bf16_f32 v38, v112, v113
    v_cvt_pk_bf16_f32 v39, v114, v115
    v_exp_f32 v116, v116
    v_exp_f32 v117, v117
    v_mfma_f32_32x32x16_bf16 v[76:91], v[188:191], v[36:39], v[76:91]
    buffer_load_dwordx4 v[160:163], v1, s[12:15], s50 offen offset:1024
    v_exp_f32 v118, v118
    v_exp_f32 v119, v119
    v_cvt_pk_bf16_f32 v40, v116, v117
    v_exp_f32 v120, v120
    v_cvt_pk_bf16_f32 v41, v118, v119
    v_exp_f32 v121, v121
    v_exp_f32 v122, v122
    v_exp_f32 v123, v123
    v_cvt_pk_bf16_f32 v42, v120, v121
    v_cvt_pk_bf16_f32 v43, v122, v123
    s_barrier
    s_setprio 3
    s_waitcnt vmcnt(8)
    v_readfirstlane_b32 s54, v246
    s_nop 0
    s_mul_i32 s54, s54, 0x10001
    s_lshr_b32 s54, s54, s45
    v_mfma_f32_32x32x16_bf16 v[108:123], v[132:135], v[12:15], 0
    s_add_u32 s52, s52, 4096
    buffer_load_dwordx4 v[188:191], v1, s[12:15], s52 offen offset:2048
    v_exp_f32 v92, v92
    v_exp_f32 v93, v93
    v_exp_f32 v94, v94
    v_mfma_f32_32x32x16_bf16 v[76:91], v[192:195], v[40:43], v[76:91]
    v_exp_f32 v95, v95
    v_exp_f32 v96, v96
    v_exp_f32 v97, v97
    v_smfmac_f32_16x16x64_bf16 v[56:59], v[44:47], v[36:43], v48
    v_cvt_pk_bf16_f32 v36, v92, v93
    v_cvt_pk_bf16_f32 v37, v94, v95
    v_exp_f32 v98, v98
    v_exp_f32 v99, v99
    v_mfma_f32_32x32x16_bf16 v[108:123], v[136:139], v[16:19], v[108:123]
    buffer_load_dwordx4 v[192:195], v1, s[12:15], s52 offen offset:3072
    v_cvt_pk_bf16_f32 v38, v96, v97
    v_cvt_pk_bf16_f32 v39, v98, v99
    v_exp_f32 v100, v100
    v_exp_f32 v101, v101
    v_mfma_f32_32x32x16_bf16 v[60:75], v[164:167], v[36:39], v[60:75]
    v_exp_f32 v102, v102
    v_exp_f32 v103, v103
    v_cvt_pk_bf16_f32 v40, v100, v101
    v_exp_f32 v104, v104
    v_cvt_pk_bf16_f32 v41, v102, v103
    v_exp_f32 v105, v105
    v_exp_f32 v106, v106
    v_exp_f32 v107, v107
    v_cvt_pk_bf16_f32 v42, v104, v105
    v_cvt_pk_bf16_f32 v43, v106, v107
    s_cmp_eq_u32 s59, 0
    s_cbranch_scc1 recurrent_scan__softmax_full_mha__moe_arch_mod__prompt_kernel_g_13
    s_lshl_b32 s64, s3, 12
    s_add_u32 m0, s64, 33792
    s_add_u32 s64, s58, 114688
    buffer_load_dwordx4 v244, s[24:27], s64 offen nt lds
recurrent_scan__softmax_full_mha__moe_arch_mod__prompt_kernel_g_13:
    v_mfma_f32_32x32x16_bf16 v[92:107], v[140:143], v[4:7], 0
    v_exp_f32 v108, v108
    v_exp_f32 v109, v109
    v_exp_f32 v110, v110
    v_mfma_f32_32x32x16_bf16 v[60:75], v[168:171], v[40:43], v[60:75]
    s_and_b32 s54, s54, s55
    s_cbranch_scc1 recurrent_scan__softmax_full_mha__moe_arch_mod__prompt_kernel_nb_14
    s_call_b64 s[56:57], recurrent_scan__softmax_full_mha__moe_arch_mod__prompt_kernel_kvspin
recurrent_scan__softmax_full_mha__moe_arch_mod__prompt_kernel_nb_14:
    s_ff1_i32_b32 s51, s54
    s_bitset0_b32 s55, s51
    s_add_u32 s51, s51, s45
    s_and_b32 s51, s51, 15
    s_lshl_b32 s51, s51, 14
    s_add_u32 s51, s51, s63
    s_mov_b32 s50, s51
    buffer_load_dwordx4 v[132:135], v1, s[12:15], s50 offen offset:0
    v_exp_f32 v111, v111
    v_exp_f32 v112, v112
    v_exp_f32 v113, v113
    v_smfmac_f32_16x16x64_bf16 v[52:55], v[44:47], v[36:43], v48
    v_cvt_pk_bf16_f32 v36, v108, v109
    v_cvt_pk_bf16_f32 v37, v110, v111
    v_exp_f32 v114, v114
    v_exp_f32 v115, v115
    v_mfma_f32_32x32x16_bf16 v[92:107], v[144:147], v[8:11], v[92:107]
    v_cvt_pk_bf16_f32 v38, v112, v113
    v_cvt_pk_bf16_f32 v39, v114, v115
    v_exp_f32 v116, v116
    v_exp_f32 v117, v117
    v_mfma_f32_32x32x16_bf16 v[76:91], v[164:167], v[36:39], v[76:91]
    buffer_load_dwordx4 v[136:139], v1, s[12:15], s50 offen offset:1024
    v_exp_f32 v118, v118
    v_exp_f32 v119, v119
    v_cvt_pk_bf16_f32 v40, v116, v117
    v_exp_f32 v120, v120
    v_cvt_pk_bf16_f32 v41, v118, v119
    v_exp_f32 v121, v121
    v_exp_f32 v122, v122
    v_exp_f32 v123, v123
    v_cvt_pk_bf16_f32 v42, v120, v121
    v_cvt_pk_bf16_f32 v43, v122, v123
    s_setprio 2
    v_mov_b32 v246, 0
    s_mov_b64 exec, 1
    buffer_atomic_or v246, v247, s[12:15], 0 offen sc0 sc1
    s_mov_b64 exec, -1
    v_mfma_f32_32x32x16_bf16 v[108:123], v[140:143], v[12:15], 0
    s_mov_b32 s52, s51
    buffer_load_dwordx4 v[164:167], v1, s[12:15], s52 offen offset:2048
    v_exp_f32 v92, v92
    v_exp_f32 v93, v93
    v_exp_f32 v94, v94
    v_mfma_f32_32x32x16_bf16 v[76:91], v[168:171], v[40:43], v[76:91]
    v_exp_f32 v95, v95
    v_exp_f32 v96, v96
    v_exp_f32 v97, v97
    v_smfmac_f32_16x16x64_bf16 v[56:59], v[44:47], v[36:43], v48
    v_cvt_pk_bf16_f32 v36, v92, v93
    v_cvt_pk_bf16_f32 v37, v94, v95
    v_exp_f32 v98, v98
    v_exp_f32 v99, v99
    v_mfma_f32_32x32x16_bf16 v[108:123], v[144:147], v[16:19], v[108:123]
    buffer_load_dwordx4 v[168:171], v1, s[12:15], s52 offen offset:3072
    v_cvt_pk_bf16_f32 v38, v96, v97
    v_cvt_pk_bf16_f32 v39, v98, v99
    v_exp_f32 v100, v100
    v_exp_f32 v101, v101
    s_waitcnt vmcnt(14)
    v_mfma_f32_32x32x16_bf16 v[60:75], v[172:175], v[36:39], v[60:75]
    v_exp_f32 v102, v102
    v_exp_f32 v103, v103
    v_cvt_pk_bf16_f32 v40, v100, v101
    v_exp_f32 v104, v104
    v_cvt_pk_bf16_f32 v41, v102, v103
    v_exp_f32 v105, v105
    v_exp_f32 v106, v106
    v_exp_f32 v107, v107
    v_cvt_pk_bf16_f32 v42, v104, v105
    v_cvt_pk_bf16_f32 v43, v106, v107
    s_cmp_eq_u32 s59, 0
    s_cbranch_scc1 recurrent_scan__softmax_full_mha__moe_arch_mod__prompt_kernel_g_15
    s_lshl_b32 s64, s3, 12
    s_add_u32 m0, s64, 34816
    s_add_u32 s64, s58, 28672
    buffer_load_dwordx4 v244, s[24:27], s64 offen nt lds
recurrent_scan__softmax_full_mha__moe_arch_mod__prompt_kernel_g_15:
    s_waitcnt vmcnt(11)
    v_mfma_f32_32x32x16_bf16 v[92:107], v[148:151], v[4:7], 0
    v_exp_f32 v108, v108
    v_exp_f32 v109, v109
    v_exp_f32 v110, v110
    v_mfma_f32_32x32x16_bf16 v[60:75], v[176:179], v[40:43], v[60:75]
    s_add_u32 s50, s50, 4096
    buffer_load_dwordx4 v[140:143], v1, s[12:15], s50 offen offset:0
    v_exp_f32 v111, v111
    v_exp_f32 v112, v112
    v_exp_f32 v113, v113
    v_smfmac_f32_16x16x64_bf16 v[52:55], v[44:47], v[36:43], v48
    v_cvt_pk_bf16_f32 v36, v108, v109
    v_cvt_pk_bf16_f32 v37, v110, v111
    v_exp_f32 v114, v114
    v_exp_f32 v115, v115
    v_mfma_f32_32x32x16_bf16 v[92:107], v[152:155], v[8:11], v[92:107]
    v_cvt_pk_bf16_f32 v38, v112, v113
    v_cvt_pk_bf16_f32 v39, v114, v115
    v_exp_f32 v116, v116
    v_exp_f32 v117, v117
    v_mfma_f32_32x32x16_bf16 v[76:91], v[172:175], v[36:39], v[76:91]
    buffer_load_dwordx4 v[144:147], v1, s[12:15], s50 offen offset:1024
    v_exp_f32 v118, v118
    v_exp_f32 v119, v119
    v_cvt_pk_bf16_f32 v40, v116, v117
    v_exp_f32 v120, v120
    v_cvt_pk_bf16_f32 v41, v118, v119
    v_exp_f32 v121, v121
    v_exp_f32 v122, v122
    v_exp_f32 v123, v123
    v_cvt_pk_bf16_f32 v42, v120, v121
    v_cvt_pk_bf16_f32 v43, v122, v123
    s_setprio 1
    v_mfma_f32_32x32x16_bf16 v[108:123], v[148:151], v[12:15], 0
    s_add_u32 s52, s52, 4096
    buffer_load_dwordx4 v[172:175], v1, s[12:15], s52 offen offset:2048
    v_exp_f32 v92, v92
    v_exp_f32 v93, v93
    v_exp_f32 v94, v94
    v_mfma_f32_32x32x16_bf16 v[76:91], v[176:179], v[40:43], v[76:91]
    v_exp_f32 v95, v95
    v_exp_f32 v96, v96
    v_exp_f32 v97, v97
    v_smfmac_f32_16x16x64_bf16 v[56:59], v[44:47], v[36:43], v48
    v_cvt_pk_bf16_f32 v36, v92, v93
    v_cvt_pk_bf16_f32 v37, v94, v95
    v_exp_f32 v98, v98
    v_exp_f32 v99, v99
    v_mfma_f32_32x32x16_bf16 v[108:123], v[152:155], v[16:19], v[108:123]
    buffer_load_dwordx4 v[176:179], v1, s[12:15], s52 offen offset:3072
    v_cvt_pk_bf16_f32 v38, v96, v97
    v_cvt_pk_bf16_f32 v39, v98, v99
    v_exp_f32 v100, v100
    v_exp_f32 v101, v101
    s_waitcnt vmcnt(14)
    v_mfma_f32_32x32x16_bf16 v[60:75], v[180:183], v[36:39], v[60:75]
    v_exp_f32 v102, v102
    v_exp_f32 v103, v103
    v_cvt_pk_bf16_f32 v40, v100, v101
    v_exp_f32 v104, v104
    v_cvt_pk_bf16_f32 v41, v102, v103
    v_exp_f32 v105, v105
    v_exp_f32 v106, v106
    v_exp_f32 v107, v107
    v_cvt_pk_bf16_f32 v42, v104, v105
    v_cvt_pk_bf16_f32 v43, v106, v107
    s_cmp_eq_u32 s59, 0
    s_cbranch_scc1 recurrent_scan__softmax_full_mha__moe_arch_mod__prompt_kernel_g_16
    s_lshl_b32 s64, s3, 12
    s_add_u32 m0, s64, 35840
    s_add_u32 s64, s58, 143360
    buffer_load_dwordx4 v244, s[24:27], s64 offen nt lds
recurrent_scan__softmax_full_mha__moe_arch_mod__prompt_kernel_g_16:
    s_waitcnt vmcnt(11)
    v_mfma_f32_32x32x16_bf16 v[92:107], v[156:159], v[4:7], 0
    v_exp_f32 v108, v108
    v_exp_f32 v109, v109
    v_exp_f32 v110, v110
    v_mfma_f32_32x32x16_bf16 v[60:75], v[184:187], v[40:43], v[60:75]
    s_and_b32 s54, s54, s55
    s_cbranch_scc1 recurrent_scan__softmax_full_mha__moe_arch_mod__prompt_kernel_nb_17
    s_call_b64 s[56:57], recurrent_scan__softmax_full_mha__moe_arch_mod__prompt_kernel_kvspin
recurrent_scan__softmax_full_mha__moe_arch_mod__prompt_kernel_nb_17:
    s_ff1_i32_b32 s51, s54
    s_bitset0_b32 s55, s51
    s_add_u32 s51, s51, s45
    s_and_b32 s51, s51, 15
    s_lshl_b32 s51, s51, 14
    s_add_u32 s51, s51, s63
    s_mov_b32 s50, s51
    buffer_load_dwordx4 v[148:151], v1, s[12:15], s50 offen offset:0
    v_exp_f32 v111, v111
    v_exp_f32 v112, v112
    v_exp_f32 v113, v113
    v_smfmac_f32_16x16x64_bf16 v[52:55], v[44:47], v[36:43], v48
    v_cvt_pk_bf16_f32 v36, v108, v109
    v_cvt_pk_bf16_f32 v37, v110, v111
    v_exp_f32 v114, v114
    v_exp_f32 v115, v115
    v_mfma_f32_32x32x16_bf16 v[92:107], v[160:163], v[8:11], v[92:107]
    v_cvt_pk_bf16_f32 v38, v112, v113
    v_cvt_pk_bf16_f32 v39, v114, v115
    v_exp_f32 v116, v116
    v_exp_f32 v117, v117
    v_mfma_f32_32x32x16_bf16 v[76:91], v[180:183], v[36:39], v[76:91]
    buffer_load_dwordx4 v[152:155], v1, s[12:15], s50 offen offset:1024
    v_exp_f32 v118, v118
    v_exp_f32 v119, v119
    v_cvt_pk_bf16_f32 v40, v116, v117
    v_exp_f32 v120, v120
    v_cvt_pk_bf16_f32 v41, v118, v119
    v_exp_f32 v121, v121
    v_exp_f32 v122, v122
    v_exp_f32 v123, v123
    v_cvt_pk_bf16_f32 v42, v120, v121
    v_cvt_pk_bf16_f32 v43, v122, v123
    s_setprio 0
    s_waitcnt vmcnt(8)
    v_readfirstlane_b32 s54, v246
    s_nop 0
    s_mul_i32 s54, s54, 0x10001
    s_lshr_b32 s54, s54, s45
    v_mfma_f32_32x32x16_bf16 v[108:123], v[156:159], v[12:15], 0
    s_mov_b32 s52, s51
    buffer_load_dwordx4 v[180:183], v1, s[12:15], s52 offen offset:2048
    v_exp_f32 v92, v92
    v_exp_f32 v93, v93
    v_exp_f32 v94, v94
    v_mfma_f32_32x32x16_bf16 v[76:91], v[184:187], v[40:43], v[76:91]
    v_exp_f32 v95, v95
    v_exp_f32 v96, v96
    v_exp_f32 v97, v97
    v_smfmac_f32_16x16x64_bf16 v[56:59], v[44:47], v[36:43], v48
    v_cvt_pk_bf16_f32 v36, v92, v93
    v_cvt_pk_bf16_f32 v37, v94, v95
    v_exp_f32 v98, v98
    v_exp_f32 v99, v99
    v_mfma_f32_32x32x16_bf16 v[108:123], v[160:163], v[16:19], v[108:123]
    buffer_load_dwordx4 v[184:187], v1, s[12:15], s52 offen offset:3072
    v_cvt_pk_bf16_f32 v38, v96, v97
    v_cvt_pk_bf16_f32 v39, v98, v99
    v_exp_f32 v100, v100
    v_exp_f32 v101, v101
    v_mfma_f32_32x32x16_bf16 v[60:75], v[188:191], v[36:39], v[60:75]
    v_exp_f32 v102, v102
    v_exp_f32 v103, v103
    v_cvt_pk_bf16_f32 v40, v100, v101
    v_exp_f32 v104, v104
    v_cvt_pk_bf16_f32 v41, v102, v103
    v_exp_f32 v105, v105
    v_exp_f32 v106, v106
    v_exp_f32 v107, v107
    v_cvt_pk_bf16_f32 v42, v104, v105
    v_cvt_pk_bf16_f32 v43, v106, v107
    s_cmp_eq_u32 s59, 0
    s_cbranch_scc1 recurrent_scan__softmax_full_mha__moe_arch_mod__prompt_kernel_g_18
    s_lshl_b32 s64, s3, 12
    s_add_u32 m0, s64, 65536
    s_add_u32 s64, s58, 0
    buffer_load_dwordx4 v244, s[28:31], s64 offen nt lds
recurrent_scan__softmax_full_mha__moe_arch_mod__prompt_kernel_g_18:
    v_mfma_f32_32x32x16_bf16 v[92:107], v[132:135], v[4:7], 0
    v_exp_f32 v108, v108
    v_exp_f32 v109, v109
    v_exp_f32 v110, v110
    v_mfma_f32_32x32x16_bf16 v[60:75], v[192:195], v[40:43], v[60:75]
    s_add_u32 s50, s50, 4096
    buffer_load_dwordx4 v[156:159], v1, s[12:15], s50 offen offset:0
    v_exp_f32 v111, v111
    v_exp_f32 v112, v112
    v_exp_f32 v113, v113
    v_smfmac_f32_16x16x64_bf16 v[52:55], v[44:47], v[36:43], v48
    v_cvt_pk_bf16_f32 v36, v108, v109
    v_cvt_pk_bf16_f32 v37, v110, v111
    v_exp_f32 v114, v114
    v_exp_f32 v115, v115
    v_mfma_f32_32x32x16_bf16 v[92:107], v[136:139], v[8:11], v[92:107]
    v_cvt_pk_bf16_f32 v38, v112, v113
    v_cvt_pk_bf16_f32 v39, v114, v115
    v_exp_f32 v116, v116
    v_exp_f32 v117, v117
    v_mfma_f32_32x32x16_bf16 v[76:91], v[188:191], v[36:39], v[76:91]
    buffer_load_dwordx4 v[160:163], v1, s[12:15], s50 offen offset:1024
    v_exp_f32 v118, v118
    v_exp_f32 v119, v119
    v_cvt_pk_bf16_f32 v40, v116, v117
    v_exp_f32 v120, v120
    v_cvt_pk_bf16_f32 v41, v118, v119
    v_exp_f32 v121, v121
    v_exp_f32 v122, v122
    v_exp_f32 v123, v123
    v_cvt_pk_bf16_f32 v42, v120, v121
    v_cvt_pk_bf16_f32 v43, v122, v123
    s_barrier
    s_setprio 3
    v_mfma_f32_32x32x16_bf16 v[108:123], v[132:135], v[12:15], 0
    s_add_u32 s52, s52, 4096
    buffer_load_dwordx4 v[188:191], v1, s[12:15], s52 offen offset:2048
    v_exp_f32 v92, v92
    v_exp_f32 v93, v93
    v_exp_f32 v94, v94
    v_mfma_f32_32x32x16_bf16 v[76:91], v[192:195], v[40:43], v[76:91]
    v_exp_f32 v95, v95
    v_exp_f32 v96, v96
    v_exp_f32 v97, v97
    v_smfmac_f32_16x16x64_bf16 v[56:59], v[44:47], v[36:43], v48
    v_cvt_pk_bf16_f32 v36, v92, v93
    v_cvt_pk_bf16_f32 v37, v94, v95
    v_exp_f32 v98, v98
    v_exp_f32 v99, v99
    v_mfma_f32_32x32x16_bf16 v[108:123], v[136:139], v[16:19], v[108:123]
    buffer_load_dwordx4 v[192:195], v1, s[12:15], s52 offen offset:3072
    v_cvt_pk_bf16_f32 v38, v96, v97
    v_cvt_pk_bf16_f32 v39, v98, v99
    v_exp_f32 v100, v100
    v_exp_f32 v101, v101
    s_waitcnt vmcnt(13)
    v_mfma_f32_32x32x16_bf16 v[60:75], v[164:167], v[36:39], v[60:75]
    v_exp_f32 v102, v102
    v_exp_f32 v103, v103
    v_cvt_pk_bf16_f32 v40, v100, v101
    v_exp_f32 v104, v104
    v_cvt_pk_bf16_f32 v41, v102, v103
    v_exp_f32 v105, v105
    v_exp_f32 v106, v106
    v_exp_f32 v107, v107
    v_cvt_pk_bf16_f32 v42, v104, v105
    v_cvt_pk_bf16_f32 v43, v106, v107
    s_cmp_eq_u32 s59, 0
    s_cbranch_scc1 recurrent_scan__softmax_full_mha__moe_arch_mod__prompt_kernel_g_19
    s_lshl_b32 s64, s3, 12
    s_add_u32 m0, s64, 66560
    s_add_u32 s64, s58, 114688
    buffer_load_dwordx4 v244, s[28:31], s64 offen nt lds
recurrent_scan__softmax_full_mha__moe_arch_mod__prompt_kernel_g_19:
    s_waitcnt vmcnt(10)
    v_mfma_f32_32x32x16_bf16 v[92:107], v[140:143], v[4:7], 0
    v_exp_f32 v108, v108
    v_exp_f32 v109, v109
    v_exp_f32 v110, v110
    v_mfma_f32_32x32x16_bf16 v[60:75], v[168:171], v[40:43], v[60:75]
    s_and_b32 s54, s54, s55
    s_cbranch_scc1 recurrent_scan__softmax_full_mha__moe_arch_mod__prompt_kernel_nb_20
    s_call_b64 s[56:57], recurrent_scan__softmax_full_mha__moe_arch_mod__prompt_kernel_kvspin
recurrent_scan__softmax_full_mha__moe_arch_mod__prompt_kernel_nb_20:
    s_ff1_i32_b32 s51, s54
    s_bitset0_b32 s55, s51
    s_add_u32 s51, s51, s45
    s_and_b32 s51, s51, 15
    s_lshl_b32 s51, s51, 14
    s_add_u32 s51, s51, s63
    s_mov_b32 s50, s51
    buffer_load_dwordx4 v[132:135], v1, s[12:15], s50 offen offset:0
    v_exp_f32 v111, v111
    v_exp_f32 v112, v112
    v_exp_f32 v113, v113
    v_smfmac_f32_16x16x64_bf16 v[52:55], v[44:47], v[36:43], v48
    v_cvt_pk_bf16_f32 v36, v108, v109
    v_cvt_pk_bf16_f32 v37, v110, v111
    v_exp_f32 v114, v114
    v_exp_f32 v115, v115
    v_mfma_f32_32x32x16_bf16 v[92:107], v[144:147], v[8:11], v[92:107]
    v_cvt_pk_bf16_f32 v38, v112, v113
    v_cvt_pk_bf16_f32 v39, v114, v115
    v_exp_f32 v116, v116
    v_exp_f32 v117, v117
    v_mfma_f32_32x32x16_bf16 v[76:91], v[164:167], v[36:39], v[76:91]
    buffer_load_dwordx4 v[136:139], v1, s[12:15], s50 offen offset:1024
    v_exp_f32 v118, v118
    v_exp_f32 v119, v119
    v_cvt_pk_bf16_f32 v40, v116, v117
    v_exp_f32 v120, v120
    v_cvt_pk_bf16_f32 v41, v118, v119
    v_exp_f32 v121, v121
    v_exp_f32 v122, v122
    v_exp_f32 v123, v123
    v_cvt_pk_bf16_f32 v42, v120, v121
    v_cvt_pk_bf16_f32 v43, v122, v123
    s_setprio 2
    v_mfma_f32_32x32x16_bf16 v[108:123], v[140:143], v[12:15], 0
    s_mov_b32 s52, s51
    buffer_load_dwordx4 v[164:167], v1, s[12:15], s52 offen offset:2048
    v_exp_f32 v92, v92
    v_exp_f32 v93, v93
    v_exp_f32 v94, v94
    v_mfma_f32_32x32x16_bf16 v[76:91], v[168:171], v[40:43], v[76:91]
    v_exp_f32 v95, v95
    v_exp_f32 v96, v96
    v_exp_f32 v97, v97
    v_smfmac_f32_16x16x64_bf16 v[56:59], v[44:47], v[36:43], v48
    v_cvt_pk_bf16_f32 v36, v92, v93
    v_cvt_pk_bf16_f32 v37, v94, v95
    v_exp_f32 v98, v98
    v_exp_f32 v99, v99
    v_mfma_f32_32x32x16_bf16 v[108:123], v[144:147], v[16:19], v[108:123]
    buffer_load_dwordx4 v[168:171], v1, s[12:15], s52 offen offset:3072
    v_cvt_pk_bf16_f32 v38, v96, v97
    v_cvt_pk_bf16_f32 v39, v98, v99
    v_exp_f32 v100, v100
    v_exp_f32 v101, v101
    s_waitcnt vmcnt(13)
    v_mfma_f32_32x32x16_bf16 v[60:75], v[172:175], v[36:39], v[60:75]
    v_exp_f32 v102, v102
    v_exp_f32 v103, v103
    v_cvt_pk_bf16_f32 v40, v100, v101
    v_exp_f32 v104, v104
    v_cvt_pk_bf16_f32 v41, v102, v103
    v_exp_f32 v105, v105
    v_exp_f32 v106, v106
    v_exp_f32 v107, v107
    v_cvt_pk_bf16_f32 v42, v104, v105
    v_cvt_pk_bf16_f32 v43, v106, v107
    s_cmp_eq_u32 s59, 0
    s_cbranch_scc1 recurrent_scan__softmax_full_mha__moe_arch_mod__prompt_kernel_g_21
    s_lshl_b32 s64, s3, 12
    s_add_u32 m0, s64, 67584
    s_add_u32 s64, s58, 28672
    buffer_load_dwordx4 v244, s[28:31], s64 offen nt lds
recurrent_scan__softmax_full_mha__moe_arch_mod__prompt_kernel_g_21:
    s_waitcnt vmcnt(10)
    v_mfma_f32_32x32x16_bf16 v[92:107], v[148:151], v[4:7], 0
    v_exp_f32 v108, v108
    v_exp_f32 v109, v109
    v_exp_f32 v110, v110
    v_mfma_f32_32x32x16_bf16 v[60:75], v[176:179], v[40:43], v[60:75]
    s_add_u32 s50, s50, 4096
    buffer_load_dwordx4 v[140:143], v1, s[12:15], s50 offen offset:0
    v_exp_f32 v111, v111
    v_exp_f32 v112, v112
    v_exp_f32 v113, v113
    v_smfmac_f32_16x16x64_bf16 v[52:55], v[44:47], v[36:43], v48
    v_cvt_pk_bf16_f32 v36, v108, v109
    v_cvt_pk_bf16_f32 v37, v110, v111
    v_exp_f32 v114, v114
    v_exp_f32 v115, v115
    v_mfma_f32_32x32x16_bf16 v[92:107], v[152:155], v[8:11], v[92:107]
    v_cvt_pk_bf16_f32 v38, v112, v113
    v_cvt_pk_bf16_f32 v39, v114, v115
    v_exp_f32 v116, v116
    v_exp_f32 v117, v117
    v_mfma_f32_32x32x16_bf16 v[76:91], v[172:175], v[36:39], v[76:91]
    buffer_load_dwordx4 v[144:147], v1, s[12:15], s50 offen offset:1024
    v_exp_f32 v118, v118
    v_exp_f32 v119, v119
    v_cvt_pk_bf16_f32 v40, v116, v117
    v_exp_f32 v120, v120
    v_cvt_pk_bf16_f32 v41, v118, v119
    v_exp_f32 v121, v121
    v_exp_f32 v122, v122
    v_exp_f32 v123, v123
    v_cvt_pk_bf16_f32 v42, v120, v121
    v_cvt_pk_bf16_f32 v43, v122, v123
    s_setprio 1
    v_mfma_f32_32x32x16_bf16 v[108:123], v[148:151], v[12:15], 0
    s_add_u32 s52, s52, 4096
    buffer_load_dwordx4 v[172:175], v1, s[12:15], s52 offen offset:2048
    v_exp_f32 v92, v92
    v_exp_f32 v93, v93
    v_exp_f32 v94, v94
    v_mfma_f32_32x32x16_bf16 v[76:91], v[176:179], v[40:43], v[76:91]
    v_exp_f32 v95, v95
    v_exp_f32 v96, v96
    v_exp_f32 v97, v97
    v_smfmac_f32_16x16x64_bf16 v[56:59], v[44:47], v[36:43], v48
    v_cvt_pk_bf16_f32 v36, v92, v93
    v_cvt_pk_bf16_f32 v37, v94, v95
    v_exp_f32 v98, v98
    v_exp_f32 v99, v99
    v_mfma_f32_32x32x16_bf16 v[108:123], v[152:155], v[16:19], v[108:123]
    buffer_load_dwordx4 v[176:179], v1, s[12:15], s52 offen offset:3072
    v_cvt_pk_bf16_f32 v38, v96, v97
    v_cvt_pk_bf16_f32 v39, v98, v99
    v_exp_f32 v100, v100
    v_exp_f32 v101, v101
    s_waitcnt vmcnt(13)
    v_mfma_f32_32x32x16_bf16 v[60:75], v[180:183], v[36:39], v[60:75]
    v_exp_f32 v102, v102
    v_exp_f32 v103, v103
    v_cvt_pk_bf16_f32 v40, v100, v101
    v_exp_f32 v104, v104
    v_cvt_pk_bf16_f32 v41, v102, v103
    v_exp_f32 v105, v105
    v_exp_f32 v106, v106
    v_exp_f32 v107, v107
    v_cvt_pk_bf16_f32 v42, v104, v105
    v_cvt_pk_bf16_f32 v43, v106, v107
    s_cmp_eq_u32 s59, 0
    s_cbranch_scc1 recurrent_scan__softmax_full_mha__moe_arch_mod__prompt_kernel_g_22
    s_lshl_b32 s64, s3, 12
    s_add_u32 m0, s64, 68608
    s_add_u32 s64, s58, 143360
    buffer_load_dwordx4 v244, s[28:31], s64 offen nt lds
recurrent_scan__softmax_full_mha__moe_arch_mod__prompt_kernel_g_22:
    s_waitcnt vmcnt(10)
    v_mfma_f32_32x32x16_bf16 v[92:107], v[156:159], v[4:7], 0
    v_exp_f32 v108, v108
    v_exp_f32 v109, v109
    v_exp_f32 v110, v110
    v_mfma_f32_32x32x16_bf16 v[60:75], v[184:187], v[40:43], v[60:75]
    s_and_b32 s54, s54, s55
    s_cbranch_scc1 recurrent_scan__softmax_full_mha__moe_arch_mod__prompt_kernel_nb_23
    s_call_b64 s[56:57], recurrent_scan__softmax_full_mha__moe_arch_mod__prompt_kernel_kvspin
recurrent_scan__softmax_full_mha__moe_arch_mod__prompt_kernel_nb_23:
    s_ff1_i32_b32 s51, s54
    s_bitset0_b32 s55, s51
    s_add_u32 s51, s51, s45
    s_and_b32 s51, s51, 15
    s_lshl_b32 s51, s51, 14
    s_add_u32 s51, s51, s63
    s_mov_b32 s50, s51
    buffer_load_dwordx4 v[148:151], v1, s[12:15], s50 offen offset:0
    v_exp_f32 v111, v111
    v_exp_f32 v112, v112
    v_exp_f32 v113, v113
    v_smfmac_f32_16x16x64_bf16 v[52:55], v[44:47], v[36:43], v48
    v_cvt_pk_bf16_f32 v36, v108, v109
    v_cvt_pk_bf16_f32 v37, v110, v111
    v_exp_f32 v114, v114
    v_exp_f32 v115, v115
    v_mfma_f32_32x32x16_bf16 v[92:107], v[160:163], v[8:11], v[92:107]
    v_cvt_pk_bf16_f32 v38, v112, v113
    v_cvt_pk_bf16_f32 v39, v114, v115
    v_exp_f32 v116, v116
    v_exp_f32 v117, v117
    v_mfma_f32_32x32x16_bf16 v[76:91], v[180:183], v[36:39], v[76:91]
    buffer_load_dwordx4 v[152:155], v1, s[12:15], s50 offen offset:1024
    v_exp_f32 v118, v118
    v_exp_f32 v119, v119
    v_cvt_pk_bf16_f32 v40, v116, v117
    v_exp_f32 v120, v120
    v_cvt_pk_bf16_f32 v41, v118, v119
    v_exp_f32 v121, v121
    v_exp_f32 v122, v122
    v_exp_f32 v123, v123
    v_cvt_pk_bf16_f32 v42, v120, v121
    v_cvt_pk_bf16_f32 v43, v122, v123
    s_setprio 0
    v_mfma_f32_32x32x16_bf16 v[108:123], v[156:159], v[12:15], 0
    s_mov_b32 s52, s51
    buffer_load_dwordx4 v[180:183], v1, s[12:15], s52 offen offset:2048
    v_exp_f32 v92, v92
    v_exp_f32 v93, v93
    v_exp_f32 v94, v94
    v_mfma_f32_32x32x16_bf16 v[76:91], v[184:187], v[40:43], v[76:91]
    v_exp_f32 v95, v95
    v_exp_f32 v96, v96
    v_exp_f32 v97, v97
    v_smfmac_f32_16x16x64_bf16 v[56:59], v[44:47], v[36:43], v48
    v_cvt_pk_bf16_f32 v36, v92, v93
    v_cvt_pk_bf16_f32 v37, v94, v95
    v_exp_f32 v98, v98
    v_exp_f32 v99, v99
    v_mfma_f32_32x32x16_bf16 v[108:123], v[160:163], v[16:19], v[108:123]
    buffer_load_dwordx4 v[184:187], v1, s[12:15], s52 offen offset:3072
    v_cvt_pk_bf16_f32 v38, v96, v97
    v_cvt_pk_bf16_f32 v39, v98, v99
    v_exp_f32 v100, v100
    v_exp_f32 v101, v101
    s_waitcnt vmcnt(13)
    v_mfma_f32_32x32x16_bf16 v[60:75], v[188:191], v[36:39], v[60:75]
    v_exp_f32 v102, v102
    v_exp_f32 v103, v103
    v_cvt_pk_bf16_f32 v40, v100, v101
    v_exp_f32 v104, v104
    v_cvt_pk_bf16_f32 v41, v102, v103
    v_exp_f32 v105, v105
    v_exp_f32 v106, v106
    v_exp_f32 v107, v107
    v_cvt_pk_bf16_f32 v42, v104, v105
    v_cvt_pk_bf16_f32 v43, v106, v107
    s_waitcnt vmcnt(10)
    v_mfma_f32_32x32x16_bf16 v[92:107], v[132:135], v[4:7], 0
    v_exp_f32 v108, v108
    v_exp_f32 v109, v109
    v_exp_f32 v110, v110
    v_mfma_f32_32x32x16_bf16 v[60:75], v[192:195], v[40:43], v[60:75]
    s_add_u32 s50, s50, 4096
    buffer_load_dwordx4 v[156:159], v1, s[12:15], s50 offen offset:0
    v_exp_f32 v111, v111
    v_exp_f32 v112, v112
    v_exp_f32 v113, v113
    v_smfmac_f32_16x16x64_bf16 v[52:55], v[44:47], v[36:43], v48
    v_cvt_pk_bf16_f32 v36, v108, v109
    v_cvt_pk_bf16_f32 v37, v110, v111
    v_exp_f32 v114, v114
    v_exp_f32 v115, v115
    v_mfma_f32_32x32x16_bf16 v[92:107], v[136:139], v[8:11], v[92:107]
    v_cvt_pk_bf16_f32 v38, v112, v113
    v_cvt_pk_bf16_f32 v39, v114, v115
    v_exp_f32 v116, v116
    v_exp_f32 v117, v117
    v_mfma_f32_32x32x16_bf16 v[76:91], v[188:191], v[36:39], v[76:91]
    buffer_load_dwordx4 v[160:163], v1, s[12:15], s50 offen offset:1024
    v_exp_f32 v118, v118
    v_exp_f32 v119, v119
    v_cvt_pk_bf16_f32 v40, v116, v117
    v_exp_f32 v120, v120
    v_cvt_pk_bf16_f32 v41, v118, v119
    v_exp_f32 v121, v121
    v_exp_f32 v122, v122
    v_exp_f32 v123, v123
    v_cvt_pk_bf16_f32 v42, v120, v121
    v_cvt_pk_bf16_f32 v43, v122, v123
    s_waitcnt vmcnt(6)
    s_barrier
    s_setprio 3
    s_cmp_eq_u32 s59, 0
    s_cbranch_scc1 recurrent_scan__softmax_full_mha__moe_arch_mod__prompt_kernel_g_24
    s_mul_i32 s66, s47, 28
    s_add_u32 s66, s66, s46
    s_and_b32 s64, s66, 3
    s_lshl_b32 s64, s64, 12
    s_add_u32 s64, s64, 139264
    v_and_b32 v248, 7, v0
    v_lshlrev_b32 v248, 4, v248
    v_lshrrev_b32 v249, 4, v0
    v_lshl_add_u32 v248, v249, 7, v248
    v_add_u32 v248, s64, v248
    s_lshl_b32 s64, s48, 15
    s_add_u32 s64, s64, 32768
    v_add_u32 v250, s64, v243
    ds_read_b128 v[220:223], v248 offset:0
    ds_read_b64_tr_b16 v[20:21], v250 offset:0
    ds_read_b64_tr_b16 v[22:23], v250 offset:2048
    ds_read_b128 v[224:227], v248 offset:512
    ds_read_b64_tr_b16 v[24:25], v250 offset:4096
    ds_read_b64_tr_b16 v[26:27], v250 offset:6144
    ds_read_b128 v[228:231], v248 offset:1024
    ds_read_b64_tr_b16 v[28:29], v250 offset:8192
    ds_read_b64_tr_b16 v[30:31], v250 offset:10240
    ds_read_b128 v[232:235], v248 offset:1536
    ds_read_b64_tr_b16 v[32:33], v250 offset:12288
    ds_read_b64_tr_b16 v[34:35], v250 offset:14336
recurrent_scan__softmax_full_mha__moe_arch_mod__prompt_kernel_g_24:
    v_mfma_f32_32x32x16_bf16 v[108:123], v[132:135], v[12:15], 0
    s_add_u32 s52, s52, 4096
    buffer_load_dwordx4 v[188:191], v1, s[12:15], s52 offen offset:2048
    v_exp_f32 v92, v92
    v_exp_f32 v93, v93
    v_exp_f32 v94, v94
    v_mfma_f32_32x32x16_bf16 v[76:91], v[192:195], v[40:43], v[76:91]
    v_exp_f32 v95, v95
    v_exp_f32 v96, v96
    v_exp_f32 v97, v97
    v_smfmac_f32_16x16x64_bf16 v[56:59], v[44:47], v[36:43], v48
    v_cvt_pk_bf16_f32 v36, v92, v93
    v_cvt_pk_bf16_f32 v37, v94, v95
    v_exp_f32 v98, v98
    v_exp_f32 v99, v99
    v_mfma_f32_32x32x16_bf16 v[108:123], v[136:139], v[16:19], v[108:123]
    buffer_load_dwordx4 v[192:195], v1, s[12:15], s52 offen offset:3072
    v_cvt_pk_bf16_f32 v38, v96, v97
    v_cvt_pk_bf16_f32 v39, v98, v99
    v_exp_f32 v100, v100
    v_exp_f32 v101, v101
    v_mfma_f32_32x32x16_bf16 v[60:75], v[164:167], v[36:39], v[60:75]
    v_exp_f32 v102, v102
    v_exp_f32 v103, v103
    v_cvt_pk_bf16_f32 v40, v100, v101
    v_exp_f32 v104, v104
    v_cvt_pk_bf16_f32 v41, v102, v103
    v_exp_f32 v105, v105
    v_exp_f32 v106, v106
    v_exp_f32 v107, v107
    v_cvt_pk_bf16_f32 v42, v104, v105
    v_cvt_pk_bf16_f32 v43, v106, v107
    s_cmp_eq_u32 s59, 0
    s_cbranch_scc1 recurrent_scan__softmax_full_mha__moe_arch_mod__prompt_kernel_g_25
    s_waitcnt lgkmcnt(0)
    v_mfma_f32_16x16x32_bf16 v[236:239], v[220:223], v[20:23], 0
    v_mfma_f32_16x16x32_bf16 v[236:239], v[224:227], v[24:27], v[236:239]
    v_mfma_f32_16x16x32_bf16 v[236:239], v[228:231], v[28:31], v[236:239]
    v_mfma_f32_16x16x32_bf16 v[236:239], v[232:235], v[32:35], v[236:239]
    ds_read_b128 v[220:223], v248 offset:2048
    ds_read_b64_tr_b16 v[20:21], v250 offset:16384
    ds_read_b64_tr_b16 v[22:23], v250 offset:18432
    ds_read_b128 v[224:227], v248 offset:2560
    ds_read_b64_tr_b16 v[24:25], v250 offset:20480
    ds_read_b64_tr_b16 v[26:27], v250 offset:22528
    ds_read_b128 v[228:231], v248 offset:3072
    ds_read_b64_tr_b16 v[28:29], v250 offset:24576
    ds_read_b64_tr_b16 v[30:31], v250 offset:26624
    ds_read_b128 v[232:235], v248 offset:3584
    ds_read_b64_tr_b16 v[32:33], v250 offset:28672
    ds_read_b64_tr_b16 v[34:35], v250 offset:30720
recurrent_scan__softmax_full_mha__moe_arch_mod__prompt_kernel_g_25:
    v_mfma_f32_32x32x16_bf16 v[92:107], v[140:143], v[4:7], 0
    v_exp_f32 v108, v108
    v_exp_f32 v109, v109
    v_exp_f32 v110, v110
    v_mfma_f32_32x32x16_bf16 v[60:75], v[168:171], v[40:43], v[60:75]
    s_and_b32 s54, s54, s55
    s_cbranch_scc1 recurrent_scan__softmax_full_mha__moe_arch_mod__prompt_kernel_nb_26
    s_call_b64 s[56:57], recurrent_scan__softmax_full_mha__moe_arch_mod__prompt_kernel_kvspin
recurrent_scan__softmax_full_mha__moe_arch_mod__prompt_kernel_nb_26:
    s_ff1_i32_b32 s51, s54
    s_bitset0_b32 s55, s51
    s_add_u32 s51, s51, s45
    s_and_b32 s51, s51, 15
    s_lshl_b32 s51, s51, 14
    s_add_u32 s51, s51, s63
    s_mov_b32 s50, s51
    buffer_load_dwordx4 v[132:135], v1, s[12:15], s50 offen offset:0
    v_exp_f32 v111, v111
    v_exp_f32 v112, v112
    v_exp_f32 v113, v113
    v_smfmac_f32_16x16x64_bf16 v[52:55], v[44:47], v[36:43], v48
    v_cvt_pk_bf16_f32 v36, v108, v109
    v_cvt_pk_bf16_f32 v37, v110, v111
    v_exp_f32 v114, v114
    v_exp_f32 v115, v115
    v_mfma_f32_32x32x16_bf16 v[92:107], v[144:147], v[8:11], v[92:107]
    v_cvt_pk_bf16_f32 v38, v112, v113
    v_cvt_pk_bf16_f32 v39, v114, v115
    v_exp_f32 v116, v116
    v_exp_f32 v117, v117
    v_mfma_f32_32x32x16_bf16 v[76:91], v[164:167], v[36:39], v[76:91]
    buffer_load_dwordx4 v[136:139], v1, s[12:15], s50 offen offset:1024
    v_exp_f32 v118, v118
    v_exp_f32 v119, v119
    v_cvt_pk_bf16_f32 v40, v116, v117
    v_exp_f32 v120, v120
    v_cvt_pk_bf16_f32 v41, v118, v119
    v_exp_f32 v121, v121
    v_exp_f32 v122, v122
    v_exp_f32 v123, v123
    v_cvt_pk_bf16_f32 v42, v120, v121
    v_cvt_pk_bf16_f32 v43, v122, v123
    s_setprio 2
    s_cmp_eq_u32 s59, 0
    s_cbranch_scc1 recurrent_scan__softmax_full_mha__moe_arch_mod__prompt_kernel_g_27
    s_waitcnt lgkmcnt(0)
    v_mfma_f32_16x16x32_bf16 v[236:239], v[220:223], v[20:23], v[236:239]
    v_mfma_f32_16x16x32_bf16 v[236:239], v[224:227], v[24:27], v[236:239]
    v_mfma_f32_16x16x32_bf16 v[236:239], v[228:231], v[28:31], v[236:239]
    v_mfma_f32_16x16x32_bf16 v[236:239], v[232:235], v[32:35], v[236:239]
    v_mul_u32_u24 v249, 57344, v249
    v_and_b32 v248, 15, v0
    v_lshl_add_u32 v248, v248, 2, v249
recurrent_scan__softmax_full_mha__moe_arch_mod__prompt_kernel_g_27:
    v_mfma_f32_32x32x16_bf16 v[108:123], v[140:143], v[12:15], 0
    s_mov_b32 s52, s51
    buffer_load_dwordx4 v[164:167], v1, s[12:15], s52 offen offset:2048
    v_exp_f32 v92, v92
    v_exp_f32 v93, v93
    v_exp_f32 v94, v94
    v_mfma_f32_32x32x16_bf16 v[76:91], v[168:171], v[40:43], v[76:91]
    v_exp_f32 v95, v95
    v_exp_f32 v96, v96
    v_exp_f32 v97, v97
    v_smfmac_f32_16x16x64_bf16 v[56:59], v[44:47], v[36:43], v48
    v_cvt_pk_bf16_f32 v36, v92, v93
    v_cvt_pk_bf16_f32 v37, v94, v95
    v_exp_f32 v98, v98
    v_exp_f32 v99, v99
    v_mfma_f32_32x32x16_bf16 v[108:123], v[144:147], v[16:19], v[108:123]
    buffer_load_dwordx4 v[168:171], v1, s[12:15], s52 offen offset:3072
    v_cvt_pk_bf16_f32 v38, v96, v97
    v_cvt_pk_bf16_f32 v39, v98, v99
    v_exp_f32 v100, v100
    v_exp_f32 v101, v101
    v_mfma_f32_32x32x16_bf16 v[60:75], v[172:175], v[36:39], v[60:75]
    v_exp_f32 v102, v102
    v_exp_f32 v103, v103
    v_cvt_pk_bf16_f32 v40, v100, v101
    v_exp_f32 v104, v104
    v_cvt_pk_bf16_f32 v41, v102, v103
    v_exp_f32 v105, v105
    v_exp_f32 v106, v106
    v_exp_f32 v107, v107
    v_cvt_pk_bf16_f32 v42, v104, v105
    v_cvt_pk_bf16_f32 v43, v106, v107
    s_cmp_eq_u32 s59, 0
    s_cbranch_scc1 recurrent_scan__softmax_full_mha__moe_arch_mod__prompt_kernel_g_28
    s_mul_i32 s66, s47, 28
    s_add_u32 s66, s66, s46
    s_lshr_b32 s64, s66, 2
    s_lshl_b32 s64, s64, 8
    s_and_b32 s65, s3, 3
    s_lshl_b32 s65, s65, 6
    s_add_u32 s64, s64, s65
    s_mul_i32 s65, s48, 114688
    s_add_u32 s64, s64, s65
    s_add_u32 s64, s64, 22020096
    s_bfm_b64 exec, 32, 0
    s_add_u32 s65, s64, 0
    buffer_atomic_add_f32 v236, v248, s[12:15], s65 offen
    s_add_u32 s65, s64, 14336
    buffer_atomic_add_f32 v237, v248, s[12:15], s65 offen
    s_add_u32 s65, s64, 28672
    buffer_atomic_add_f32 v238, v248, s[12:15], s65 offen
    s_add_u32 s65, s64, 43008
    buffer_atomic_add_f32 v239, v248, s[12:15], s65 offen
    s_mov_b64 exec, -1
recurrent_scan__softmax_full_mha__moe_arch_mod__prompt_kernel_g_28:
    s_waitcnt vmcnt(10)
    v_mfma_f32_32x32x16_bf16 v[92:107], v[148:151], v[4:7], 0
    v_exp_f32 v108, v108
    v_exp_f32 v109, v109
    v_exp_f32 v110, v110
    v_mfma_f32_32x32x16_bf16 v[60:75], v[176:179], v[40:43], v[60:75]
    s_add_u32 s50, s50, 4096
    buffer_load_dwordx4 v[140:143], v1, s[12:15], s50 offen offset:0
    v_exp_f32 v111, v111
    v_exp_f32 v112, v112
    v_exp_f32 v113, v113
    v_smfmac_f32_16x16x64_bf16 v[52:55], v[44:47], v[36:43], v48
    v_cvt_pk_bf16_f32 v36, v108, v109
    v_cvt_pk_bf16_f32 v37, v110, v111
    v_exp_f32 v114, v114
    v_exp_f32 v115, v115
    v_mfma_f32_32x32x16_bf16 v[92:107], v[152:155], v[8:11], v[92:107]
    v_cvt_pk_bf16_f32 v38, v112, v113
    v_cvt_pk_bf16_f32 v39, v114, v115
    v_exp_f32 v116, v116
    v_exp_f32 v117, v117
    v_mfma_f32_32x32x16_bf16 v[76:91], v[172:175], v[36:39], v[76:91]
    buffer_load_dwordx4 v[144:147], v1, s[12:15], s50 offen offset:1024
    v_exp_f32 v118, v118
    v_exp_f32 v119, v119
    v_cvt_pk_bf16_f32 v40, v116, v117
    v_exp_f32 v120, v120
    v_cvt_pk_bf16_f32 v41, v118, v119
    v_exp_f32 v121, v121
    v_exp_f32 v122, v122
    v_exp_f32 v123, v123
    v_cvt_pk_bf16_f32 v42, v120, v121
    v_cvt_pk_bf16_f32 v43, v122, v123
    s_setprio 1
    v_mfma_f32_32x32x16_bf16 v[108:123], v[148:151], v[12:15], 0
    s_add_u32 s52, s52, 4096
    buffer_load_dwordx4 v[172:175], v1, s[12:15], s52 offen offset:2048
    v_exp_f32 v92, v92
    v_exp_f32 v93, v93
    v_exp_f32 v94, v94
    v_mfma_f32_32x32x16_bf16 v[76:91], v[176:179], v[40:43], v[76:91]
    v_exp_f32 v95, v95
    v_exp_f32 v96, v96
    v_exp_f32 v97, v97
    v_smfmac_f32_16x16x64_bf16 v[56:59], v[44:47], v[36:43], v48
    v_cvt_pk_bf16_f32 v36, v92, v93
    v_cvt_pk_bf16_f32 v37, v94, v95
    v_exp_f32 v98, v98
    v_exp_f32 v99, v99
    v_mfma_f32_32x32x16_bf16 v[108:123], v[152:155], v[16:19], v[108:123]
    buffer_load_dwordx4 v[176:179], v1, s[12:15], s52 offen offset:3072
    v_cvt_pk_bf16_f32 v38, v96, v97
    v_cvt_pk_bf16_f32 v39, v98, v99
    v_exp_f32 v100, v100
    v_exp_f32 v101, v101
    s_waitcnt vmcnt(13)
    v_mfma_f32_32x32x16_bf16 v[60:75], v[180:183], v[36:39], v[60:75]
    v_exp_f32 v102, v102
    v_exp_f32 v103, v103
    v_cvt_pk_bf16_f32 v40, v100, v101
    v_exp_f32 v104, v104
    v_cvt_pk_bf16_f32 v41, v102, v103
    v_exp_f32 v105, v105
    v_exp_f32 v106, v106
    v_exp_f32 v107, v107
    v_cvt_pk_bf16_f32 v42, v104, v105
    v_cvt_pk_bf16_f32 v43, v106, v107
    s_waitcnt vmcnt(10)
    v_mfma_f32_32x32x16_bf16 v[92:107], v[156:159], v[4:7], 0
    v_exp_f32 v108, v108
    v_exp_f32 v109, v109
    v_exp_f32 v110, v110
    v_mfma_f32_32x32x16_bf16 v[60:75], v[184:187], v[40:43], v[60:75]
    s_and_b32 s54, s54, s55
    s_cbranch_scc1 recurrent_scan__softmax_full_mha__moe_arch_mod__prompt_kernel_nb_29
    s_call_b64 s[56:57], recurrent_scan__softmax_full_mha__moe_arch_mod__prompt_kernel_kvspin
recurrent_scan__softmax_full_mha__moe_arch_mod__prompt_kernel_nb_29:
    s_ff1_i32_b32 s51, s54
    s_bitset0_b32 s55, s51
    s_add_u32 s51, s51, s45
    s_and_b32 s51, s51, 15
    s_lshl_b32 s51, s51, 14
    s_add_u32 s51, s51, s63
    s_mov_b32 s50, s51
    buffer_load_dwordx4 v[148:151], v1, s[12:15], s50 offen offset:0
    v_exp_f32 v111, v111
    v_exp_f32 v112, v112
    v_exp_f32 v113, v113
    v_smfmac_f32_16x16x64_bf16 v[52:55], v[44:47], v[36:43], v48
    v_cvt_pk_bf16_f32 v36, v108, v109
    v_cvt_pk_bf16_f32 v37, v110, v111
    v_exp_f32 v114, v114
    v_exp_f32 v115, v115
    v_mfma_f32_32x32x16_bf16 v[92:107], v[160:163], v[8:11], v[92:107]
    v_cvt_pk_bf16_f32 v38, v112, v113
    v_cvt_pk_bf16_f32 v39, v114, v115
    v_exp_f32 v116, v116
    v_exp_f32 v117, v117
    v_mfma_f32_32x32x16_bf16 v[76:91], v[180:183], v[36:39], v[76:91]
    buffer_load_dwordx4 v[152:155], v1, s[12:15], s50 offen offset:1024
    v_exp_f32 v118, v118
    v_exp_f32 v119, v119
    v_cvt_pk_bf16_f32 v40, v116, v117
    v_exp_f32 v120, v120
    v_cvt_pk_bf16_f32 v41, v118, v119
    v_exp_f32 v121, v121
    v_exp_f32 v122, v122
    v_exp_f32 v123, v123
    v_cvt_pk_bf16_f32 v42, v120, v121
    v_cvt_pk_bf16_f32 v43, v122, v123
    s_setprio 0
    s_waitcnt vmcnt(6)
    s_cmp_eq_u32 s59, 0
    s_cbranch_scc1 recurrent_scan__softmax_full_mha__moe_arch_mod__prompt_kernel_g_30
    s_mul_i32 s64, s47, 28
    s_add_u32 s64, s64, s46
    s_lshr_b32 s64, s64, 2
    s_lshl_b32 s64, s64, 7
    s_add_u32 s64, s64, 21446656
    v_mov_b32 v248, s64
    v_mov_b32 v249, 1
    s_mov_b64 exec, 1
    buffer_atomic_add v249, v248, s[12:15], 0 offen sc1
    s_mov_b64 exec, -1
recurrent_scan__softmax_full_mha__moe_arch_mod__prompt_kernel_g_30:
    v_mfma_f32_32x32x16_bf16 v[108:123], v[156:159], v[12:15], 0
    s_mov_b32 s52, s51
    buffer_load_dwordx4 v[180:183], v1, s[12:15], s52 offen offset:2048
    v_exp_f32 v92, v92
    v_exp_f32 v93, v93
    v_exp_f32 v94, v94
    v_mfma_f32_32x32x16_bf16 v[76:91], v[184:187], v[40:43], v[76:91]
    v_exp_f32 v95, v95
    v_exp_f32 v96, v96
    v_exp_f32 v97, v97
    v_smfmac_f32_16x16x64_bf16 v[56:59], v[44:47], v[36:43], v48
    v_cvt_pk_bf16_f32 v36, v92, v93
    v_cvt_pk_bf16_f32 v37, v94, v95
    v_exp_f32 v98, v98
    v_exp_f32 v99, v99
    v_mfma_f32_32x32x16_bf16 v[108:123], v[160:163], v[16:19], v[108:123]
    buffer_load_dwordx4 v[184:187], v1, s[12:15], s52 offen offset:3072
    v_cvt_pk_bf16_f32 v38, v96, v97
    v_cvt_pk_bf16_f32 v39, v98, v99
    v_exp_f32 v100, v100
    v_exp_f32 v101, v101
    v_mfma_f32_32x32x16_bf16 v[60:75], v[188:191], v[36:39], v[60:75]
    v_exp_f32 v102, v102
    v_exp_f32 v103, v103
    v_cvt_pk_bf16_f32 v40, v100, v101
    v_exp_f32 v104, v104
    v_cvt_pk_bf16_f32 v41, v102, v103
    v_exp_f32 v105, v105
    v_exp_f32 v106, v106
    v_exp_f32 v107, v107
    v_cvt_pk_bf16_f32 v42, v104, v105
    v_cvt_pk_bf16_f32 v43, v106, v107
    v_mfma_f32_32x32x16_bf16 v[92:107], v[132:135], v[4:7], 0
    v_exp_f32 v108, v108
    v_exp_f32 v109, v109
    v_exp_f32 v110, v110
    v_mfma_f32_32x32x16_bf16 v[60:75], v[192:195], v[40:43], v[60:75]
    s_add_u32 s50, s50, 4096
    buffer_load_dwordx4 v[156:159], v1, s[12:15], s50 offen offset:0
    v_exp_f32 v111, v111
    v_exp_f32 v112, v112
    v_exp_f32 v113, v113
    v_smfmac_f32_16x16x64_bf16 v[52:55], v[44:47], v[36:43], v48
    v_cvt_pk_bf16_f32 v36, v108, v109
    v_cvt_pk_bf16_f32 v37, v110, v111
    v_exp_f32 v114, v114
    v_exp_f32 v115, v115
    v_mfma_f32_32x32x16_bf16 v[92:107], v[136:139], v[8:11], v[92:107]
    v_cvt_pk_bf16_f32 v38, v112, v113
    v_cvt_pk_bf16_f32 v39, v114, v115
    v_exp_f32 v116, v116
    v_exp_f32 v117, v117
    v_mfma_f32_32x32x16_bf16 v[76:91], v[188:191], v[36:39], v[76:91]
    buffer_load_dwordx4 v[160:163], v1, s[12:15], s50 offen offset:1024
    v_exp_f32 v118, v118
    v_exp_f32 v119, v119
    v_cvt_pk_bf16_f32 v40, v116, v117
    v_exp_f32 v120, v120
    v_cvt_pk_bf16_f32 v41, v118, v119
    v_exp_f32 v121, v121
    v_exp_f32 v122, v122
    v_exp_f32 v123, v123
    v_cvt_pk_bf16_f32 v42, v120, v121
    v_cvt_pk_bf16_f32 v43, v122, v123
    s_barrier
    s_setprio 3
    s_lshl_b32 s64, s3, 10
    s_add_u32 m0, s64, 131072
    s_add_u32 s64, s60, 0
    buffer_load_dwordx4 v245, s[32:35], s64 offen nt lds
recurrent_scan__softmax_full_mha__moe_arch_mod__prompt_kernel_s2d_31:
    v_lshrrev_b32 v244, 3, v0
    v_lshlrev_b32 v244, 11, v244
    v_bfe_u32 v248, v0, 4, 1
    s_bfe_u32 s64, s3, 0x10001
    s_lshl_b32 s64, s64, 1
    v_or_b32 v248, s64, v248
    v_lshlrev_b32 v248, 1, v248
    v_and_b32 v249, 7, v0
    v_xor_b32 v248, v248, v249
    v_lshl_add_u32 v244, v248, 4, v244
    s_lshl_b32 s61, s3, 14
    s_lshl_b32 s64, s44, 7
    s_add_u32 s61, s61, s64
    s_lshl_b32 s62, s3, 10
    v_mfma_f32_32x32x16_bf16 v[108:123], v[132:135], v[12:15], 0
    s_add_u32 s52, s52, 4096
    buffer_load_dwordx4 v[188:191], v1, s[12:15], s52 offen offset:2048
    v_exp_f32 v92, v92
    v_exp_f32 v93, v93
    v_exp_f32 v94, v94
    v_mfma_f32_32x32x16_bf16 v[76:91], v[192:195], v[40:43], v[76:91]
    v_exp_f32 v95, v95
    v_exp_f32 v96, v96
    v_exp_f32 v97, v97
    v_smfmac_f32_16x16x64_bf16 v[56:59], v[44:47], v[36:43], v48
    v_cvt_pk_bf16_f32 v36, v92, v93
    v_cvt_pk_bf16_f32 v37, v94, v95
    v_exp_f32 v98, v98
    v_exp_f32 v99, v99
    v_mfma_f32_32x32x16_bf16 v[108:123], v[136:139], v[16:19], v[108:123]
    buffer_load_dwordx4 v[192:195], v1, s[12:15], s52 offen offset:3072
    v_cvt_pk_bf16_f32 v38, v96, v97
    v_cvt_pk_bf16_f32 v39, v98, v99
    v_exp_f32 v100, v100
    v_exp_f32 v101, v101
    v_mfma_f32_32x32x16_bf16 v[60:75], v[164:167], v[36:39], v[60:75]
    v_exp_f32 v102, v102
    v_exp_f32 v103, v103
    v_cvt_pk_bf16_f32 v40, v100, v101
    v_exp_f32 v104, v104
    v_cvt_pk_bf16_f32 v41, v102, v103
    v_exp_f32 v105, v105
    v_exp_f32 v106, v106
    v_exp_f32 v107, v107
    v_cvt_pk_bf16_f32 v42, v104, v105
    v_cvt_pk_bf16_f32 v43, v106, v107
    s_waitcnt vmcnt(11)
    v_mfma_f32_32x32x16_bf16 v[92:107], v[140:143], v[4:7], 0
    v_exp_f32 v108, v108
    v_exp_f32 v109, v109
    v_exp_f32 v110, v110
    v_mfma_f32_32x32x16_bf16 v[60:75], v[168:171], v[40:43], v[60:75]
    s_and_b32 s54, s54, s55
    s_cbranch_scc1 recurrent_scan__softmax_full_mha__moe_arch_mod__prompt_kernel_nb_32
    s_call_b64 s[56:57], recurrent_scan__softmax_full_mha__moe_arch_mod__prompt_kernel_kvspin
recurrent_scan__softmax_full_mha__moe_arch_mod__prompt_kernel_nb_32:
    s_ff1_i32_b32 s51, s54
    s_bitset0_b32 s55, s51
    s_add_u32 s51, s51, s45
    s_and_b32 s51, s51, 15
    s_lshl_b32 s51, s51, 14
    s_add_u32 s51, s51, s63
    s_mov_b32 s50, s51
    buffer_load_dwordx4 v[132:135], v1, s[12:15], s50 offen offset:0
    v_exp_f32 v111, v111
    v_exp_f32 v112, v112
    v_exp_f32 v113, v113
    v_smfmac_f32_16x16x64_bf16 v[52:55], v[44:47], v[36:43], v48
    v_cvt_pk_bf16_f32 v36, v108, v109
    v_cvt_pk_bf16_f32 v37, v110, v111
    v_exp_f32 v114, v114
    v_exp_f32 v115, v115
    v_mfma_f32_32x32x16_bf16 v[92:107], v[144:147], v[8:11], v[92:107]
    v_cvt_pk_bf16_f32 v38, v112, v113
    v_cvt_pk_bf16_f32 v39, v114, v115
    v_exp_f32 v116, v116
    v_exp_f32 v117, v117
    v_mfma_f32_32x32x16_bf16 v[76:91], v[164:167], v[36:39], v[76:91]
    buffer_load_dwordx4 v[136:139], v1, s[12:15], s50 offen offset:1024
    v_exp_f32 v118, v118
    v_exp_f32 v119, v119
    v_cvt_pk_bf16_f32 v40, v116, v117
    v_exp_f32 v120, v120
    v_cvt_pk_bf16_f32 v41, v118, v119
    v_exp_f32 v121, v121
    v_exp_f32 v122, v122
    v_exp_f32 v123, v123
    v_cvt_pk_bf16_f32 v42, v120, v121
    v_cvt_pk_bf16_f32 v43, v122, v123
    s_setprio 2
    s_lshl_b32 s64, s3, 10
    s_add_u32 m0, s64, 139264
    s_add_u32 s64, s60, 131072
    buffer_load_dwordx4 v245, s[32:35], s64 offen nt lds
recurrent_scan__softmax_full_mha__moe_arch_mod__prompt_kernel_s2d_33:
    v_mfma_f32_32x32x16_bf16 v[108:123], v[140:143], v[12:15], 0
    s_mov_b32 s52, s51
    buffer_load_dwordx4 v[164:167], v1, s[12:15], s52 offen offset:2048
    v_exp_f32 v92, v92
    v_exp_f32 v93, v93
    v_exp_f32 v94, v94
    v_mfma_f32_32x32x16_bf16 v[76:91], v[168:171], v[40:43], v[76:91]
    v_exp_f32 v95, v95
    v_exp_f32 v96, v96
    v_exp_f32 v97, v97
    v_smfmac_f32_16x16x64_bf16 v[56:59], v[44:47], v[36:43], v48
    v_cvt_pk_bf16_f32 v36, v92, v93
    v_cvt_pk_bf16_f32 v37, v94, v95
    v_exp_f32 v98, v98
    v_exp_f32 v99, v99
    v_mfma_f32_32x32x16_bf16 v[108:123], v[144:147], v[16:19], v[108:123]
    buffer_load_dwordx4 v[168:171], v1, s[12:15], s52 offen offset:3072
    v_cvt_pk_bf16_f32 v38, v96, v97
    v_cvt_pk_bf16_f32 v39, v98, v99
    v_exp_f32 v100, v100
    v_exp_f32 v101, v101
    s_waitcnt vmcnt(15)
    v_mfma_f32_32x32x16_bf16 v[60:75], v[172:175], v[36:39], v[60:75]
    v_exp_f32 v102, v102
    v_exp_f32 v103, v103
    v_cvt_pk_bf16_f32 v40, v100, v101
    v_exp_f32 v104, v104
    v_cvt_pk_bf16_f32 v41, v102, v103
    v_exp_f32 v105, v105
    v_exp_f32 v106, v106
    v_exp_f32 v107, v107
    v_cvt_pk_bf16_f32 v42, v104, v105
    v_cvt_pk_bf16_f32 v43, v106, v107
    v_and_b32 v248, 15, v0
    s_and_b32 s64, s3, 3
    s_lshl_b32 s64, s64, 5
    v_add_u32 v248, s64, v248
    v_lshlrev_b32 v248, 2, v248
    v_add_u32 v248, 159744, v248
    ds_read_b32 v206, v248 offset:0
    ds_read_b32 v207, v248 offset:512
    ds_read_b32 v208, v248 offset:64
    ds_read_b32 v209, v248 offset:576
    v_lshlrev_b32 v248, 2, v0
    v_add_u32 v248, 161664, v248
    ds_read_b32 v210, v248
    s_waitcnt vmcnt(12)
    v_mfma_f32_32x32x16_bf16 v[92:107], v[148:151], v[4:7], 0
    v_exp_f32 v108, v108
    v_exp_f32 v109, v109
    v_exp_f32 v110, v110
    v_mfma_f32_32x32x16_bf16 v[60:75], v[176:179], v[40:43], v[60:75]
    s_add_u32 s50, s50, 4096
    buffer_load_dwordx4 v[140:143], v1, s[12:15], s50 offen offset:0
    v_exp_f32 v111, v111
    v_exp_f32 v112, v112
    v_exp_f32 v113, v113
    v_smfmac_f32_16x16x64_bf16 v[52:55], v[44:47], v[36:43], v48
    v_cvt_pk_bf16_f32 v36, v108, v109
    v_cvt_pk_bf16_f32 v37, v110, v111
    v_exp_f32 v114, v114
    v_exp_f32 v115, v115
    v_mfma_f32_32x32x16_bf16 v[92:107], v[152:155], v[8:11], v[92:107]
    v_cvt_pk_bf16_f32 v38, v112, v113
    v_cvt_pk_bf16_f32 v39, v114, v115
    v_exp_f32 v116, v116
    v_exp_f32 v117, v117
    v_mfma_f32_32x32x16_bf16 v[76:91], v[172:175], v[36:39], v[76:91]
    buffer_load_dwordx4 v[144:147], v1, s[12:15], s50 offen offset:1024
    v_exp_f32 v118, v118
    v_exp_f32 v119, v119
    v_cvt_pk_bf16_f32 v40, v116, v117
    v_exp_f32 v120, v120
    v_cvt_pk_bf16_f32 v41, v118, v119
    v_exp_f32 v121, v121
    v_exp_f32 v122, v122
    v_exp_f32 v123, v123
    v_cvt_pk_bf16_f32 v42, v120, v121
    v_cvt_pk_bf16_f32 v43, v122, v123
    s_setprio 1
    s_lshl_b32 s64, s3, 10
    s_add_u32 m0, s64, 147456
    s_add_u32 s64, s60, 262144
    buffer_load_dwordx4 v245, s[32:35], s64 offen nt lds
recurrent_scan__softmax_full_mha__moe_arch_mod__prompt_kernel_s2d_34:
    s_cmp_lg_u32 s3, 0
    s_cbranch_scc1 recurrent_scan__softmax_full_mha__moe_arch_mod__prompt_kernel_w0_35
    s_lshr_b32 s64, s2, 4
    s_mul_i32 s64, s64, 7
    s_lshr_b32 s64, s64, 1
    s_lshl_b32 s64, s64, 7
    s_add_u32 s64, s64, 21446656
    v_lshlrev_b32 v252, 7, v0
    v_add_u32 v252, s64, v252
    v_mov_b32 v253, 0
    s_mov_b64 exec, 15
    buffer_atomic_or v253, v252, s[12:15], 0 offen sc0 sc1
    s_mov_b64 exec, -1
recurrent_scan__softmax_full_mha__moe_arch_mod__prompt_kernel_w0_35:
    v_mfma_f32_32x32x16_bf16 v[108:123], v[148:151], v[12:15], 0
    s_add_u32 s52, s52, 4096
    buffer_load_dwordx4 v[172:175], v1, s[12:15], s52 offen offset:2048
    v_exp_f32 v92, v92
    v_exp_f32 v93, v93
    v_exp_f32 v94, v94
    v_mfma_f32_32x32x16_bf16 v[76:91], v[176:179], v[40:43], v[76:91]
    v_exp_f32 v95, v95
    v_exp_f32 v96, v96
    v_exp_f32 v97, v97
    v_smfmac_f32_16x16x64_bf16 v[56:59], v[44:47], v[36:43], v48
    v_cvt_pk_bf16_f32 v36, v92, v93
    v_cvt_pk_bf16_f32 v37, v94, v95
    v_exp_f32 v98, v98
    v_exp_f32 v99, v99
    v_mfma_f32_32x32x16_bf16 v[108:123], v[152:155], v[16:19], v[108:123]
    buffer_load_dwordx4 v[176:179], v1, s[12:15], s52 offen offset:3072
    v_cvt_pk_bf16_f32 v38, v96, v97
    v_cvt_pk_bf16_f32 v39, v98, v99
    v_exp_f32 v100, v100
    v_exp_f32 v101, v101
    s_waitcnt vmcnt(16)
    v_mfma_f32_32x32x16_bf16 v[60:75], v[180:183], v[36:39], v[60:75]
    v_exp_f32 v102, v102
    v_exp_f32 v103, v103
    v_cvt_pk_bf16_f32 v40, v100, v101
    v_exp_f32 v104, v104
    v_cvt_pk_bf16_f32 v41, v102, v103
    v_exp_f32 v105, v105
    v_exp_f32 v106, v106
    v_exp_f32 v107, v107
    v_cvt_pk_bf16_f32 v42, v104, v105
    v_cvt_pk_bf16_f32 v43, v106, v107
    s_waitcnt vmcnt(13)
    v_mfma_f32_32x32x16_bf16 v[92:107], v[156:159], v[4:7], 0
    v_exp_f32 v108, v108
    v_exp_f32 v109, v109
    v_exp_f32 v110, v110
    v_mfma_f32_32x32x16_bf16 v[60:75], v[184:187], v[40:43], v[60:75]
    s_and_b32 s54, s54, s55
    s_cbranch_scc1 recurrent_scan__softmax_full_mha__moe_arch_mod__prompt_kernel_nb_36
    s_call_b64 s[56:57], recurrent_scan__softmax_full_mha__moe_arch_mod__prompt_kernel_kvspin
recurrent_scan__softmax_full_mha__moe_arch_mod__prompt_kernel_nb_36:
    s_ff1_i32_b32 s51, s54
    s_bitset0_b32 s55, s51
    s_add_u32 s51, s51, s45
    s_and_b32 s51, s51, 15
    s_lshl_b32 s51, s51, 14
    s_add_u32 s51, s51, s63
    s_mov_b32 s50, s51
    buffer_load_dwordx4 v[148:151], v1, s[12:15], s50 offen offset:0
    v_exp_f32 v111, v111
    v_exp_f32 v112, v112
    v_exp_f32 v113, v113
    v_smfmac_f32_16x16x64_bf16 v[52:55], v[44:47], v[36:43], v48
    v_cvt_pk_bf16_f32 v36, v108, v109
    v_cvt_pk_bf16_f32 v37, v110, v111
    v_exp_f32 v114, v114
    v_exp_f32 v115, v115
    v_mfma_f32_32x32x16_bf16 v[92:107], v[160:163], v[8:11], v[92:107]
    v_cvt_pk_bf16_f32 v38, v112, v113
    v_cvt_pk_bf16_f32 v39, v114, v115
    v_exp_f32 v116, v116
    v_exp_f32 v117, v117
    v_mfma_f32_32x32x16_bf16 v[76:91], v[180:183], v[36:39], v[76:91]
    buffer_load_dwordx4 v[152:155], v1, s[12:15], s50 offen offset:1024
    v_exp_f32 v118, v118
    v_exp_f32 v119, v119
    v_cvt_pk_bf16_f32 v40, v116, v117
    v_exp_f32 v120, v120
    v_cvt_pk_bf16_f32 v41, v118, v119
    v_exp_f32 v121, v121
    v_exp_f32 v122, v122
    v_exp_f32 v123, v123
    v_cvt_pk_bf16_f32 v42, v120, v121
    v_cvt_pk_bf16_f32 v43, v122, v123
    s_setprio 0
    s_cmp_lg_u32 s48, 0
    s_cbranch_scc1 recurrent_scan__softmax_full_mha__moe_arch_mod__prompt_kernel_s2d_37
    s_lshl_b32 s64, s3, 10
    s_add_u32 m0, s64, 155648
    s_add_u32 s64, s60, 393216
    buffer_load_dwordx4 v245, s[32:35], s64 offen nt lds
recurrent_scan__softmax_full_mha__moe_arch_mod__prompt_kernel_s2d_37:
    v_mfma_f32_32x32x16_bf16 v[108:123], v[156:159], v[12:15], 0
    s_mov_b32 s52, s51
    buffer_load_dwordx4 v[180:183], v1, s[12:15], s52 offen offset:2048
    v_exp_f32 v92, v92
    v_exp_f32 v93, v93
    v_exp_f32 v94, v94
    v_mfma_f32_32x32x16_bf16 v[76:91], v[184:187], v[40:43], v[76:91]
    v_exp_f32 v95, v95
    v_exp_f32 v96, v96
    v_exp_f32 v97, v97
    v_smfmac_f32_16x16x64_bf16 v[56:59], v[44:47], v[36:43], v48
    v_cvt_pk_bf16_f32 v36, v92, v93
    v_cvt_pk_bf16_f32 v37, v94, v95
    v_exp_f32 v98, v98
    v_exp_f32 v99, v99
    v_mfma_f32_32x32x16_bf16 v[108:123], v[160:163], v[16:19], v[108:123]
    buffer_load_dwordx4 v[184:187], v1, s[12:15], s52 offen offset:3072
    v_cvt_pk_bf16_f32 v38, v96, v97
    v_cvt_pk_bf16_f32 v39, v98, v99
    v_exp_f32 v100, v100
    v_exp_f32 v101, v101
    s_waitcnt vmcnt(15)
    v_mfma_f32_32x32x16_bf16 v[60:75], v[188:191], v[36:39], v[60:75]
    v_exp_f32 v102, v102
    v_exp_f32 v103, v103
    v_cvt_pk_bf16_f32 v40, v100, v101
    v_exp_f32 v104, v104
    v_cvt_pk_bf16_f32 v41, v102, v103
    v_exp_f32 v105, v105
    v_exp_f32 v106, v106
    v_exp_f32 v107, v107
    v_cvt_pk_bf16_f32 v42, v104, v105
    v_cvt_pk_bf16_f32 v43, v106, v107
    s_waitcnt vmcnt(12)
    v_mfma_f32_32x32x16_bf16 v[92:107], v[132:135], v[4:7], 0
    v_exp_f32 v108, v108
    v_exp_f32 v109, v109
    v_exp_f32 v110, v110
    v_mfma_f32_32x32x16_bf16 v[60:75], v[192:195], v[40:43], v[60:75]
    s_add_u32 s50, s50, 4096
    buffer_load_dwordx4 v[156:159], v1, s[12:15], s50 offen offset:0
    v_exp_f32 v111, v111
    v_exp_f32 v112, v112
    v_exp_f32 v113, v113
    v_smfmac_f32_16x16x64_bf16 v[52:55], v[44:47], v[36:43], v48
    v_cvt_pk_bf16_f32 v36, v108, v109
    v_cvt_pk_bf16_f32 v37, v110, v111
    v_exp_f32 v114, v114
    v_exp_f32 v115, v115
    v_mfma_f32_32x32x16_bf16 v[92:107], v[136:139], v[8:11], v[92:107]
    v_cvt_pk_bf16_f32 v38, v112, v113
    v_cvt_pk_bf16_f32 v39, v114, v115
    v_exp_f32 v116, v116
    v_exp_f32 v117, v117
    v_mfma_f32_32x32x16_bf16 v[76:91], v[188:191], v[36:39], v[76:91]
    buffer_load_dwordx4 v[160:163], v1, s[12:15], s50 offen offset:1024
    v_exp_f32 v118, v118
    v_exp_f32 v119, v119
    v_cvt_pk_bf16_f32 v40, v116, v117
    v_exp_f32 v120, v120
    v_cvt_pk_bf16_f32 v41, v118, v119
    v_exp_f32 v121, v121
    v_exp_f32 v122, v122
    v_exp_f32 v123, v123
    v_cvt_pk_bf16_f32 v42, v120, v121
    v_cvt_pk_bf16_f32 v43, v122, v123
    s_waitcnt lgkmcnt(0)
    s_cmp_lg_u32 s3, 0
    s_cbranch_scc1 recurrent_scan__softmax_full_mha__moe_arch_mod__prompt_kernel_w0_38
    s_waitcnt vmcnt(8)
    v_cmp_gt_u32 vcc, 32, v253
    s_and_b32 vcc_lo, vcc_lo, 15
    s_cbranch_scc1 recurrent_scan__softmax_full_mha__moe_arch_mod__prompt_kernel_hp_39_spin
recurrent_scan__softmax_full_mha__moe_arch_mod__prompt_kernel_hp_39_ok:
recurrent_scan__softmax_full_mha__moe_arch_mod__prompt_kernel_w0_38:
    s_barrier
    s_setprio 3
    s_lshr_b32 s64, s2, 4
    s_mul_i32 s64, s64, 896
    s_mul_i32 s65, s3, 14336
    s_add_u32 s64, s64, s65
    s_add_u32 s64, s64, 22020096
    s_add_u32 s65, s64, 114688
    s_bfm_b64 exec, 56, 0
    buffer_load_dwordx4 v[220:223], v1, s[12:15], s64 offen sc1
    buffer_load_dwordx4 v[224:227], v1, s[12:15], s65 offen sc1
    s_mov_b64 exec, -1
    v_mfma_f32_32x32x16_bf16 v[108:123], v[132:135], v[12:15], 0
    s_add_u32 s52, s52, 4096
    buffer_load_dwordx4 v[188:191], v1, s[12:15], s52 offen offset:2048
    v_exp_f32 v92, v92
    v_exp_f32 v93, v93
    v_exp_f32 v94, v94
    v_mfma_f32_32x32x16_bf16 v[76:91], v[192:195], v[40:43], v[76:91]
    v_exp_f32 v95, v95
    v_exp_f32 v96, v96
    v_exp_f32 v97, v97
    v_smfmac_f32_16x16x64_bf16 v[56:59], v[44:47], v[36:43], v48
    v_cvt_pk_bf16_f32 v36, v92, v93
    v_cvt_pk_bf16_f32 v37, v94, v95
    v_exp_f32 v98, v98
    v_exp_f32 v99, v99
    v_mfma_f32_32x32x16_bf16 v[108:123], v[136:139], v[16:19], v[108:123]
    buffer_load_dwordx4 v[192:195], v1, s[12:15], s52 offen offset:3072
    v_cvt_pk_bf16_f32 v38, v96, v97
    v_cvt_pk_bf16_f32 v39, v98, v99
    v_exp_f32 v100, v100
    v_exp_f32 v101, v101
    s_waitcnt vmcnt(16)
    v_mfma_f32_32x32x16_bf16 v[60:75], v[164:167], v[36:39], v[60:75]
    v_exp_f32 v102, v102
    v_exp_f32 v103, v103
    v_cvt_pk_bf16_f32 v40, v100, v101
    v_exp_f32 v104, v104
    v_cvt_pk_bf16_f32 v41, v102, v103
    v_exp_f32 v105, v105
    v_exp_f32 v106, v106
    v_exp_f32 v107, v107
    v_cvt_pk_bf16_f32 v42, v104, v105
    v_cvt_pk_bf16_f32 v43, v106, v107
    s_add_u32 m0, s62, 0
    s_add_u32 s64, s61, 0
    buffer_load_dwordx4 v244, s[36:39], s64 offen  lds
recurrent_scan__softmax_full_mha__moe_arch_mod__prompt_kernel_wo_40:
    s_add_u32 m0, s62, 8192
    s_add_u32 s64, s61, 131072
    buffer_load_dwordx4 v244, s[36:39], s64 offen  lds
recurrent_scan__softmax_full_mha__moe_arch_mod__prompt_kernel_wo_41:
    s_waitcnt vmcnt(15)
    v_mfma_f32_32x32x16_bf16 v[92:107], v[140:143], v[4:7], 0
    v_exp_f32 v108, v108
    v_exp_f32 v109, v109
    v_exp_f32 v110, v110
    v_mfma_f32_32x32x16_bf16 v[60:75], v[168:171], v[40:43], v[60:75]
    s_and_b32 s54, s54, s55
    s_cbranch_scc1 recurrent_scan__softmax_full_mha__moe_arch_mod__prompt_kernel_nb_42
    s_call_b64 s[56:57], recurrent_scan__softmax_full_mha__moe_arch_mod__prompt_kernel_kvspin
recurrent_scan__softmax_full_mha__moe_arch_mod__prompt_kernel_nb_42:
    s_ff1_i32_b32 s51, s54
    s_bitset0_b32 s55, s51
    s_add_u32 s51, s51, s45
    s_and_b32 s51, s51, 15
    s_lshl_b32 s51, s51, 14
    s_add_u32 s51, s51, s63
    s_mov_b32 s50, s51
    buffer_load_dwordx4 v[132:135], v1, s[12:15], s50 offen offset:0
    v_exp_f32 v111, v111
    v_exp_f32 v112, v112
    v_exp_f32 v113, v113
    v_smfmac_f32_16x16x64_bf16 v[52:55], v[44:47], v[36:43], v48
    v_cvt_pk_bf16_f32 v36, v108, v109
    v_cvt_pk_bf16_f32 v37, v110, v111
    v_exp_f32 v114, v114
    v_exp_f32 v115, v115
    v_mfma_f32_32x32x16_bf16 v[92:107], v[144:147], v[8:11], v[92:107]
    v_cvt_pk_bf16_f32 v38, v112, v113
    v_cvt_pk_bf16_f32 v39, v114, v115
    v_exp_f32 v116, v116
    v_exp_f32 v117, v117
    v_mfma_f32_32x32x16_bf16 v[76:91], v[164:167], v[36:39], v[76:91]
    buffer_load_dwordx4 v[136:139], v1, s[12:15], s50 offen offset:1024
    v_exp_f32 v118, v118
    v_exp_f32 v119, v119
    v_cvt_pk_bf16_f32 v40, v116, v117
    v_exp_f32 v120, v120
    v_cvt_pk_bf16_f32 v41, v118, v119
    v_exp_f32 v121, v121
    v_exp_f32 v122, v122
    v_exp_f32 v123, v123
    v_cvt_pk_bf16_f32 v42, v120, v121
    v_cvt_pk_bf16_f32 v43, v122, v123
    s_setprio 2
    v_and_b32 v248, 15, v0
    s_lshl_b32 s64, s45, 2
    s_and_b32 s65, s3, 3
    s_add_u32 s64, s64, s65
    s_lshl_b32 s64, s64, 5
    v_add_u32 v248, s64, v248
    v_lshlrev_b32 v204, 11, v248
    v_bfe_u32 v248, v0, 4, 1
    v_lshl_add_u32 v204, v248, 5, v204
    v_lshrrev_b32 v248, 5, v0
    v_lshl_add_u32 v204, v248, 4, v204
    s_lshl_b32 s64, s44, 7
    s_lshl_b32 s65, s48, 6
    s_add_u32 s64, s64, s65
    v_add_u32 v204, s64, v204
    s_mov_b32 s64, 32768
    buffer_load_dwordx4 v[196:199], v204, s[4:7], 0 offen
    buffer_load_dwordx4 v[200:203], v204, s[4:7], s64 offen
    v_mfma_f32_32x32x16_bf16 v[108:123], v[140:143], v[12:15], 0
    s_mov_b32 s52, s51
    buffer_load_dwordx4 v[164:167], v1, s[12:15], s52 offen offset:2048
    v_exp_f32 v92, v92
    v_exp_f32 v93, v93
    v_exp_f32 v94, v94
    v_mfma_f32_32x32x16_bf16 v[76:91], v[168:171], v[40:43], v[76:91]
    v_exp_f32 v95, v95
    v_exp_f32 v96, v96
    v_exp_f32 v97, v97
    v_smfmac_f32_16x16x64_bf16 v[56:59], v[44:47], v[36:43], v48
    v_cvt_pk_bf16_f32 v36, v92, v93
    v_cvt_pk_bf16_f32 v37, v94, v95
    v_exp_f32 v98, v98
    v_exp_f32 v99, v99
    v_mfma_f32_32x32x16_bf16 v[108:123], v[144:147], v[16:19], v[108:123]
    buffer_load_dwordx4 v[168:171], v1, s[12:15], s52 offen offset:3072
    v_cvt_pk_bf16_f32 v38, v96, v97
    v_cvt_pk_bf16_f32 v39, v98, v99
    v_exp_f32 v100, v100
    v_exp_f32 v101, v101
    s_waitcnt vmcnt(19)
    v_mfma_f32_32x32x16_bf16 v[60:75], v[172:175], v[36:39], v[60:75]
    v_exp_f32 v102, v102
    v_exp_f32 v103, v103
    v_cvt_pk_bf16_f32 v40, v100, v101
    v_exp_f32 v104, v104
    v_cvt_pk_bf16_f32 v41, v102, v103
    v_exp_f32 v105, v105
    v_exp_f32 v106, v106
    v_exp_f32 v107, v107
    v_cvt_pk_bf16_f32 v42, v104, v105
    v_cvt_pk_bf16_f32 v43, v106, v107
    s_add_u32 m0, s62, 16384
    s_add_u32 s64, s61, 262144
    buffer_load_dwordx4 v244, s[36:39], s64 offen  lds
recurrent_scan__softmax_full_mha__moe_arch_mod__prompt_kernel_wo_43:
    s_waitcnt vmcnt(17)
    v_mfma_f32_32x32x16_bf16 v[92:107], v[148:151], v[4:7], 0
    v_exp_f32 v108, v108
    v_exp_f32 v109, v109
    v_exp_f32 v110, v110
    v_mfma_f32_32x32x16_bf16 v[60:75], v[176:179], v[40:43], v[60:75]
    s_add_u32 s50, s50, 4096
    buffer_load_dwordx4 v[140:143], v1, s[12:15], s50 offen offset:0
    v_exp_f32 v111, v111
    v_exp_f32 v112, v112
    v_exp_f32 v113, v113
    v_smfmac_f32_16x16x64_bf16 v[52:55], v[44:47], v[36:43], v48
    v_cvt_pk_bf16_f32 v36, v108, v109
    v_cvt_pk_bf16_f32 v37, v110, v111
    v_exp_f32 v114, v114
    v_exp_f32 v115, v115
    v_mfma_f32_32x32x16_bf16 v[92:107], v[152:155], v[8:11], v[92:107]
    v_cvt_pk_bf16_f32 v38, v112, v113
    v_cvt_pk_bf16_f32 v39, v114, v115
    v_exp_f32 v116, v116
    v_exp_f32 v117, v117
    v_mfma_f32_32x32x16_bf16 v[76:91], v[172:175], v[36:39], v[76:91]
    buffer_load_dwordx4 v[144:147], v1, s[12:15], s50 offen offset:1024
    v_exp_f32 v118, v118
    v_exp_f32 v119, v119
    v_cvt_pk_bf16_f32 v40, v116, v117
    v_exp_f32 v120, v120
    v_cvt_pk_bf16_f32 v41, v118, v119
    v_exp_f32 v121, v121
    v_exp_f32 v122, v122
    v_exp_f32 v123, v123
    v_cvt_pk_bf16_f32 v42, v120, v121
    v_cvt_pk_bf16_f32 v43, v122, v123
    s_setprio 1
    s_waitcnt vmcnt(13)
    v_cvt_pk_bf16_f32 v228, v220, v221
    v_cvt_pk_bf16_f32 v229, v224, v225
    v_lshlrev_b32 v220, 16, v228
    v_and_b32 v221, 0xffff0000, v228
    v_lshlrev_b32 v224, 16, v229
    v_and_b32 v225, 0xffff0000, v229
    v_cvt_pk_bf16_f32 v228, v222, v223
    v_cvt_pk_bf16_f32 v229, v226, v227
    v_lshlrev_b32 v222, 16, v228
    v_and_b32 v223, 0xffff0000, v228
    v_lshlrev_b32 v226, 16, v229
    v_and_b32 v227, 0xffff0000, v229
    v_mul_f32 v228, 0xbfb8aa3b, v220
    v_mul_f32 v229, 0xbfb8aa3b, v221
    v_mul_f32 v230, 0xbfb8aa3b, v222
    v_mul_f32 v231, 0xbfb8aa3b, v223
    v_exp_f32 v228, v228
    v_exp_f32 v229, v229
    v_exp_f32 v230, v230
    v_exp_f32 v231, v231
    v_add_f32 v228, 1.0, v228
    v_add_f32 v229, 1.0, v229
    v_add_f32 v230, 1.0, v230
    v_add_f32 v231, 1.0, v231
    v_rcp_f32 v228, v228
    v_rcp_f32 v229, v229
    v_rcp_f32 v230, v230
    v_rcp_f32 v231, v231
    v_mul_f32 v220, v220, v228
    v_mul_f32 v221, v221, v229
    v_mul_f32 v222, v222, v230
    v_mul_f32 v223, v223, v231
    v_cvt_pk_bf16_f32 v228, v220, v221
    v_lshlrev_b32 v220, 16, v228
    v_and_b32 v221, 0xffff0000, v228
    v_cvt_pk_bf16_f32 v228, v222, v223
    v_lshlrev_b32 v222, 16, v228
    v_and_b32 v223, 0xffff0000, v228
    v_mul_f32 v220, v220, v224
    v_mul_f32 v221, v221, v225
    v_mul_f32 v222, v222, v226
    v_mul_f32 v223, v223, v227
    v_cvt_pk_bf16_f32 v228, v220, v221
    v_cvt_pk_bf16_f32 v229, v222, v223
    v_lshrrev_b32 v248, 1, v0
    v_lshlrev_b32 v248, 7, v248
    v_and_b32 v249, 1, v0
    v_lshl_add_u32 v248, v249, 3, v248
    s_lshl_b32 s64, s3, 4
    s_add_u32 s64, s64, 159744
    v_add_u32 v248, s64, v248
    s_bfm_b64 exec, 56, 0
    ds_write_b64 v248, v[228:229]
    s_mov_b64 exec, -1
    v_mfma_f32_32x32x16_bf16 v[108:123], v[148:151], v[12:15], 0
    s_add_u32 s52, s52, 4096
    buffer_load_dwordx4 v[172:175], v1, s[12:15], s52 offen offset:2048
    v_exp_f32 v92, v92
    v_exp_f32 v93, v93
    v_exp_f32 v94, v94
    v_mfma_f32_32x32x16_bf16 v[76:91], v[176:179], v[40:43], v[76:91]
    v_exp_f32 v95, v95
    v_exp_f32 v96, v96
    v_exp_f32 v97, v97
    v_smfmac_f32_16x16x64_bf16 v[56:59], v[44:47], v[36:43], v48
    v_cvt_pk_bf16_f32 v36, v92, v93
    v_cvt_pk_bf16_f32 v37, v94, v95
    v_exp_f32 v98, v98
    v_exp_f32 v99, v99
    v_mfma_f32_32x32x16_bf16 v[108:123], v[152:155], v[16:19], v[108:123]
    buffer_load_dwordx4 v[176:179], v1, s[12:15], s52 offen offset:3072
    v_cvt_pk_bf16_f32 v38, v96, v97
    v_cvt_pk_bf16_f32 v39, v98, v99
    v_exp_f32 v100, v100
    v_exp_f32 v101, v101
    v_mfma_f32_32x32x16_bf16 v[60:75], v[180:183], v[36:39], v[60:75]
    v_exp_f32 v102, v102
    v_exp_f32 v103, v103
    v_cvt_pk_bf16_f32 v40, v100, v101
    v_exp_f32 v104, v104
    v_cvt_pk_bf16_f32 v41, v102, v103
    v_exp_f32 v105, v105
    v_exp_f32 v106, v106
    v_exp_f32 v107, v107
    v_cvt_pk_bf16_f32 v42, v104, v105
    v_cvt_pk_bf16_f32 v43, v106, v107
    s_add_u32 m0, s62, 24576
    s_add_u32 s64, s61, 393216
    buffer_load_dwordx4 v244, s[36:39], s64 offen  lds
recurrent_scan__softmax_full_mha__moe_arch_mod__prompt_kernel_wo_44:
    s_add_u32 m0, s62, 32768
    s_add_u32 s64, s61, 524288
    buffer_load_dwordx4 v244, s[36:39], s64 offen  lds
recurrent_scan__softmax_full_mha__moe_arch_mod__prompt_kernel_wo_45:
    v_mfma_f32_32x32x16_bf16 v[92:107], v[156:159], v[4:7], 0
    v_exp_f32 v108, v108
    v_exp_f32 v109, v109
    v_exp_f32 v110, v110
    v_mfma_f32_32x32x16_bf16 v[60:75], v[184:187], v[40:43], v[60:75]
    s_and_b32 s54, s54, s55
    s_cbranch_scc1 recurrent_scan__softmax_full_mha__moe_arch_mod__prompt_kernel_nb_46
    s_call_b64 s[56:57], recurrent_scan__softmax_full_mha__moe_arch_mod__prompt_kernel_kvspin
recurrent_scan__softmax_full_mha__moe_arch_mod__prompt_kernel_nb_46:
    s_ff1_i32_b32 s51, s54
    s_bitset0_b32 s55, s51
    s_add_u32 s51, s51, s45
    s_and_b32 s51, s51, 15
    s_lshl_b32 s51, s51, 14
    s_add_u32 s51, s51, s63
    s_mov_b32 s50, s51
    buffer_load_dwordx4 v[148:151], v1, s[12:15], s50 offen offset:0
    v_exp_f32 v111, v111
    v_exp_f32 v112, v112
    v_exp_f32 v113, v113
    v_smfmac_f32_16x16x64_bf16 v[52:55], v[44:47], v[36:43], v48
    v_cvt_pk_bf16_f32 v36, v108, v109
    v_cvt_pk_bf16_f32 v37, v110, v111
    v_exp_f32 v114, v114
    v_exp_f32 v115, v115
    v_mfma_f32_32x32x16_bf16 v[92:107], v[160:163], v[8:11], v[92:107]
    v_cvt_pk_bf16_f32 v38, v112, v113
    v_cvt_pk_bf16_f32 v39, v114, v115
    v_exp_f32 v116, v116
    v_exp_f32 v117, v117
    v_mfma_f32_32x32x16_bf16 v[76:91], v[180:183], v[36:39], v[76:91]
    buffer_load_dwordx4 v[152:155], v1, s[12:15], s50 offen offset:1024
    v_exp_f32 v118, v118
    v_exp_f32 v119, v119
    v_cvt_pk_bf16_f32 v40, v116, v117
    v_exp_f32 v120, v120
    v_cvt_pk_bf16_f32 v41, v118, v119
    v_exp_f32 v121, v121
    v_exp_f32 v122, v122
    v_exp_f32 v123, v123
    v_cvt_pk_bf16_f32 v42, v120, v121
    v_cvt_pk_bf16_f32 v43, v122, v123
    s_setprio 0
    v_mfma_f32_32x32x16_bf16 v[108:123], v[156:159], v[12:15], 0
    s_mov_b32 s52, s51
    buffer_load_dwordx4 v[180:183], v1, s[12:15], s52 offen offset:2048
    v_exp_f32 v92, v92
    v_exp_f32 v93, v93
    v_exp_f32 v94, v94
    v_mfma_f32_32x32x16_bf16 v[76:91], v[184:187], v[40:43], v[76:91]
    v_exp_f32 v95, v95
    v_exp_f32 v96, v96
    v_exp_f32 v97, v97
    v_smfmac_f32_16x16x64_bf16 v[56:59], v[44:47], v[36:43], v48
    v_cvt_pk_bf16_f32 v36, v92, v93
    v_cvt_pk_bf16_f32 v37, v94, v95
    v_exp_f32 v98, v98
    v_exp_f32 v99, v99
    v_mfma_f32_32x32x16_bf16 v[108:123], v[160:163], v[16:19], v[108:123]
    buffer_load_dwordx4 v[184:187], v1, s[12:15], s52 offen offset:3072
    v_cvt_pk_bf16_f32 v38, v96, v97
    v_cvt_pk_bf16_f32 v39, v98, v99
    v_exp_f32 v100, v100
    v_exp_f32 v101, v101
    s_waitcnt vmcnt(20)
    v_mfma_f32_32x32x16_bf16 v[60:75], v[188:191], v[36:39], v[60:75]
    v_exp_f32 v102, v102
    v_exp_f32 v103, v103
    v_cvt_pk_bf16_f32 v40, v100, v101
    v_exp_f32 v104, v104
    v_cvt_pk_bf16_f32 v41, v102, v103
    v_exp_f32 v105, v105
    v_exp_f32 v106, v106
    v_exp_f32 v107, v107
    v_cvt_pk_bf16_f32 v42, v104, v105
    v_cvt_pk_bf16_f32 v43, v106, v107
    s_add_u32 m0, s62, 40960
    s_add_u32 s64, s61, 655360
    buffer_load_dwordx4 v244, s[36:39], s64 offen  lds
recurrent_scan__softmax_full_mha__moe_arch_mod__prompt_kernel_wo_47:
    s_waitcnt vmcnt(16)
    v_mfma_f32_32x32x16_bf16 v[92:107], v[132:135], v[4:7], 0
    v_exp_f32 v108, v108
    v_exp_f32 v109, v109
    v_exp_f32 v110, v110
    v_mfma_f32_32x32x16_bf16 v[60:75], v[192:195], v[40:43], v[60:75]
    s_add_u32 s50, s50, 4096
    buffer_load_dwordx4 v[156:159], v1, s[12:15], s50 offen offset:0
    v_exp_f32 v111, v111
    v_exp_f32 v112, v112
    v_exp_f32 v113, v113
    v_smfmac_f32_16x16x64_bf16 v[52:55], v[44:47], v[36:43], v48
    v_cvt_pk_bf16_f32 v36, v108, v109
    v_cvt_pk_bf16_f32 v37, v110, v111
    v_exp_f32 v114, v114
    v_exp_f32 v115, v115
    v_mfma_f32_32x32x16_bf16 v[92:107], v[136:139], v[8:11], v[92:107]
    v_cvt_pk_bf16_f32 v38, v112, v113
    v_cvt_pk_bf16_f32 v39, v114, v115
    v_exp_f32 v116, v116
    v_exp_f32 v117, v117
    v_mfma_f32_32x32x16_bf16 v[76:91], v[188:191], v[36:39], v[76:91]
    buffer_load_dwordx4 v[160:163], v1, s[12:15], s50 offen offset:1024
    v_exp_f32 v118, v118
    v_exp_f32 v119, v119
    v_cvt_pk_bf16_f32 v40, v116, v117
    v_exp_f32 v120, v120
    v_cvt_pk_bf16_f32 v41, v118, v119
    v_exp_f32 v121, v121
    v_exp_f32 v122, v122
    v_exp_f32 v123, v123
    v_cvt_pk_bf16_f32 v42, v120, v121
    v_cvt_pk_bf16_f32 v43, v122, v123
    s_waitcnt lgkmcnt(0)
    s_barrier
    s_setprio 3
    s_lshl_b32 s64, s48, 11
    s_add_u32 s64, s64, 159744
    v_and_b32 v248, 7, v0
    v_lshlrev_b32 v248, 4, v248
    v_lshrrev_b32 v249, 4, v0
    v_lshl_add_u32 v248, v249, 7, v248
    v_add_u32 v248, s64, v248
    s_lshl_b32 s64, s48, 14
    s_add_u32 s64, s64, 131072
    v_add_u32 v250, s64, v243
    ds_read_b128 v[220:223], v248 offset:0
    ds_read_b64_tr_b16 v[20:21], v250 offset:0
    ds_read_b64_tr_b16 v[22:23], v250 offset:2048
    ds_read_b128 v[224:227], v248 offset:512
    ds_read_b64_tr_b16 v[24:25], v250 offset:4096
    ds_read_b64_tr_b16 v[26:27], v250 offset:6144
    ds_read_b128 v[228:231], v248 offset:1024
    ds_read_b64_tr_b16 v[28:29], v250 offset:8192
    ds_read_b64_tr_b16 v[30:31], v250 offset:10240
    ds_read_b128 v[232:235], v248 offset:1536
    ds_read_b64_tr_b16 v[32:33], v250 offset:12288
    ds_read_b64_tr_b16 v[34:35], v250 offset:14336
    v_mfma_f32_32x32x16_bf16 v[108:123], v[132:135], v[12:15], 0
    s_add_u32 s52, s52, 4096
    buffer_load_dwordx4 v[188:191], v1, s[12:15], s52 offen offset:2048
    v_exp_f32 v92, v92
    v_exp_f32 v93, v93
    v_exp_f32 v94, v94
    v_mfma_f32_32x32x16_bf16 v[76:91], v[192:195], v[40:43], v[76:91]
    v_exp_f32 v95, v95
    v_exp_f32 v96, v96
    v_exp_f32 v97, v97
    v_smfmac_f32_16x16x64_bf16 v[56:59], v[44:47], v[36:43], v48
    v_cvt_pk_bf16_f32 v36, v92, v93
    v_cvt_pk_bf16_f32 v37, v94, v95
    v_exp_f32 v98, v98
    v_exp_f32 v99, v99
    v_mfma_f32_32x32x16_bf16 v[108:123], v[136:139], v[16:19], v[108:123]
    buffer_load_dwordx4 v[192:195], v1, s[12:15], s52 offen offset:3072
    v_cvt_pk_bf16_f32 v38, v96, v97
    v_cvt_pk_bf16_f32 v39, v98, v99
    v_exp_f32 v100, v100
    v_exp_f32 v101, v101
    s_waitcnt vmcnt(17)
    v_mfma_f32_32x32x16_bf16 v[60:75], v[164:167], v[36:39], v[60:75]
    v_exp_f32 v102, v102
    v_exp_f32 v103, v103
    v_cvt_pk_bf16_f32 v40, v100, v101
    v_exp_f32 v104, v104
    v_cvt_pk_bf16_f32 v41, v102, v103
    v_exp_f32 v105, v105
    v_exp_f32 v106, v106
    v_exp_f32 v107, v107
    v_cvt_pk_bf16_f32 v42, v104, v105
    v_cvt_pk_bf16_f32 v43, v106, v107
    s_waitcnt lgkmcnt(0)
    s_cmp_lg_u32 s48, 0
    v_mfma_f32_16x16x32_bf16 v[236:239], v[220:223], v[20:23], 0
    v_mfma_f32_16x16x32_bf16 v[236:239], v[224:227], v[24:27], v[236:239]
    v_mfma_f32_16x16x32_bf16 v[236:239], v[228:231], v[28:31], v[236:239]
    s_cbranch_scc1 recurrent_scan__softmax_full_mha__moe_arch_mod__prompt_kernel_s2k_48
    v_mfma_f32_16x16x32_bf16 v[236:239], v[232:235], v[32:35], v[236:239]
recurrent_scan__softmax_full_mha__moe_arch_mod__prompt_kernel_s2k_48:
    v_mul_u32_u24 v249, 16384, v249
    v_and_b32 v248, 15, v0
    v_lshl_add_u32 v248, v248, 2, v249
    s_add_u32 m0, s62, 49152
    s_add_u32 s64, s61, 786432
    buffer_load_dwordx4 v244, s[36:39], s64 offen  lds
recurrent_scan__softmax_full_mha__moe_arch_mod__prompt_kernel_wo_49:
    s_add_u32 m0, s62, 57344
    s_add_u32 s64, s61, 917504
    buffer_load_dwordx4 v244, s[36:39], s64 offen  lds
recurrent_scan__softmax_full_mha__moe_arch_mod__prompt_kernel_wo_50:
    s_waitcnt vmcnt(15)
    v_mfma_f32_32x32x16_bf16 v[92:107], v[140:143], v[4:7], 0
    v_exp_f32 v108, v108
    v_exp_f32 v109, v109
    v_exp_f32 v110, v110
    v_mfma_f32_32x32x16_bf16 v[60:75], v[168:171], v[40:43], v[60:75]
    s_and_b32 s54, s54, s55
    s_cbranch_scc1 recurrent_scan__softmax_full_mha__moe_arch_mod__prompt_kernel_nb_51
    s_call_b64 s[56:57], recurrent_scan__softmax_full_mha__moe_arch_mod__prompt_kernel_kvspin
recurrent_scan__softmax_full_mha__moe_arch_mod__prompt_kernel_nb_51:
    s_ff1_i32_b32 s51, s54
    s_bitset0_b32 s55, s51
    s_add_u32 s51, s51, s45
    s_and_b32 s51, s51, 15
    s_lshl_b32 s51, s51, 14
    s_add_u32 s51, s51, s63
    s_mov_b32 s50, s51
    buffer_load_dwordx4 v[132:135], v1, s[12:15], s50 offen offset:0
    v_exp_f32 v111, v111
    v_exp_f32 v112, v112
    v_exp_f32 v113, v113
    v_smfmac_f32_16x16x64_bf16 v[52:55], v[44:47], v[36:43], v48
    v_cvt_pk_bf16_f32 v36, v108, v109
    v_cvt_pk_bf16_f32 v37, v110, v111
    v_exp_f32 v114, v114
    v_exp_f32 v115, v115
    v_mfma_f32_32x32x16_bf16 v[92:107], v[144:147], v[8:11], v[92:107]
    v_cvt_pk_bf16_f32 v38, v112, v113
    v_cvt_pk_bf16_f32 v39, v114, v115
    v_exp_f32 v116, v116
    v_exp_f32 v117, v117
    v_mfma_f32_32x32x16_bf16 v[76:91], v[164:167], v[36:39], v[76:91]
    buffer_load_dwordx4 v[136:139], v1, s[12:15], s50 offen offset:1024
    v_exp_f32 v118, v118
    v_exp_f32 v119, v119
    v_cvt_pk_bf16_f32 v40, v116, v117
    v_exp_f32 v120, v120
    v_cvt_pk_bf16_f32 v41, v118, v119
    v_exp_f32 v121, v121
    v_exp_f32 v122, v122
    v_exp_f32 v123, v123
    v_cvt_pk_bf16_f32 v42, v120, v121
    v_cvt_pk_bf16_f32 v43, v122, v123
    s_setprio 2
    s_and_b32 s64, s2, 15
    s_lshl_b32 s64, s64, 8
    s_and_b32 s65, s3, 3
    s_lshl_b32 s65, s65, 6
    s_add_u32 s64, s64, s65
    s_add_u32 s64, s64, 21233664
    s_bfm_b64 exec, 32, 0
    s_add_u32 s65, s64, 0
    buffer_atomic_add_f32 v236, v248, s[12:15], s65 offen
    s_add_u32 s65, s64, 4096
    buffer_atomic_add_f32 v237, v248, s[12:15], s65 offen
    s_add_u32 s65, s64, 8192
    buffer_atomic_add_f32 v238, v248, s[12:15], s65 offen
    s_add_u32 s65, s64, 12288
    buffer_atomic_add_f32 v239, v248, s[12:15], s65 offen
    s_mov_b64 exec, -1
    v_mfma_f32_32x32x16_bf16 v[108:123], v[140:143], v[12:15], 0
    s_mov_b32 s52, s51
    buffer_load_dwordx4 v[164:167], v1, s[12:15], s52 offen offset:2048
    v_exp_f32 v92, v92
    v_exp_f32 v93, v93
    v_exp_f32 v94, v94
    v_mfma_f32_32x32x16_bf16 v[76:91], v[168:171], v[40:43], v[76:91]
    v_exp_f32 v95, v95
    v_exp_f32 v96, v96
    v_exp_f32 v97, v97
    v_smfmac_f32_16x16x64_bf16 v[56:59], v[44:47], v[36:43], v48
    v_cvt_pk_bf16_f32 v36, v92, v93
    v_cvt_pk_bf16_f32 v37, v94, v95
    v_exp_f32 v98, v98
    v_exp_f32 v99, v99
    v_mfma_f32_32x32x16_bf16 v[108:123], v[144:147], v[16:19], v[108:123]
    buffer_load_dwordx4 v[168:171], v1, s[12:15], s52 offen offset:3072
    v_cvt_pk_bf16_f32 v38, v96, v97
    v_cvt_pk_bf16_f32 v39, v98, v99
    v_exp_f32 v100, v100
    v_exp_f32 v101, v101
    s_waitcnt vmcnt(22)
    v_mfma_f32_32x32x16_bf16 v[60:75], v[172:175], v[36:39], v[60:75]
    v_exp_f32 v102, v102
    v_exp_f32 v103, v103
    v_cvt_pk_bf16_f32 v40, v100, v101
    v_exp_f32 v104, v104
    v_cvt_pk_bf16_f32 v41, v102, v103
    v_exp_f32 v105, v105
    v_exp_f32 v106, v106
    v_exp_f32 v107, v107
    v_cvt_pk_bf16_f32 v42, v104, v105
    v_cvt_pk_bf16_f32 v43, v106, v107
    s_add_u32 m0, s62, 65536
    s_add_u32 s64, s61, 1048576
    buffer_load_dwordx4 v244, s[36:39], s64 offen  lds
recurrent_scan__softmax_full_mha__moe_arch_mod__prompt_kernel_wo_52:
    s_waitcnt vmcnt(18)
    v_mfma_f32_32x32x16_bf16 v[92:107], v[148:151], v[4:7], 0
    v_exp_f32 v108, v108
    v_exp_f32 v109, v109
    v_exp_f32 v110, v110
    v_mfma_f32_32x32x16_bf16 v[60:75], v[176:179], v[40:43], v[60:75]
    s_add_u32 s50, s50, 4096
    buffer_load_dwordx4 v[140:143], v1, s[12:15], s50 offen offset:0
    v_exp_f32 v111, v111
    v_exp_f32 v112, v112
    v_exp_f32 v113, v113
    v_smfmac_f32_16x16x64_bf16 v[52:55], v[44:47], v[36:43], v48
    v_cvt_pk_bf16_f32 v36, v108, v109
    v_cvt_pk_bf16_f32 v37, v110, v111
    v_exp_f32 v114, v114
    v_exp_f32 v115, v115
    v_mfma_f32_32x32x16_bf16 v[92:107], v[152:155], v[8:11], v[92:107]
    v_cvt_pk_bf16_f32 v38, v112, v113
    v_cvt_pk_bf16_f32 v39, v114, v115
    v_exp_f32 v116, v116
    v_exp_f32 v117, v117
    v_mfma_f32_32x32x16_bf16 v[76:91], v[172:175], v[36:39], v[76:91]
    buffer_load_dwordx4 v[144:147], v1, s[12:15], s50 offen offset:1024
    v_exp_f32 v118, v118
    v_exp_f32 v119, v119
    v_cvt_pk_bf16_f32 v40, v116, v117
    v_exp_f32 v120, v120
    v_cvt_pk_bf16_f32 v41, v118, v119
    v_exp_f32 v121, v121
    v_exp_f32 v122, v122
    v_exp_f32 v123, v123
    v_cvt_pk_bf16_f32 v42, v120, v121
    v_cvt_pk_bf16_f32 v43, v122, v123
    s_setprio 1
    v_mfma_f32_32x32x16_bf16 v[108:123], v[148:151], v[12:15], 0
    s_add_u32 s52, s52, 4096
    buffer_load_dwordx4 v[172:175], v1, s[12:15], s52 offen offset:2048
    v_exp_f32 v92, v92
    v_exp_f32 v93, v93
    v_exp_f32 v94, v94
    v_mfma_f32_32x32x16_bf16 v[76:91], v[176:179], v[40:43], v[76:91]
    v_exp_f32 v95, v95
    v_exp_f32 v96, v96
    v_exp_f32 v97, v97
    v_smfmac_f32_16x16x64_bf16 v[56:59], v[44:47], v[36:43], v48
    v_cvt_pk_bf16_f32 v36, v92, v93
    v_cvt_pk_bf16_f32 v37, v94, v95
    v_exp_f32 v98, v98
    v_exp_f32 v99, v99
    v_mfma_f32_32x32x16_bf16 v[108:123], v[152:155], v[16:19], v[108:123]
    buffer_load_dwordx4 v[176:179], v1, s[12:15], s52 offen offset:3072
    v_cvt_pk_bf16_f32 v38, v96, v97
    v_cvt_pk_bf16_f32 v39, v98, v99
    v_exp_f32 v100, v100
    v_exp_f32 v101, v101
    s_waitcnt vmcnt(21)
    v_mfma_f32_32x32x16_bf16 v[60:75], v[180:183], v[36:39], v[60:75]
    v_exp_f32 v102, v102
    v_exp_f32 v103, v103
    v_cvt_pk_bf16_f32 v40, v100, v101
    v_exp_f32 v104, v104
    v_cvt_pk_bf16_f32 v41, v102, v103
    v_exp_f32 v105, v105
    v_exp_f32 v106, v106
    v_exp_f32 v107, v107
    v_cvt_pk_bf16_f32 v42, v104, v105
    v_cvt_pk_bf16_f32 v43, v106, v107
    s_add_u32 m0, s62, 73728
    s_add_u32 s64, s61, 1179648
    buffer_load_dwordx4 v244, s[36:39], s64 offen  lds
recurrent_scan__softmax_full_mha__moe_arch_mod__prompt_kernel_wo_53:
    s_add_u32 m0, s62, 81920
    s_add_u32 s64, s61, 1310720
    buffer_load_dwordx4 v244, s[36:39], s64 offen  lds
recurrent_scan__softmax_full_mha__moe_arch_mod__prompt_kernel_wo_54:
    s_waitcnt vmcnt(19)
    v_mfma_f32_32x32x16_bf16 v[92:107], v[156:159], v[4:7], 0
    v_exp_f32 v108, v108
    v_exp_f32 v109, v109
    v_exp_f32 v110, v110
    v_mfma_f32_32x32x16_bf16 v[60:75], v[184:187], v[40:43], v[60:75]
    s_and_b32 s54, s54, s55
    s_cbranch_scc1 recurrent_scan__softmax_full_mha__moe_arch_mod__prompt_kernel_nb_55
    s_call_b64 s[56:57], recurrent_scan__softmax_full_mha__moe_arch_mod__prompt_kernel_kvspin
recurrent_scan__softmax_full_mha__moe_arch_mod__prompt_kernel_nb_55:
    s_ff1_i32_b32 s51, s54
    s_bitset0_b32 s55, s51
    s_add_u32 s51, s51, s45
    s_and_b32 s51, s51, 15
    s_lshl_b32 s51, s51, 14
    s_add_u32 s51, s51, s63
    s_mov_b32 s50, s51
    buffer_load_dwordx4 v[148:151], v1, s[12:15], s50 offen offset:0
    v_exp_f32 v111, v111
    v_exp_f32 v112, v112
    v_exp_f32 v113, v113
    v_smfmac_f32_16x16x64_bf16 v[52:55], v[44:47], v[36:43], v48
    v_cvt_pk_bf16_f32 v36, v108, v109
    v_cvt_pk_bf16_f32 v37, v110, v111
    v_exp_f32 v114, v114
    v_exp_f32 v115, v115
    v_mfma_f32_32x32x16_bf16 v[92:107], v[160:163], v[8:11], v[92:107]
    v_cvt_pk_bf16_f32 v38, v112, v113
    v_cvt_pk_bf16_f32 v39, v114, v115
    v_exp_f32 v116, v116
    v_exp_f32 v117, v117
    v_mfma_f32_32x32x16_bf16 v[76:91], v[180:183], v[36:39], v[76:91]
    buffer_load_dwordx4 v[152:155], v1, s[12:15], s50 offen offset:1024
    v_exp_f32 v118, v118
    v_exp_f32 v119, v119
    v_cvt_pk_bf16_f32 v40, v116, v117
    v_exp_f32 v120, v120
    v_cvt_pk_bf16_f32 v41, v118, v119
    v_exp_f32 v121, v121
    v_exp_f32 v122, v122
    v_exp_f32 v123, v123
    v_cvt_pk_bf16_f32 v42, v120, v121
    v_cvt_pk_bf16_f32 v43, v122, v123
    s_setprio 0
    v_mfma_f32_32x32x16_bf16 v[108:123], v[156:159], v[12:15], 0
    s_mov_b32 s52, s51
    buffer_load_dwordx4 v[180:183], v1, s[12:15], s52 offen offset:2048
    v_exp_f32 v92, v92
    v_exp_f32 v93, v93
    v_exp_f32 v94, v94
    v_mfma_f32_32x32x16_bf16 v[76:91], v[184:187], v[40:43], v[76:91]
    v_exp_f32 v95, v95
    v_exp_f32 v96, v96
    v_exp_f32 v97, v97
    v_smfmac_f32_16x16x64_bf16 v[56:59], v[44:47], v[36:43], v48
    v_cvt_pk_bf16_f32 v36, v92, v93
    v_cvt_pk_bf16_f32 v37, v94, v95
    v_exp_f32 v98, v98
    v_exp_f32 v99, v99
    v_mfma_f32_32x32x16_bf16 v[108:123], v[160:163], v[16:19], v[108:123]
    buffer_load_dwordx4 v[184:187], v1, s[12:15], s52 offen offset:3072
    v_cvt_pk_bf16_f32 v38, v96, v97
    v_cvt_pk_bf16_f32 v39, v98, v99
    v_exp_f32 v100, v100
    v_exp_f32 v101, v101
    s_waitcnt vmcnt(22)
    v_mfma_f32_32x32x16_bf16 v[60:75], v[188:191], v[36:39], v[60:75]
    v_exp_f32 v102, v102
    v_exp_f32 v103, v103
    v_cvt_pk_bf16_f32 v40, v100, v101
    v_exp_f32 v104, v104
    v_cvt_pk_bf16_f32 v41, v102, v103
    v_exp_f32 v105, v105
    v_exp_f32 v106, v106
    v_exp_f32 v107, v107
    v_cvt_pk_bf16_f32 v42, v104, v105
    v_cvt_pk_bf16_f32 v43, v106, v107
    s_waitcnt vmcnt(13)
    s_and_b32 s64, s2, 15
    s_lshl_b32 s64, s64, 7
    s_add_u32 s64, s64, 21479424
    v_mov_b32 v248, s64
    v_mov_b32 v249, 1
    s_mov_b64 exec, 1
    buffer_atomic_add v249, v248, s[12:15], 0 offen sc1
    s_mov_b64 exec, -1
    s_add_u32 m0, s62, 90112
    s_add_u32 s64, s61, 1441792
    buffer_load_dwordx4 v244, s[36:39], s64 offen  lds
recurrent_scan__softmax_full_mha__moe_arch_mod__prompt_kernel_wo_56:
    v_mfma_f32_32x32x16_bf16 v[92:107], v[132:135], v[4:7], 0
    v_exp_f32 v108, v108
    v_exp_f32 v109, v109
    v_exp_f32 v110, v110
    v_mfma_f32_32x32x16_bf16 v[60:75], v[192:195], v[40:43], v[60:75]
    s_add_u32 s50, s50, 4096
    buffer_load_dwordx4 v[156:159], v1, s[12:15], s50 offen offset:0
    v_exp_f32 v111, v111
    v_exp_f32 v112, v112
    v_exp_f32 v113, v113
    v_smfmac_f32_16x16x64_bf16 v[52:55], v[44:47], v[36:43], v48
    v_cvt_pk_bf16_f32 v36, v108, v109
    v_cvt_pk_bf16_f32 v37, v110, v111
    v_exp_f32 v114, v114
    v_exp_f32 v115, v115
    v_mfma_f32_32x32x16_bf16 v[92:107], v[136:139], v[8:11], v[92:107]
    v_cvt_pk_bf16_f32 v38, v112, v113
    v_cvt_pk_bf16_f32 v39, v114, v115
    v_exp_f32 v116, v116
    v_exp_f32 v117, v117
    v_mfma_f32_32x32x16_bf16 v[76:91], v[188:191], v[36:39], v[76:91]
    buffer_load_dwordx4 v[160:163], v1, s[12:15], s50 offen offset:1024
    v_exp_f32 v118, v118
    v_exp_f32 v119, v119
    v_cvt_pk_bf16_f32 v40, v116, v117
    v_exp_f32 v120, v120
    v_cvt_pk_bf16_f32 v41, v118, v119
    v_exp_f32 v121, v121
    v_exp_f32 v122, v122
    v_exp_f32 v123, v123
    v_cvt_pk_bf16_f32 v42, v120, v121
    v_cvt_pk_bf16_f32 v43, v122, v123
    s_barrier
    s_setprio 3
    v_mfma_f32_32x32x16_bf16 v[108:123], v[132:135], v[12:15], 0
    s_add_u32 s52, s52, 4096
    buffer_load_dwordx4 v[188:191], v1, s[12:15], s52 offen offset:2048
    v_exp_f32 v92, v92
    v_exp_f32 v93, v93
    v_exp_f32 v94, v94
    v_mfma_f32_32x32x16_bf16 v[76:91], v[192:195], v[40:43], v[76:91]
    v_exp_f32 v95, v95
    v_exp_f32 v96, v96
    v_exp_f32 v97, v97
    v_smfmac_f32_16x16x64_bf16 v[56:59], v[44:47], v[36:43], v48
    v_cvt_pk_bf16_f32 v36, v92, v93
    v_cvt_pk_bf16_f32 v37, v94, v95
    v_exp_f32 v98, v98
    v_exp_f32 v99, v99
    v_mfma_f32_32x32x16_bf16 v[108:123], v[136:139], v[16:19], v[108:123]
    buffer_load_dwordx4 v[192:195], v1, s[12:15], s52 offen offset:3072
    v_cvt_pk_bf16_f32 v38, v96, v97
    v_cvt_pk_bf16_f32 v39, v98, v99
    v_exp_f32 v100, v100
    v_exp_f32 v101, v101
    s_waitcnt vmcnt(18)
    v_mfma_f32_32x32x16_bf16 v[60:75], v[164:167], v[36:39], v[60:75]
    v_exp_f32 v102, v102
    v_exp_f32 v103, v103
    v_cvt_pk_bf16_f32 v40, v100, v101
    v_exp_f32 v104, v104
    v_cvt_pk_bf16_f32 v41, v102, v103
    v_exp_f32 v105, v105
    v_exp_f32 v106, v106
    v_exp_f32 v107, v107
    v_cvt_pk_bf16_f32 v42, v104, v105
    v_cvt_pk_bf16_f32 v43, v106, v107
    s_add_u32 m0, s62, 98304
    s_add_u32 s64, s61, 1572864
    buffer_load_dwordx4 v244, s[36:39], s64 offen  lds
recurrent_scan__softmax_full_mha__moe_arch_mod__prompt_kernel_wo_57:
    s_add_u32 m0, s62, 106496
    s_add_u32 s64, s61, 1703936
    buffer_load_dwordx4 v244, s[36:39], s64 offen  lds
recurrent_scan__softmax_full_mha__moe_arch_mod__prompt_kernel_wo_58:
    s_waitcnt vmcnt(16)
    v_mfma_f32_32x32x16_bf16 v[92:107], v[140:143], v[4:7], 0
    v_exp_f32 v108, v108
    v_exp_f32 v109, v109
    v_exp_f32 v110, v110
    v_mfma_f32_32x32x16_bf16 v[60:75], v[168:171], v[40:43], v[60:75]
    v_exp_f32 v111, v111
    v_exp_f32 v112, v112
    v_exp_f32 v113, v113
    v_smfmac_f32_16x16x64_bf16 v[52:55], v[44:47], v[36:43], v48
    v_cvt_pk_bf16_f32 v36, v108, v109
    v_cvt_pk_bf16_f32 v37, v110, v111
    v_exp_f32 v114, v114
    v_exp_f32 v115, v115
    v_mfma_f32_32x32x16_bf16 v[92:107], v[144:147], v[8:11], v[92:107]
    v_cvt_pk_bf16_f32 v38, v112, v113
    v_cvt_pk_bf16_f32 v39, v114, v115
    v_exp_f32 v116, v116
    v_exp_f32 v117, v117
    v_mfma_f32_32x32x16_bf16 v[76:91], v[164:167], v[36:39], v[76:91]
    v_exp_f32 v118, v118
    v_exp_f32 v119, v119
    v_cvt_pk_bf16_f32 v40, v116, v117
    v_exp_f32 v120, v120
    v_cvt_pk_bf16_f32 v41, v118, v119
    v_exp_f32 v121, v121
    v_exp_f32 v122, v122
    v_exp_f32 v123, v123
    v_cvt_pk_bf16_f32 v42, v120, v121
    v_cvt_pk_bf16_f32 v43, v122, v123
    s_setprio 2
    v_readlane_b32 s64, v210, 0
    v_readlane_b32 s65, v210, 1
    v_readlane_b32 s66, v210, 2
    v_readlane_b32 s67, v210, 3
    v_readlane_b32 s68, v210, 4
    v_readlane_b32 s69, v210, 5
    v_readlane_b32 s70, v210, 6
    v_readlane_b32 s71, v210, 7
    s_lshl_b32 s72, s45, 2
    s_and_b32 s73, s3, 3
    s_add_u32 s72, s72, s73
    s_mov_b32 s58, 0
    s_lshr_b32 s73, s64, 5
    s_cmp_eq_u32 s73, s72
    s_cselect_b32 s58, 1, s58
    s_lshr_b32 s73, s65, 5
    s_cmp_eq_u32 s73, s72
    s_cselect_b32 s58, 1, s58
    s_lshr_b32 s73, s66, 5
    s_cmp_eq_u32 s73, s72
    s_cselect_b32 s58, 1, s58
    s_lshr_b32 s73, s67, 5
    s_cmp_eq_u32 s73, s72
    s_cselect_b32 s58, 1, s58
    s_lshr_b32 s73, s68, 5
    s_cmp_eq_u32 s73, s72
    s_cselect_b32 s58, 1, s58
    s_lshr_b32 s73, s69, 5
    s_cmp_eq_u32 s73, s72
    s_cselect_b32 s58, 1, s58
    s_lshr_b32 s73, s70, 5
    s_cmp_eq_u32 s73, s72
    s_cselect_b32 s58, 1, s58
    s_lshr_b32 s73, s71, 5
    s_cmp_eq_u32 s73, s72
    s_cselect_b32 s58, 1, s58
    s_cmp_lg_u32 s58, 0
    s_cbranch_scc1 recurrent_scan__softmax_full_mha__moe_arch_mod__prompt_kernel_rdet
recurrent_scan__softmax_full_mha__moe_arch_mod__prompt_kernel_rdet_done:
    v_mfma_f32_32x32x16_bf16 v[108:123], v[140:143], v[12:15], 0
    v_exp_f32 v92, v92
    v_exp_f32 v93, v93
    v_exp_f32 v94, v94
    v_mfma_f32_32x32x16_bf16 v[76:91], v[168:171], v[40:43], v[76:91]
    v_exp_f32 v95, v95
    v_exp_f32 v96, v96
    v_exp_f32 v97, v97
    v_smfmac_f32_16x16x64_bf16 v[56:59], v[44:47], v[36:43], v48
    v_cvt_pk_bf16_f32 v36, v92, v93
    v_cvt_pk_bf16_f32 v37, v94, v95
    v_exp_f32 v98, v98
    v_exp_f32 v99, v99
    v_mfma_f32_32x32x16_bf16 v[108:123], v[144:147], v[16:19], v[108:123]
    v_cvt_pk_bf16_f32 v38, v96, v97
    v_cvt_pk_bf16_f32 v39, v98, v99
    v_exp_f32 v100, v100
    v_exp_f32 v101, v101
    s_waitcnt vmcnt(15)
    v_mfma_f32_32x32x16_bf16 v[60:75], v[172:175], v[36:39], v[60:75]
    v_exp_f32 v102, v102
    v_exp_f32 v103, v103
    v_cvt_pk_bf16_f32 v40, v100, v101
    v_exp_f32 v104, v104
    v_cvt_pk_bf16_f32 v41, v102, v103
    v_exp_f32 v105, v105
    v_exp_f32 v106, v106
    v_exp_f32 v107, v107
    v_cvt_pk_bf16_f32 v42, v104, v105
    v_cvt_pk_bf16_f32 v43, v106, v107
    s_add_u32 m0, s62, 114688
    s_add_u32 s64, s61, 1835008
    buffer_load_dwordx4 v244, s[36:39], s64 offen  lds
recurrent_scan__softmax_full_mha__moe_arch_mod__prompt_kernel_wo_59:
    s_waitcnt vmcnt(11)
    v_mfma_f32_32x32x16_bf16 v[92:107], v[148:151], v[4:7], 0
    v_exp_f32 v108, v108
    v_exp_f32 v109, v109
    v_exp_f32 v110, v110
    v_mfma_f32_32x32x16_bf16 v[60:75], v[176:179], v[40:43], v[60:75]
    v_exp_f32 v111, v111
    v_exp_f32 v112, v112
    v_exp_f32 v113, v113
    v_smfmac_f32_16x16x64_bf16 v[52:55], v[44:47], v[36:43], v48
    v_cvt_pk_bf16_f32 v36, v108, v109
    v_cvt_pk_bf16_f32 v37, v110, v111
    v_exp_f32 v114, v114
    v_exp_f32 v115, v115
    v_mfma_f32_32x32x16_bf16 v[92:107], v[152:155], v[8:11], v[92:107]
    v_cvt_pk_bf16_f32 v38, v112, v113
    v_cvt_pk_bf16_f32 v39, v114, v115
    v_exp_f32 v116, v116
    v_exp_f32 v117, v117
    v_mfma_f32_32x32x16_bf16 v[76:91], v[172:175], v[36:39], v[76:91]
    v_exp_f32 v118, v118
    v_exp_f32 v119, v119
    v_cvt_pk_bf16_f32 v40, v116, v117
    v_exp_f32 v120, v120
    v_cvt_pk_bf16_f32 v41, v118, v119
    v_exp_f32 v121, v121
    v_exp_f32 v122, v122
    v_exp_f32 v123, v123
    v_cvt_pk_bf16_f32 v42, v120, v121
    v_cvt_pk_bf16_f32 v43, v122, v123
    s_setprio 1
    s_cmp_lg_u32 s58, 0
    s_cbranch_scc1 recurrent_scan__softmax_full_mha__moe_arch_mod__prompt_kernel_rfet
recurrent_scan__softmax_full_mha__moe_arch_mod__prompt_kernel_rfet_done:
    s_and_b32 s60, s44, 3
    s_lshl_b32 s64, s45, 2
    s_and_b32 s65, s3, 3
    s_add_u32 s64, s64, s65
    s_lshl_b32 s50, s64, 16
    s_lshl_b32 s65, s48, 14
    s_add_u32 s50, s50, s65
    s_add_u32 s50, s50, 16777216
    s_add_u32 s51, s50, 32768
    s_lshl_b32 s64, s64, 1
    s_add_u32 s64, s64, s48
    s_lshl_b32 s64, s64, 7
    s_add_u32 s64, s64, 21430272
    v_mov_b32 v237, s64
    s_mov_b32 s52, 0
    s_mov_b32 s73, 0x1111
    v_mfma_f32_32x32x16_bf16 v[108:123], v[148:151], v[12:15], 0
    v_exp_f32 v92, v92
    v_exp_f32 v93, v93
    v_exp_f32 v94, v94
    v_mfma_f32_32x32x16_bf16 v[76:91], v[176:179], v[40:43], v[76:91]
    v_exp_f32 v95, v95
    v_exp_f32 v96, v96
    v_exp_f32 v97, v97
    v_smfmac_f32_16x16x64_bf16 v[56:59], v[44:47], v[36:43], v48
    v_cvt_pk_bf16_f32 v36, v92, v93
    v_cvt_pk_bf16_f32 v37, v94, v95
    v_exp_f32 v98, v98
    v_exp_f32 v99, v99
    v_mfma_f32_32x32x16_bf16 v[108:123], v[152:155], v[16:19], v[108:123]
    v_cvt_pk_bf16_f32 v38, v96, v97
    v_cvt_pk_bf16_f32 v39, v98, v99
    v_exp_f32 v100, v100
    v_exp_f32 v101, v101
    s_waitcnt vmcnt(10)
    v_mfma_f32_32x32x16_bf16 v[60:75], v[180:183], v[36:39], v[60:75]
    v_exp_f32 v102, v102
    v_exp_f32 v103, v103
    v_cvt_pk_bf16_f32 v40, v100, v101
    v_exp_f32 v104, v104
    v_cvt_pk_bf16_f32 v41, v102, v103
    v_exp_f32 v105, v105
    v_exp_f32 v106, v106
    v_exp_f32 v107, v107
    v_cvt_pk_bf16_f32 v42, v104, v105
    v_cvt_pk_bf16_f32 v43, v106, v107
    s_cmp_ge_u32 s3, 6
    s_cbranch_scc1 recurrent_scan__softmax_full_mha__moe_arch_mod__prompt_kernel_wo_60
    s_add_u32 m0, s62, 122880
    s_add_u32 s64, s61, 1966080
    buffer_load_dwordx4 v244, s[36:39], s64 offen  lds
recurrent_scan__softmax_full_mha__moe_arch_mod__prompt_kernel_wo_60:
    s_waitcnt vmcnt(5)
    v_mfma_f32_32x32x16_bf16 v[92:107], v[156:159], v[4:7], 0
    v_exp_f32 v108, v108
    v_exp_f32 v109, v109
    v_exp_f32 v110, v110
    v_mfma_f32_32x32x16_bf16 v[60:75], v[184:187], v[40:43], v[60:75]
    v_exp_f32 v111, v111
    v_exp_f32 v112, v112
    v_exp_f32 v113, v113
    v_smfmac_f32_16x16x64_bf16 v[52:55], v[44:47], v[36:43], v48
    v_cvt_pk_bf16_f32 v36, v108, v109
    v_cvt_pk_bf16_f32 v37, v110, v111
    v_exp_f32 v114, v114
    v_exp_f32 v115, v115
    v_mfma_f32_32x32x16_bf16 v[92:107], v[160:163], v[8:11], v[92:107]
    v_cvt_pk_bf16_f32 v38, v112, v113
    v_cvt_pk_bf16_f32 v39, v114, v115
    v_exp_f32 v116, v116
    v_exp_f32 v117, v117
    v_mfma_f32_32x32x16_bf16 v[76:91], v[180:183], v[36:39], v[76:91]
    v_exp_f32 v118, v118
    v_exp_f32 v119, v119
    v_cvt_pk_bf16_f32 v40, v116, v117
    v_exp_f32 v120, v120
    v_cvt_pk_bf16_f32 v41, v118, v119
    v_exp_f32 v121, v121
    v_exp_f32 v122, v122
    v_exp_f32 v123, v123
    v_cvt_pk_bf16_f32 v42, v120, v121
    v_cvt_pk_bf16_f32 v43, v122, v123
    s_setprio 0
    v_mfma_f32_32x32x16_bf16 v[108:123], v[156:159], v[12:15], 0
    v_exp_f32 v92, v92
    v_exp_f32 v93, v93
    v_exp_f32 v94, v94
    v_mfma_f32_32x32x16_bf16 v[76:91], v[184:187], v[40:43], v[76:91]
    v_exp_f32 v95, v95
    v_exp_f32 v96, v96
    v_exp_f32 v97, v97
    v_smfmac_f32_16x16x64_bf16 v[56:59], v[44:47], v[36:43], v48
    v_cvt_pk_bf16_f32 v36, v92, v93
    v_cvt_pk_bf16_f32 v37, v94, v95
    v_exp_f32 v98, v98
    v_exp_f32 v99, v99
    v_mfma_f32_32x32x16_bf16 v[108:123], v[160:163], v[16:19], v[108:123]
    v_cvt_pk_bf16_f32 v38, v96, v97
    v_cvt_pk_bf16_f32 v39, v98, v99
    v_exp_f32 v100, v100
    v_exp_f32 v101, v101
    s_waitcnt vmcnt(4)
    v_mfma_f32_32x32x16_bf16 v[60:75], v[188:191], v[36:39], v[60:75]
    v_exp_f32 v102, v102
    v_exp_f32 v103, v103
    v_cvt_pk_bf16_f32 v40, v100, v101
    v_exp_f32 v104, v104
    v_cvt_pk_bf16_f32 v41, v102, v103
    v_exp_f32 v105, v105
    v_exp_f32 v106, v106
    v_exp_f32 v107, v107
    v_cvt_pk_bf16_f32 v42, v104, v105
    v_cvt_pk_bf16_f32 v43, v106, v107
    s_waitcnt vmcnt(3)
    v_mfma_f32_32x32x16_bf16 v[92:107], v[132:135], v[4:7], 0
    v_exp_f32 v108, v108
    v_exp_f32 v109, v109
    v_exp_f32 v110, v110
    v_mfma_f32_32x32x16_bf16 v[60:75], v[192:195], v[40:43], v[60:75]
    v_exp_f32 v111, v111
    v_exp_f32 v112, v112
    v_exp_f32 v113, v113
    v_smfmac_f32_16x16x64_bf16 v[52:55], v[44:47], v[36:43], v48
    v_cvt_pk_bf16_f32 v36, v108, v109
    v_cvt_pk_bf16_f32 v37, v110, v111
    v_exp_f32 v114, v114
    v_exp_f32 v115, v115
    v_mfma_f32_32x32x16_bf16 v[92:107], v[136:139], v[8:11], v[92:107]
    v_cvt_pk_bf16_f32 v38, v112, v113
    v_cvt_pk_bf16_f32 v39, v114, v115
    v_exp_f32 v116, v116
    v_exp_f32 v117, v117
    v_mfma_f32_32x32x16_bf16 v[76:91], v[188:191], v[36:39], v[76:91]
    v_exp_f32 v118, v118
    v_exp_f32 v119, v119
    v_cvt_pk_bf16_f32 v40, v116, v117
    v_exp_f32 v120, v120
    v_cvt_pk_bf16_f32 v41, v118, v119
    v_exp_f32 v121, v121
    v_exp_f32 v122, v122
    v_exp_f32 v123, v123
    v_cvt_pk_bf16_f32 v42, v120, v121
    v_cvt_pk_bf16_f32 v43, v122, v123
    s_setprio 0
    s_nop 0
    v_mfma_f32_32x32x16_bf16 v[76:91], v[192:195], v[40:43], v[76:91]
    v_smfmac_f32_16x16x64_bf16 v[56:59], v[44:47], v[36:43], v48
    s_nop 7
    s_nop 7
    s_mov_b64 s[74:75], 0
    v_add_f32 v52, v52, v53
    v_add_f32 v56, v56, v57
    s_lshl_b32 s64, s3, 12
    s_add_u32 s64, s64, 131072
    v_add_u32 v124, s64, v1
    v_xor_b32 v125, 16384, v124
    s_lshl_b32 s64, s3, 8
    s_add_u32 s64, s64, 129024
    v_lshrrev_b32 v126, 2, v1
    v_add_u32 v126, s64, v126
    v_xor_b32 v127, 1024, v126
    s_cmp_eq_u32 s48, 0
    s_cbranch_scc1 recurrent_scan__softmax_full_mha__moe_arch_mod__prompt_kernel_kh0
    ds_write_b128 v124, v[60:63] offset:0
    ds_write_b128 v124, v[64:67] offset:1024
    ds_write_b128 v124, v[68:71] offset:2048
    ds_write_b128 v124, v[72:75] offset:3072
    ds_write_b32 v126, v52
    s_waitcnt lgkmcnt(0)
    v_mov_b32 v60, v76
    v_mov_b32 v61, v77
    v_mov_b32 v62, v78
    v_mov_b32 v63, v79
    v_mov_b32 v64, v80
    v_mov_b32 v65, v81
    v_mov_b32 v66, v82
    v_mov_b32 v67, v83
    v_mov_b32 v68, v84
    v_mov_b32 v69, v85
    v_mov_b32 v70, v86
    v_mov_b32 v71, v87
    v_mov_b32 v72, v88
    v_mov_b32 v73, v89
    v_mov_b32 v74, v90
    v_mov_b32 v75, v91
    v_mov_b32 v52, v56
    s_branch recurrent_scan__softmax_full_mha__moe_arch_mod__prompt_kernel_khj
recurrent_scan__softmax_full_mha__moe_arch_mod__prompt_kernel_kh0:
    ds_write_b128 v124, v[76:79] offset:0
    ds_write_b128 v124, v[80:83] offset:1024
    ds_write_b128 v124, v[84:87] offset:2048
    ds_write_b128 v124, v[88:91] offset:3072
    ds_write_b32 v126, v56
recurrent_scan__softmax_full_mha__moe_arch_mod__prompt_kernel_khj:
    s_waitcnt lgkmcnt(0)
    s_barrier
    ds_read_b128 v[76:79], v125 offset:0
    ds_read_b128 v[80:83], v125 offset:1024
    ds_read_b128 v[84:87], v125 offset:2048
    ds_read_b128 v[88:91], v125 offset:3072
    ds_read_b32 v56, v127
    s_lshl_b32 s64, s45, 2
    s_and_b32 s65, s3, 2
    s_add_u32 s64, s64, s65
    s_lshr_b32 s65, s3, 2
    s_add_u32 s64, s64, s65
    s_lshl_b32 s64, s64, 6
    s_lshl_b32 s65, s44, 1
    s_and_b32 s66, s3, 1
    s_add_u32 s65, s65, s66
    s_add_u32 s64, s64, s65
    s_lshl_b32 s68, s64, 10
    s_add_u32 s68, s68, 16777216
    v_bfe_u32 v128, v0, 4, 1
    v_lshlrev_b32 v128, 15, v128
    v_lshrrev_b32 v129, 5, v0
    v_lshl_add_u32 v128, v129, 9, v128
    v_and_b32 v129, 15, v0
    v_lshl_add_u32 v128, v129, 4, v128
    s_waitcnt lgkmcnt(0)
    v_add_f32 v60, v60, v76
    v_add_f32 v61, v61, v77
    v_add_f32 v62, v62, v78
    v_add_f32 v63, v63, v79
    v_add_f32 v64, v64, v80
    v_add_f32 v65, v65, v81
    v_add_f32 v66, v66, v82
    v_add_f32 v67, v67, v83
    v_add_f32 v68, v68, v84
    v_add_f32 v69, v69, v85
    v_add_f32 v70, v70, v86
    v_add_f32 v71, v71, v87
    v_add_f32 v72, v72, v88
    v_add_f32 v73, v73, v89
    v_add_f32 v74, v74, v90
    v_add_f32 v75, v75, v91
    v_add_f32 v52, v52, v56
    v_mov_b32 v125, 0
recurrent_scan__softmax_full_mha__moe_arch_mod__prompt_kernel_fin:
    v_rcp_f32 v124, v52
    s_mov_b32 s64, 0x2b800000
    v_pk_mul_f32 v[76:77], v[60:61], v[124:125] op_sel_hi:[1,0]
    v_cvt_pk_bf16_f32 v36, v76, v77
    v_pk_mul_f32 v[78:79], v[62:63], v[124:125] op_sel_hi:[1,0]
    v_cvt_pk_bf16_f32 v37, v78, v79
    v_pk_mul_f32 v[80:81], v[64:65], v[124:125] op_sel_hi:[1,0]
    v_cvt_pk_bf16_f32 v38, v80, v81
    v_pk_mul_f32 v[82:83], v[66:67], v[124:125] op_sel_hi:[1,0]
    v_cvt_pk_bf16_f32 v39, v82, v83
    buffer_store_dwordx4 v[36:39], v128, s[12:15], s68 offen offset:0 sc1
    v_pk_mul_f32 v[84:85], v[68:69], v[124:125] op_sel_hi:[1,0]
    v_cvt_pk_bf16_f32 v40, v84, v85
    v_pk_mul_f32 v[86:87], v[70:71], v[124:125] op_sel_hi:[1,0]
    v_cvt_pk_bf16_f32 v41, v86, v87
    v_pk_mul_f32 v[88:89], v[72:73], v[124:125] op_sel_hi:[1,0]
    v_cvt_pk_bf16_f32 v42, v88, v89
    v_pk_mul_f32 v[90:91], v[74:75], v[124:125] op_sel_hi:[1,0]
    v_cvt_pk_bf16_f32 v43, v90, v91
    buffer_store_dwordx4 v[40:43], v128, s[12:15], s68 offen offset:256 sc1
    v_mov_b32 v125, 0
    v_fmac_f32 v125, 0, v60
    v_fmac_f32 v125, 0, v61
    v_fmac_f32 v125, 0, v62
    v_fmac_f32 v125, 0, v63
    v_fmac_f32 v125, 0, v64
    v_fmac_f32 v125, 0, v65
    v_fmac_f32 v125, 0, v66
    v_fmac_f32 v125, 0, v67
    v_fmac_f32 v125, 0, v68
    v_fmac_f32 v125, 0, v69
    v_fmac_f32 v125, 0, v70
    v_fmac_f32 v125, 0, v71
    v_fmac_f32 v125, 0, v72
    v_fmac_f32 v125, 0, v73
    v_fmac_f32 v125, 0, v74
    v_fmac_f32 v125, 0, v75
    s_mov_b32 s65, 0x5d800000
    v_cmp_nle_f32 s[70:71], s64, v52
    v_cmp_nge_f32 s[66:67], s65, v52
    v_cmp_u_f32 vcc, v125, v125
    s_or_b64 s[70:71], s[70:71], s[66:67]
    s_or_b64 s[70:71], s[70:71], vcc
    s_andn2_b64 s[70:71], s[70:71], s[74:75]
    s_cmp_lg_u64 s[70:71], 0
    s_cbranch_scc1 recurrent_scan__softmax_full_mha__moe_arch_mod__prompt_kernel_slow0_
    v_lshrrev_b32 v241, 4, v0
    v_and_b32 v246, 1, v241
    v_lshlrev_b32 v247, 4, v246
    v_lshrrev_b32 v248, 1, v241
    v_lshl_add_u32 v247, v248, 2, v247
    v_bfe_u32 v248, v0, 2, 2
    v_add_u32 v247, v247, v248
    v_lshlrev_b32 v247, 7, v247
    v_and_b32 v248, 3, v0
    v_lshl_add_u32 v247, v248, 3, v247
    v_lshlrev_b32 v246, 1, v246
    v_bfe_u32 v248, v0, 3, 1
    v_or_b32 v246, v246, v248
    v_lshl_add_u32 v247, v246, 5, v247
    s_lshl_b32 s64, s48, 16
    v_add_u32 v228, s64, v247
    v_xor_b32 v229, 32, v228
    v_xor_b32 v230, 64, v228
    v_xor_b32 v231, 96, v228
    s_lshl_b32 s64, s45, 2
    s_and_b32 s65, s3, 2
    s_add_u32 s64, s64, s65
    s_lshr_b32 s65, s3, 2
    s_add_u32 s64, s64, s65
    s_lshl_b32 s64, s64, 1
    s_lshr_b32 s65, s44, 3
    s_add_u32 s64, s64, s65
    s_lshl_b32 s64, s64, 7
    s_add_u32 s64, s64, 21430272
    s_and_b32 s65, s44, 7
    s_lshl_b32 s65, s65, 1
    s_and_b32 s66, s3, 1
    s_add_u32 s65, s65, s66
    s_lshl_b32 s65, 1, s65
    s_waitcnt vmcnt(0)
    v_mov_b32 v246, s64
    v_mov_b32 v247, s65
    s_mov_b64 exec, 1
    buffer_atomic_or v247, v246, s[12:15], 0 offen sc1
    s_mov_b64 exec, -1
    s_barrier
    s_cmp_ge_u32 s3, 6
    s_cbranch_scc0 recurrent_scan__softmax_full_mha__moe_arch_mod__prompt_kernel_wo_61
    s_add_u32 m0, s62, 122880
    s_add_u32 s64, s61, 1966080
    buffer_load_dwordx4 v244, s[36:39], s64 offen  lds
recurrent_scan__softmax_full_mha__moe_arch_mod__prompt_kernel_wo_61:
    v_mov_b32 v236, 0
    s_mov_b64 exec, 1
    buffer_atomic_or v236, v237, s[12:15], 0 offen sc0 sc1
    s_mov_b64 exec, -1
    s_cmp_lg_u32 s58, 0
    s_cbranch_scc1 recurrent_scan__softmax_full_mha__moe_arch_mod__prompt_kernel_routed
    v_lshlrev_b32 v212, 16, v196
    v_and_b32 v213, 0xffff0000, v196
    v_sub_f32 v212, v212, v206
    v_sub_f32 v213, v213, v206
    v_cvt_pk_bf16_f32 v246, v212, v213
    v_lshlrev_b32 v212, 16, v246
    v_and_b32 v213, 0xffff0000, v246
    v_mul_f32 v212, v212, v207
    v_mul_f32 v213, v213, v207
    v_cvt_pk_bf16_f32 v246, v212, v213
    v_lshlrev_b32 v212, 16, v246
    v_and_b32 v213, 0xffff0000, v246
    v_lshlrev_b32 v214, 16, v197
    v_and_b32 v215, 0xffff0000, v197
    v_sub_f32 v214, v214, v206
    v_sub_f32 v215, v215, v206
    v_cvt_pk_bf16_f32 v246, v214, v215
    v_lshlrev_b32 v214, 16, v246
    v_and_b32 v215, 0xffff0000, v246
    v_mul_f32 v214, v214, v207
    v_mul_f32 v215, v215, v207
    v_cvt_pk_bf16_f32 v246, v214, v215
    v_lshlrev_b32 v214, 16, v246
    v_and_b32 v215, 0xffff0000, v246
    v_lshlrev_b32 v216, 16, v198
    v_and_b32 v217, 0xffff0000, v198
    v_sub_f32 v216, v216, v206
    v_sub_f32 v217, v217, v206
    v_cvt_pk_bf16_f32 v246, v216, v217
    v_lshlrev_b32 v216, 16, v246
    v_and_b32 v217, 0xffff0000, v246
    v_mul_f32 v216, v216, v207
    v_mul_f32 v217, v217, v207
    v_cvt_pk_bf16_f32 v246, v216, v217
    v_lshlrev_b32 v216, 16, v246
    v_and_b32 v217, 0xffff0000, v246
    v_lshlrev_b32 v218, 16, v199
    v_and_b32 v219, 0xffff0000, v199
    v_sub_f32 v218, v218, v206
    v_sub_f32 v219, v219, v206
    v_cvt_pk_bf16_f32 v246, v218, v219
    v_lshlrev_b32 v218, 16, v246
    v_and_b32 v219, 0xffff0000, v246
    v_mul_f32 v218, v218, v207
    v_mul_f32 v219, v219, v207
    v_cvt_pk_bf16_f32 v246, v218, v219
    v_lshlrev_b32 v218, 16, v246
    v_and_b32 v219, 0xffff0000, v246
    v_lshlrev_b32 v220, 16, v200
    v_and_b32 v221, 0xffff0000, v200
    v_sub_f32 v220, v220, v208
    v_sub_f32 v221, v221, v208
    v_cvt_pk_bf16_f32 v246, v220, v221
    v_lshlrev_b32 v220, 16, v246
    v_and_b32 v221, 0xffff0000, v246
    v_mul_f32 v220, v220, v209
    v_mul_f32 v221, v221, v209
    v_cvt_pk_bf16_f32 v246, v220, v221
    v_lshlrev_b32 v220, 16, v246
    v_and_b32 v221, 0xffff0000, v246
    v_lshlrev_b32 v222, 16, v201
    v_and_b32 v223, 0xffff0000, v201
    v_sub_f32 v222, v222, v208
    v_sub_f32 v223, v223, v208
    v_cvt_pk_bf16_f32 v246, v222, v223
    v_lshlrev_b32 v222, 16, v246
    v_and_b32 v223, 0xffff0000, v246
    v_mul_f32 v222, v222, v209
    v_mul_f32 v223, v223, v209
    v_cvt_pk_bf16_f32 v246, v222, v223
    v_lshlrev_b32 v222, 16, v246
    v_and_b32 v223, 0xffff0000, v246
    v_lshlrev_b32 v224, 16, v202
    v_and_b32 v225, 0xffff0000, v202
    v_sub_f32 v224, v224, v208
    v_sub_f32 v225, v225, v208
    v_cvt_pk_bf16_f32 v246, v224, v225
    v_lshlrev_b32 v224, 16, v246
    v_and_b32 v225, 0xffff0000, v246
    v_mul_f32 v224, v224, v209
    v_mul_f32 v225, v225, v209
    v_cvt_pk_bf16_f32 v246, v224, v225
    v_lshlrev_b32 v224, 16, v246
    v_and_b32 v225, 0xffff0000, v246
    v_lshlrev_b32 v226, 16, v203
    v_and_b32 v227, 0xffff0000, v203
    v_sub_f32 v226, v226, v208
    v_sub_f32 v227, v227, v208
    v_cvt_pk_bf16_f32 v246, v226, v227
    v_lshlrev_b32 v226, 16, v246
    v_and_b32 v227, 0xffff0000, v246
    v_mul_f32 v226, v226, v209
    v_mul_f32 v227, v227, v209
    v_cvt_pk_bf16_f32 v246, v226, v227
    v_lshlrev_b32 v226, 16, v246
    v_and_b32 v227, 0xffff0000, v246
recurrent_scan__softmax_full_mha__moe_arch_mod__prompt_kernel_routed_done:
    s_waitcnt vmcnt(0)
    v_readfirstlane_b32 s52, v236
    s_lshl_b32 s74, s60, 2
    s_mul_i32 s52, s52, 0x10001
    s_lshr_b32 s52, s52, s74
    s_lshr_b32 s74, s52, 1
    s_and_b32 s72, s52, s74
    s_lshr_b32 s74, s72, 2
    s_and_b32 s72, s72, s74
    s_and_b32 s72, s72, s73
    s_barrier
    s_cmp_lg_u32 s72, 0
    s_cbranch_scc1 recurrent_scan__softmax_full_mha__moe_arch_mod__prompt_kernel_og_62
    s_call_b64 s[44:45], recurrent_scan__softmax_full_mha__moe_arch_mod__prompt_kernel_ospin
recurrent_scan__softmax_full_mha__moe_arch_mod__prompt_kernel_og_62:
    s_ff1_i32_b32 s53, s72
    s_bitset0_b32 s73, s53
    s_bitset0_b32 s72, s53
    s_lshr_b32 s53, s53, 2
    s_add_u32 s53, s53, s60
    s_and_b32 s55, s53, 3
    s_lshl_b32 s53, s55, 12
    s_add_u32 s54, s53, s51
    s_add_u32 s53, s53, s50
    buffer_load_dwordx4 v[132:135], v1, s[12:15], s53 offen offset:0
    buffer_load_dwordx4 v[136:139], v1, s[12:15], s54 offen offset:0
    buffer_load_dwordx4 v[140:143], v1, s[12:15], s53 offen offset:1024
    buffer_load_dwordx4 v[144:147], v1, s[12:15], s54 offen offset:1024
    buffer_load_dwordx4 v[148:151], v1, s[12:15], s53 offen offset:2048
    buffer_load_dwordx4 v[152:155], v1, s[12:15], s54 offen offset:2048
    buffer_load_dwordx4 v[156:159], v1, s[12:15], s53 offen offset:3072
    buffer_load_dwordx4 v[160:163], v1, s[12:15], s54 offen offset:3072
    v_mul_f32 v246, 0xbfb8aa3b, v212
    v_mul_f32 v247, 0xbfb8aa3b, v213
    v_mul_f32 v248, 0xbfb8aa3b, v214
    v_mul_f32 v249, 0xbfb8aa3b, v215
    v_mul_f32 v250, 0xbfb8aa3b, v216
    v_mul_f32 v251, 0xbfb8aa3b, v217
    v_mul_f32 v252, 0xbfb8aa3b, v218
    v_mul_f32 v253, 0xbfb8aa3b, v219
    v_exp_f32 v246, v246
    v_exp_f32 v247, v247
    v_exp_f32 v248, v248
    v_exp_f32 v249, v249
    v_exp_f32 v250, v250
    v_exp_f32 v251, v251
    v_exp_f32 v252, v252
    v_exp_f32 v253, v253
    v_add_f32 v246, 1.0, v246
    v_add_f32 v247, 1.0, v247
    v_add_f32 v248, 1.0, v248
    v_add_f32 v249, 1.0, v249
    v_add_f32 v250, 1.0, v250
    v_add_f32 v251, 1.0, v251
    v_add_f32 v252, 1.0, v252
    v_add_f32 v253, 1.0, v253
    v_rcp_f32 v246, v246
    v_rcp_f32 v247, v247
    v_rcp_f32 v248, v248
    v_rcp_f32 v249, v249
    v_rcp_f32 v250, v250
    v_rcp_f32 v251, v251
    v_rcp_f32 v252, v252
    v_rcp_f32 v253, v253
    v_mul_f32 v212, v212, v246
    v_mul_f32 v213, v213, v247
    v_mul_f32 v214, v214, v248
    v_mul_f32 v215, v215, v249
    v_mul_f32 v216, v216, v250
    v_mul_f32 v217, v217, v251
    v_mul_f32 v218, v218, v252
    v_mul_f32 v219, v219, v253
    v_mul_f32 v246, 0xbfb8aa3b, v220
    v_mul_f32 v247, 0xbfb8aa3b, v221
    v_mul_f32 v248, 0xbfb8aa3b, v222
    v_mul_f32 v249, 0xbfb8aa3b, v223
    v_mul_f32 v250, 0xbfb8aa3b, v224
    v_mul_f32 v251, 0xbfb8aa3b, v225
    v_mul_f32 v252, 0xbfb8aa3b, v226
    v_mul_f32 v253, 0xbfb8aa3b, v227
    v_exp_f32 v246, v246
    v_exp_f32 v247, v247
    v_exp_f32 v248, v248
    v_exp_f32 v249, v249
    v_exp_f32 v250, v250
    v_exp_f32 v251, v251
    v_exp_f32 v252, v252
    v_exp_f32 v253, v253
    v_add_f32 v246, 1.0, v246
    v_add_f32 v247, 1.0, v247
    v_add_f32 v248, 1.0, v248
    v_add_f32 v249, 1.0, v249
    v_add_f32 v250, 1.0, v250
    v_add_f32 v251, 1.0, v251
    v_add_f32 v252, 1.0, v252
    v_add_f32 v253, 1.0, v253
    v_rcp_f32 v246, v246
    v_rcp_f32 v247, v247
    v_rcp_f32 v248, v248
    v_rcp_f32 v249, v249
    v_rcp_f32 v250, v250
    v_rcp_f32 v251, v251
    v_rcp_f32 v252, v252
    v_rcp_f32 v253, v253
    v_mul_f32 v220, v220, v246
    v_mul_f32 v221, v221, v247
    v_mul_f32 v222, v222, v248
    v_mul_f32 v223, v223, v249
    v_mul_f32 v224, v224, v250
    v_mul_f32 v225, v225, v251
    v_mul_f32 v226, v226, v252
    v_mul_f32 v227, v227, v253
    s_cmp_lg_u32 s72, 0
    s_cbranch_scc1 recurrent_scan__softmax_full_mha__moe_arch_mod__prompt_kernel_og_63
    s_call_b64 s[44:45], recurrent_scan__softmax_full_mha__moe_arch_mod__prompt_kernel_ospin
recurrent_scan__softmax_full_mha__moe_arch_mod__prompt_kernel_og_63:
    s_ff1_i32_b32 s53, s72
    s_bitset0_b32 s73, s53
    s_bitset0_b32 s72, s53
    s_lshr_b32 s53, s53, 2
    s_add_u32 s53, s53, s60
    s_and_b32 s56, s53, 3
    s_lshl_b32 s53, s56, 12
    s_add_u32 s54, s53, s51
    s_add_u32 s53, s53, s50
    buffer_load_dwordx4 v[164:167], v1, s[12:15], s53 offen offset:0
    buffer_load_dwordx4 v[168:171], v1, s[12:15], s54 offen offset:0
    buffer_load_dwordx4 v[172:175], v1, s[12:15], s53 offen offset:1024
    buffer_load_dwordx4 v[176:179], v1, s[12:15], s54 offen offset:1024
    buffer_load_dwordx4 v[180:183], v1, s[12:15], s53 offen offset:2048
    buffer_load_dwordx4 v[184:187], v1, s[12:15], s54 offen offset:2048
    buffer_load_dwordx4 v[188:191], v1, s[12:15], s53 offen offset:3072
    buffer_load_dwordx4 v[192:195], v1, s[12:15], s54 offen offset:3072
    s_lshl_b32 s64, s55, 14
    v_add_u32 v232, s64, v228
    v_add_u32 v233, s64, v229
    v_add_u32 v234, s64, v230
    v_add_u32 v235, s64, v231
    ds_read_b64_tr_b16 v[36:37], v232 offset:0
    ds_read_b64_tr_b16 v[38:39], v232 offset:1024
    ds_read_b64_tr_b16 v[40:41], v233 offset:0
    ds_read_b64_tr_b16 v[42:43], v233 offset:1024
    ds_read_b64_tr_b16 v[44:45], v234 offset:0
    ds_read_b64_tr_b16 v[46:47], v234 offset:1024
    ds_read_b64_tr_b16 v[48:49], v235 offset:0
    ds_read_b64_tr_b16 v[50:51], v235 offset:1024
    s_waitcnt vmcnt(14)
    s_waitcnt lgkmcnt(0)
    v_mfma_f32_16x16x32_bf16 v[4:7], v[36:39], v[132:135], 0
    ds_read_b64_tr_b16 v[52:53], v232 offset:4096
    v_mfma_f32_16x16x32_bf16 v[20:23], v[36:39], v[136:139], 0
    ds_read_b64_tr_b16 v[54:55], v232 offset:5120
    v_mfma_f32_16x16x32_bf16 v[8:11], v[40:43], v[132:135], 0
    ds_read_b64_tr_b16 v[56:57], v233 offset:4096
    v_mfma_f32_16x16x32_bf16 v[24:27], v[40:43], v[136:139], 0
    ds_read_b64_tr_b16 v[58:59], v233 offset:5120
    v_mfma_f32_16x16x32_bf16 v[12:15], v[44:47], v[132:135], 0
    ds_read_b64_tr_b16 v[60:61], v234 offset:4096
    v_mfma_f32_16x16x32_bf16 v[28:31], v[44:47], v[136:139], 0
    ds_read_b64_tr_b16 v[62:63], v234 offset:5120
    v_mfma_f32_16x16x32_bf16 v[16:19], v[48:51], v[132:135], 0
    ds_read_b64_tr_b16 v[64:65], v235 offset:4096
    v_mfma_f32_16x16x32_bf16 v[32:35], v[48:51], v[136:139], 0
    ds_read_b64_tr_b16 v[66:67], v235 offset:5120
    s_cmp_lg_u32 s72, 0
    s_cbranch_scc1 recurrent_scan__softmax_full_mha__moe_arch_mod__prompt_kernel_og_64
    s_call_b64 s[44:45], recurrent_scan__softmax_full_mha__moe_arch_mod__prompt_kernel_ospin
recurrent_scan__softmax_full_mha__moe_arch_mod__prompt_kernel_og_64:
    s_ff1_i32_b32 s53, s72
    s_bitset0_b32 s73, s53
    s_bitset0_b32 s72, s53
    s_lshr_b32 s53, s53, 2
    s_add_u32 s53, s53, s60
    s_and_b32 s57, s53, 3
    s_lshl_b32 s53, s57, 12
    s_add_u32 s54, s53, s51
    s_add_u32 s53, s53, s50
    buffer_load_dwordx4 v[68:71], v1, s[12:15], s53 offen offset:0
    buffer_load_dwordx4 v[72:75], v1, s[12:15], s54 offen offset:0
    buffer_load_dwordx4 v[76:79], v1, s[12:15], s53 offen offset:1024
    buffer_load_dwordx4 v[80:83], v1, s[12:15], s54 offen offset:1024
    buffer_load_dwordx4 v[84:87], v1, s[12:15], s53 offen offset:2048
    buffer_load_dwordx4 v[88:91], v1, s[12:15], s54 offen offset:2048
    buffer_load_dwordx4 v[92:95], v1, s[12:15], s53 offen offset:3072
    buffer_load_dwordx4 v[96:99], v1, s[12:15], s54 offen offset:3072
    s_waitcnt vmcnt(20)
    s_waitcnt lgkmcnt(0)
    v_mfma_f32_16x16x32_bf16 v[4:7], v[52:55], v[140:143], v[4:7]
    ds_read_b64_tr_b16 v[36:37], v232 offset:8192
    v_mfma_f32_16x16x32_bf16 v[20:23], v[52:55], v[144:147], v[20:23]
    ds_read_b64_tr_b16 v[38:39], v232 offset:9216
    v_mfma_f32_16x16x32_bf16 v[8:11], v[56:59], v[140:143], v[8:11]
    ds_read_b64_tr_b16 v[40:41], v233 offset:8192
    v_mfma_f32_16x16x32_bf16 v[24:27], v[56:59], v[144:147], v[24:27]
    ds_read_b64_tr_b16 v[42:43], v233 offset:9216
    v_mfma_f32_16x16x32_bf16 v[12:15], v[60:63], v[140:143], v[12:15]
    ds_read_b64_tr_b16 v[44:45], v234 offset:8192
    v_mfma_f32_16x16x32_bf16 v[28:31], v[60:63], v[144:147], v[28:31]
    ds_read_b64_tr_b16 v[46:47], v234 offset:9216
    v_mfma_f32_16x16x32_bf16 v[16:19], v[64:67], v[140:143], v[16:19]
    ds_read_b64_tr_b16 v[48:49], v235 offset:8192
    v_mfma_f32_16x16x32_bf16 v[32:35], v[64:67], v[144:147], v[32:35]
    ds_read_b64_tr_b16 v[50:51], v235 offset:9216
    s_waitcnt vmcnt(18)
    s_waitcnt lgkmcnt(0)
    v_mfma_f32_16x16x32_bf16 v[4:7], v[36:39], v[148:151], v[4:7]
    ds_read_b64_tr_b16 v[52:53], v232 offset:12288
    v_mfma_f32_16x16x32_bf16 v[20:23], v[36:39], v[152:155], v[20:23]
    ds_read_b64_tr_b16 v[54:55], v232 offset:13312
    v_mfma_f32_16x16x32_bf16 v[8:11], v[40:43], v[148:151], v[8:11]
    ds_read_b64_tr_b16 v[56:57], v233 offset:12288
    v_mfma_f32_16x16x32_bf16 v[24:27], v[40:43], v[152:155], v[24:27]
    ds_read_b64_tr_b16 v[58:59], v233 offset:13312
    v_mfma_f32_16x16x32_bf16 v[12:15], v[44:47], v[148:151], v[12:15]
    ds_read_b64_tr_b16 v[60:61], v234 offset:12288
    v_mfma_f32_16x16x32_bf16 v[28:31], v[44:47], v[152:155], v[28:31]
    ds_read_b64_tr_b16 v[62:63], v234 offset:13312
    v_mfma_f32_16x16x32_bf16 v[16:19], v[48:51], v[148:151], v[16:19]
    ds_read_b64_tr_b16 v[64:65], v235 offset:12288
    v_mfma_f32_16x16x32_bf16 v[32:35], v[48:51], v[152:155], v[32:35]
    ds_read_b64_tr_b16 v[66:67], v235 offset:13312
    s_lshl_b32 s64, s56, 14
    v_add_u32 v232, s64, v228
    v_add_u32 v233, s64, v229
    v_add_u32 v234, s64, v230
    v_add_u32 v235, s64, v231
    s_waitcnt vmcnt(16)
    s_waitcnt lgkmcnt(0)
    v_mfma_f32_16x16x32_bf16 v[4:7], v[52:55], v[156:159], v[4:7]
    ds_read_b64_tr_b16 v[36:37], v232 offset:0
    v_mfma_f32_16x16x32_bf16 v[20:23], v[52:55], v[160:163], v[20:23]
    ds_read_b64_tr_b16 v[38:39], v232 offset:1024
    v_mfma_f32_16x16x32_bf16 v[8:11], v[56:59], v[156:159], v[8:11]
    ds_read_b64_tr_b16 v[40:41], v233 offset:0
    v_mfma_f32_16x16x32_bf16 v[24:27], v[56:59], v[160:163], v[24:27]
    ds_read_b64_tr_b16 v[42:43], v233 offset:1024
    v_mfma_f32_16x16x32_bf16 v[12:15], v[60:63], v[156:159], v[12:15]
    ds_read_b64_tr_b16 v[44:45], v234 offset:0
    v_mfma_f32_16x16x32_bf16 v[28:31], v[60:63], v[160:163], v[28:31]
    ds_read_b64_tr_b16 v[46:47], v234 offset:1024
    v_mfma_f32_16x16x32_bf16 v[16:19], v[64:67], v[156:159], v[16:19]
    ds_read_b64_tr_b16 v[48:49], v235 offset:0
    v_mfma_f32_16x16x32_bf16 v[32:35], v[64:67], v[160:163], v[32:35]
    ds_read_b64_tr_b16 v[50:51], v235 offset:1024
    s_cmp_lg_u32 s72, 0
    s_cbranch_scc1 recurrent_scan__softmax_full_mha__moe_arch_mod__prompt_kernel_og_65
    s_call_b64 s[44:45], recurrent_scan__softmax_full_mha__moe_arch_mod__prompt_kernel_ospin
recurrent_scan__softmax_full_mha__moe_arch_mod__prompt_kernel_og_65:
    s_ff1_i32_b32 s53, s72
    s_bitset0_b32 s73, s53
    s_bitset0_b32 s72, s53
    s_lshr_b32 s53, s53, 2
    s_add_u32 s53, s53, s60
    s_and_b32 s59, s53, 3
    s_lshl_b32 s53, s59, 12
    s_add_u32 s54, s53, s51
    s_add_u32 s53, s53, s50
    buffer_load_dwordx4 v[100:103], v1, s[12:15], s53 offen offset:0
    buffer_load_dwordx4 v[104:107], v1, s[12:15], s54 offen offset:0
    buffer_load_dwordx4 v[108:111], v1, s[12:15], s53 offen offset:1024
    buffer_load_dwordx4 v[112:115], v1, s[12:15], s54 offen offset:1024
    buffer_load_dwordx4 v[116:119], v1, s[12:15], s53 offen offset:2048
    buffer_load_dwordx4 v[120:123], v1, s[12:15], s54 offen offset:2048
    buffer_load_dwordx4 v[124:127], v1, s[12:15], s53 offen offset:3072
    buffer_load_dwordx4 v[128:131], v1, s[12:15], s54 offen offset:3072
    s_waitcnt vmcnt(22)
    s_waitcnt lgkmcnt(0)
    v_mfma_f32_16x16x32_bf16 v[4:7], v[36:39], v[164:167], v[4:7]
    ds_read_b64_tr_b16 v[52:53], v232 offset:4096
    v_mfma_f32_16x16x32_bf16 v[20:23], v[36:39], v[168:171], v[20:23]
    ds_read_b64_tr_b16 v[54:55], v232 offset:5120
    v_mfma_f32_16x16x32_bf16 v[8:11], v[40:43], v[164:167], v[8:11]
    ds_read_b64_tr_b16 v[56:57], v233 offset:4096
    v_mfma_f32_16x16x32_bf16 v[24:27], v[40:43], v[168:171], v[24:27]
    ds_read_b64_tr_b16 v[58:59], v233 offset:5120
    v_mfma_f32_16x16x32_bf16 v[12:15], v[44:47], v[164:167], v[12:15]
    ds_read_b64_tr_b16 v[60:61], v234 offset:4096
    v_mfma_f32_16x16x32_bf16 v[28:31], v[44:47], v[168:171], v[28:31]
    ds_read_b64_tr_b16 v[62:63], v234 offset:5120
    v_mfma_f32_16x16x32_bf16 v[16:19], v[48:51], v[164:167], v[16:19]
    ds_read_b64_tr_b16 v[64:65], v235 offset:4096
    v_mfma_f32_16x16x32_bf16 v[32:35], v[48:51], v[168:171], v[32:35]
    ds_read_b64_tr_b16 v[66:67], v235 offset:5120
    s_waitcnt vmcnt(20)
    s_waitcnt lgkmcnt(0)
    v_mfma_f32_16x16x32_bf16 v[4:7], v[52:55], v[172:175], v[4:7]
    ds_read_b64_tr_b16 v[36:37], v232 offset:8192
    v_mfma_f32_16x16x32_bf16 v[20:23], v[52:55], v[176:179], v[20:23]
    ds_read_b64_tr_b16 v[38:39], v232 offset:9216
    v_mfma_f32_16x16x32_bf16 v[8:11], v[56:59], v[172:175], v[8:11]
    ds_read_b64_tr_b16 v[40:41], v233 offset:8192
    v_mfma_f32_16x16x32_bf16 v[24:27], v[56:59], v[176:179], v[24:27]
    ds_read_b64_tr_b16 v[42:43], v233 offset:9216
    v_mfma_f32_16x16x32_bf16 v[12:15], v[60:63], v[172:175], v[12:15]
    ds_read_b64_tr_b16 v[44:45], v234 offset:8192
    v_mfma_f32_16x16x32_bf16 v[28:31], v[60:63], v[176:179], v[28:31]
    ds_read_b64_tr_b16 v[46:47], v234 offset:9216
    v_mfma_f32_16x16x32_bf16 v[16:19], v[64:67], v[172:175], v[16:19]
    ds_read_b64_tr_b16 v[48:49], v235 offset:8192
    v_mfma_f32_16x16x32_bf16 v[32:35], v[64:67], v[176:179], v[32:35]
    ds_read_b64_tr_b16 v[50:51], v235 offset:9216
    s_waitcnt vmcnt(18)
    s_waitcnt lgkmcnt(0)
    v_mfma_f32_16x16x32_bf16 v[4:7], v[36:39], v[180:183], v[4:7]
    ds_read_b64_tr_b16 v[52:53], v232 offset:12288
    v_mfma_f32_16x16x32_bf16 v[20:23], v[36:39], v[184:187], v[20:23]
    ds_read_b64_tr_b16 v[54:55], v232 offset:13312
    v_mfma_f32_16x16x32_bf16 v[8:11], v[40:43], v[180:183], v[8:11]
    ds_read_b64_tr_b16 v[56:57], v233 offset:12288
    v_mfma_f32_16x16x32_bf16 v[24:27], v[40:43], v[184:187], v[24:27]
    ds_read_b64_tr_b16 v[58:59], v233 offset:13312
    v_mfma_f32_16x16x32_bf16 v[12:15], v[44:47], v[180:183], v[12:15]
    ds_read_b64_tr_b16 v[60:61], v234 offset:12288
    v_mfma_f32_16x16x32_bf16 v[28:31], v[44:47], v[184:187], v[28:31]
    ds_read_b64_tr_b16 v[62:63], v234 offset:13312
    v_mfma_f32_16x16x32_bf16 v[16:19], v[48:51], v[180:183], v[16:19]
    ds_read_b64_tr_b16 v[64:65], v235 offset:12288
    v_mfma_f32_16x16x32_bf16 v[32:35], v[48:51], v[184:187], v[32:35]
    ds_read_b64_tr_b16 v[66:67], v235 offset:13312
    s_lshl_b32 s64, s57, 14
    v_add_u32 v232, s64, v228
    v_add_u32 v233, s64, v229
    v_add_u32 v234, s64, v230
    v_add_u32 v235, s64, v231
    s_waitcnt vmcnt(16)
    s_waitcnt lgkmcnt(0)
    v_mfma_f32_16x16x32_bf16 v[4:7], v[52:55], v[188:191], v[4:7]
    ds_read_b64_tr_b16 v[36:37], v232 offset:0
    v_mfma_f32_16x16x32_bf16 v[20:23], v[52:55], v[192:195], v[20:23]
    ds_read_b64_tr_b16 v[38:39], v232 offset:1024
    v_mfma_f32_16x16x32_bf16 v[8:11], v[56:59], v[188:191], v[8:11]
    ds_read_b64_tr_b16 v[40:41], v233 offset:0
    v_mfma_f32_16x16x32_bf16 v[24:27], v[56:59], v[192:195], v[24:27]
    ds_read_b64_tr_b16 v[42:43], v233 offset:1024
    v_mfma_f32_16x16x32_bf16 v[12:15], v[60:63], v[188:191], v[12:15]
    ds_read_b64_tr_b16 v[44:45], v234 offset:0
    v_mfma_f32_16x16x32_bf16 v[28:31], v[60:63], v[192:195], v[28:31]
    ds_read_b64_tr_b16 v[46:47], v234 offset:1024
    v_mfma_f32_16x16x32_bf16 v[16:19], v[64:67], v[188:191], v[16:19]
    ds_read_b64_tr_b16 v[48:49], v235 offset:0
    v_mfma_f32_16x16x32_bf16 v[32:35], v[64:67], v[192:195], v[32:35]
    ds_read_b64_tr_b16 v[50:51], v235 offset:1024
    s_waitcnt vmcnt(14)
    s_waitcnt lgkmcnt(0)
    v_mfma_f32_16x16x32_bf16 v[4:7], v[36:39], v[68:71], v[4:7]
    ds_read_b64_tr_b16 v[52:53], v232 offset:4096
    v_mfma_f32_16x16x32_bf16 v[20:23], v[36:39], v[72:75], v[20:23]
    ds_read_b64_tr_b16 v[54:55], v232 offset:5120
    v_mfma_f32_16x16x32_bf16 v[8:11], v[40:43], v[68:71], v[8:11]
    ds_read_b64_tr_b16 v[56:57], v233 offset:4096
    v_mfma_f32_16x16x32_bf16 v[24:27], v[40:43], v[72:75], v[24:27]
    ds_read_b64_tr_b16 v[58:59], v233 offset:5120
    v_mfma_f32_16x16x32_bf16 v[12:15], v[44:47], v[68:71], v[12:15]
    ds_read_b64_tr_b16 v[60:61], v234 offset:4096
    v_mfma_f32_16x16x32_bf16 v[28:31], v[44:47], v[72:75], v[28:31]
    ds_read_b64_tr_b16 v[62:63], v234 offset:5120
    v_mfma_f32_16x16x32_bf16 v[16:19], v[48:51], v[68:71], v[16:19]
    ds_read_b64_tr_b16 v[64:65], v235 offset:4096
    v_mfma_f32_16x16x32_bf16 v[32:35], v[48:51], v[72:75], v[32:35]
    ds_read_b64_tr_b16 v[66:67], v235 offset:5120
    s_waitcnt vmcnt(12)
    s_waitcnt lgkmcnt(0)
    v_mfma_f32_16x16x32_bf16 v[4:7], v[52:55], v[76:79], v[4:7]
    ds_read_b64_tr_b16 v[36:37], v232 offset:8192
    v_mfma_f32_16x16x32_bf16 v[20:23], v[52:55], v[80:83], v[20:23]
    ds_read_b64_tr_b16 v[38:39], v232 offset:9216
    v_mfma_f32_16x16x32_bf16 v[8:11], v[56:59], v[76:79], v[8:11]
    ds_read_b64_tr_b16 v[40:41], v233 offset:8192
    v_mfma_f32_16x16x32_bf16 v[24:27], v[56:59], v[80:83], v[24:27]
    ds_read_b64_tr_b16 v[42:43], v233 offset:9216
    v_mfma_f32_16x16x32_bf16 v[12:15], v[60:63], v[76:79], v[12:15]
    ds_read_b64_tr_b16 v[44:45], v234 offset:8192
    v_mfma_f32_16x16x32_bf16 v[28:31], v[60:63], v[80:83], v[28:31]
    ds_read_b64_tr_b16 v[46:47], v234 offset:9216
    v_mfma_f32_16x16x32_bf16 v[16:19], v[64:67], v[76:79], v[16:19]
    ds_read_b64_tr_b16 v[48:49], v235 offset:8192
    v_mfma_f32_16x16x32_bf16 v[32:35], v[64:67], v[80:83], v[32:35]
    ds_read_b64_tr_b16 v[50:51], v235 offset:9216
    s_waitcnt vmcnt(10)
    s_waitcnt lgkmcnt(0)
    v_mfma_f32_16x16x32_bf16 v[4:7], v[36:39], v[84:87], v[4:7]
    ds_read_b64_tr_b16 v[52:53], v232 offset:12288
    v_mfma_f32_16x16x32_bf16 v[20:23], v[36:39], v[88:91], v[20:23]
    ds_read_b64_tr_b16 v[54:55], v232 offset:13312
    v_mfma_f32_16x16x32_bf16 v[8:11], v[40:43], v[84:87], v[8:11]
    ds_read_b64_tr_b16 v[56:57], v233 offset:12288
    v_mfma_f32_16x16x32_bf16 v[24:27], v[40:43], v[88:91], v[24:27]
    ds_read_b64_tr_b16 v[58:59], v233 offset:13312
    v_mfma_f32_16x16x32_bf16 v[12:15], v[44:47], v[84:87], v[12:15]
    ds_read_b64_tr_b16 v[60:61], v234 offset:12288
    v_mfma_f32_16x16x32_bf16 v[28:31], v[44:47], v[88:91], v[28:31]
    ds_read_b64_tr_b16 v[62:63], v234 offset:13312
    v_mfma_f32_16x16x32_bf16 v[16:19], v[48:51], v[84:87], v[16:19]
    ds_read_b64_tr_b16 v[64:65], v235 offset:12288
    v_mfma_f32_16x16x32_bf16 v[32:35], v[48:51], v[88:91], v[32:35]
    ds_read_b64_tr_b16 v[66:67], v235 offset:13312
    s_lshl_b32 s64, s59, 14
    v_add_u32 v232, s64, v228
    v_add_u32 v233, s64, v229
    v_add_u32 v234, s64, v230
    v_add_u32 v235, s64, v231
    s_waitcnt vmcnt(8)
    s_waitcnt lgkmcnt(0)
    v_mfma_f32_16x16x32_bf16 v[4:7], v[52:55], v[92:95], v[4:7]
    ds_read_b64_tr_b16 v[36:37], v232 offset:0
    v_mfma_f32_16x16x32_bf16 v[20:23], v[52:55], v[96:99], v[20:23]
    ds_read_b64_tr_b16 v[38:39], v232 offset:1024
    v_mfma_f32_16x16x32_bf16 v[8:11], v[56:59], v[92:95], v[8:11]
    ds_read_b64_tr_b16 v[40:41], v233 offset:0
    v_mfma_f32_16x16x32_bf16 v[24:27], v[56:59], v[96:99], v[24:27]
    ds_read_b64_tr_b16 v[42:43], v233 offset:1024
    v_mfma_f32_16x16x32_bf16 v[12:15], v[60:63], v[92:95], v[12:15]
    ds_read_b64_tr_b16 v[44:45], v234 offset:0
    v_mfma_f32_16x16x32_bf16 v[28:31], v[60:63], v[96:99], v[28:31]
    ds_read_b64_tr_b16 v[46:47], v234 offset:1024
    v_mfma_f32_16x16x32_bf16 v[16:19], v[64:67], v[92:95], v[16:19]
    ds_read_b64_tr_b16 v[48:49], v235 offset:0
    v_mfma_f32_16x16x32_bf16 v[32:35], v[64:67], v[96:99], v[32:35]
    ds_read_b64_tr_b16 v[50:51], v235 offset:1024
    s_waitcnt vmcnt(6)
    s_waitcnt lgkmcnt(0)
    v_mfma_f32_16x16x32_bf16 v[4:7], v[36:39], v[100:103], v[4:7]
    ds_read_b64_tr_b16 v[52:53], v232 offset:4096
    v_mfma_f32_16x16x32_bf16 v[20:23], v[36:39], v[104:107], v[20:23]
    ds_read_b64_tr_b16 v[54:55], v232 offset:5120
    v_mfma_f32_16x16x32_bf16 v[8:11], v[40:43], v[100:103], v[8:11]
    ds_read_b64_tr_b16 v[56:57], v233 offset:4096
    v_mfma_f32_16x16x32_bf16 v[24:27], v[40:43], v[104:107], v[24:27]
    ds_read_b64_tr_b16 v[58:59], v233 offset:5120
    v_mfma_f32_16x16x32_bf16 v[12:15], v[44:47], v[100:103], v[12:15]
    ds_read_b64_tr_b16 v[60:61], v234 offset:4096
    v_mfma_f32_16x16x32_bf16 v[28:31], v[44:47], v[104:107], v[28:31]
    ds_read_b64_tr_b16 v[62:63], v234 offset:5120
    v_mfma_f32_16x16x32_bf16 v[16:19], v[48:51], v[100:103], v[16:19]
    ds_read_b64_tr_b16 v[64:65], v235 offset:4096
    v_mfma_f32_16x16x32_bf16 v[32:35], v[48:51], v[104:107], v[32:35]
    ds_read_b64_tr_b16 v[66:67], v235 offset:5120
    s_waitcnt vmcnt(4)
    s_waitcnt lgkmcnt(0)
    v_mfma_f32_16x16x32_bf16 v[4:7], v[52:55], v[108:111], v[4:7]
    ds_read_b64_tr_b16 v[36:37], v232 offset:8192
    v_mfma_f32_16x16x32_bf16 v[20:23], v[52:55], v[112:115], v[20:23]
    ds_read_b64_tr_b16 v[38:39], v232 offset:9216
    v_mfma_f32_16x16x32_bf16 v[8:11], v[56:59], v[108:111], v[8:11]
    ds_read_b64_tr_b16 v[40:41], v233 offset:8192
    v_mfma_f32_16x16x32_bf16 v[24:27], v[56:59], v[112:115], v[24:27]
    ds_read_b64_tr_b16 v[42:43], v233 offset:9216
    v_mfma_f32_16x16x32_bf16 v[12:15], v[60:63], v[108:111], v[12:15]
    ds_read_b64_tr_b16 v[44:45], v234 offset:8192
    v_mfma_f32_16x16x32_bf16 v[28:31], v[60:63], v[112:115], v[28:31]
    ds_read_b64_tr_b16 v[46:47], v234 offset:9216
    v_mfma_f32_16x16x32_bf16 v[16:19], v[64:67], v[108:111], v[16:19]
    ds_read_b64_tr_b16 v[48:49], v235 offset:8192
    v_mfma_f32_16x16x32_bf16 v[32:35], v[64:67], v[112:115], v[32:35]
    ds_read_b64_tr_b16 v[50:51], v235 offset:9216
    s_waitcnt vmcnt(2)
    s_waitcnt lgkmcnt(0)
    v_mfma_f32_16x16x32_bf16 v[4:7], v[36:39], v[116:119], v[4:7]
    ds_read_b64_tr_b16 v[52:53], v232 offset:12288
    v_mfma_f32_16x16x32_bf16 v[20:23], v[36:39], v[120:123], v[20:23]
    ds_read_b64_tr_b16 v[54:55], v232 offset:13312
    v_mfma_f32_16x16x32_bf16 v[8:11], v[40:43], v[116:119], v[8:11]
    ds_read_b64_tr_b16 v[56:57], v233 offset:12288
    v_mfma_f32_16x16x32_bf16 v[24:27], v[40:43], v[120:123], v[24:27]
    ds_read_b64_tr_b16 v[58:59], v233 offset:13312
    v_mfma_f32_16x16x32_bf16 v[12:15], v[44:47], v[116:119], v[12:15]
    ds_read_b64_tr_b16 v[60:61], v234 offset:12288
    v_mfma_f32_16x16x32_bf16 v[28:31], v[44:47], v[120:123], v[28:31]
    ds_read_b64_tr_b16 v[62:63], v234 offset:13312
    v_mfma_f32_16x16x32_bf16 v[16:19], v[48:51], v[116:119], v[16:19]
    ds_read_b64_tr_b16 v[64:65], v235 offset:12288
    v_mfma_f32_16x16x32_bf16 v[32:35], v[48:51], v[120:123], v[32:35]
    ds_read_b64_tr_b16 v[66:67], v235 offset:13312
    s_waitcnt vmcnt(0)
    s_waitcnt lgkmcnt(0)
    v_mfma_f32_16x16x32_bf16 v[4:7], v[52:55], v[124:127], v[4:7]
    v_mfma_f32_16x16x32_bf16 v[20:23], v[52:55], v[128:131], v[20:23]
    v_mfma_f32_16x16x32_bf16 v[8:11], v[56:59], v[124:127], v[8:11]
    v_mfma_f32_16x16x32_bf16 v[24:27], v[56:59], v[128:131], v[24:27]
    v_mfma_f32_16x16x32_bf16 v[12:15], v[60:63], v[124:127], v[12:15]
    v_mfma_f32_16x16x32_bf16 v[28:31], v[60:63], v[128:131], v[28:31]
    v_mfma_f32_16x16x32_bf16 v[16:19], v[64:67], v[124:127], v[16:19]
    v_mfma_f32_16x16x32_bf16 v[32:35], v[64:67], v[128:131], v[32:35]
    s_lshl_b32 s64, s3, 12
    s_add_u32 s64, s64, 131072
    s_xor_b32 s65, s64, 16384
    v_add_u32 v240, s64, v1
    v_add_u32 v241, s65, v1
    s_cmp_eq_u32 s48, 0
    s_nop 3
    s_cbranch_scc1 recurrent_scan__softmax_full_mha__moe_arch_mod__prompt_kernel_ck0
    ds_write_b128 v240, v[4:7] offset:0
    ds_write_b128 v240, v[8:11] offset:1024
    ds_write_b128 v240, v[20:23] offset:2048
    ds_write_b128 v240, v[24:27] offset:3072
    s_waitcnt lgkmcnt(0)
    v_mov_b32 v4, v12
    v_mov_b32 v5, v13
    v_mov_b32 v6, v14
    v_mov_b32 v7, v15
    v_mov_b32 v8, v16
    v_mov_b32 v9, v17
    v_mov_b32 v10, v18
    v_mov_b32 v11, v19
    v_mov_b32 v20, v28
    v_mov_b32 v21, v29
    v_mov_b32 v22, v30
    v_mov_b32 v23, v31
    v_mov_b32 v24, v32
    v_mov_b32 v25, v33
    v_mov_b32 v26, v34
    v_mov_b32 v27, v35
    s_branch recurrent_scan__softmax_full_mha__moe_arch_mod__prompt_kernel_ckj
recurrent_scan__softmax_full_mha__moe_arch_mod__prompt_kernel_ck0:
    ds_write_b128 v240, v[12:15] offset:0
    ds_write_b128 v240, v[16:19] offset:1024
    ds_write_b128 v240, v[28:31] offset:2048
    ds_write_b128 v240, v[32:35] offset:3072
recurrent_scan__softmax_full_mha__moe_arch_mod__prompt_kernel_ckj:
    v_lshlrev_b32 v68, 16, v196
    v_and_b32 v69, 0xffff0000, v196
    v_lshlrev_b32 v70, 16, v197
    v_and_b32 v71, 0xffff0000, v197
    v_lshlrev_b32 v72, 16, v198
    v_and_b32 v73, 0xffff0000, v198
    v_lshlrev_b32 v74, 16, v199
    v_and_b32 v75, 0xffff0000, v199
    v_lshlrev_b32 v76, 16, v200
    v_and_b32 v77, 0xffff0000, v200
    v_lshlrev_b32 v78, 16, v201
    v_and_b32 v79, 0xffff0000, v201
    v_lshlrev_b32 v80, 16, v202
    v_and_b32 v81, 0xffff0000, v202
    v_lshlrev_b32 v82, 16, v203
    v_and_b32 v83, 0xffff0000, v203
    s_waitcnt lgkmcnt(0)
    s_barrier
    ds_read_b128 v[12:15], v241 offset:0
    ds_read_b128 v[16:19], v241 offset:1024
    ds_read_b128 v[28:31], v241 offset:2048
    ds_read_b128 v[32:35], v241 offset:3072
    s_mov_b32 s64, 32768
    s_waitcnt lgkmcnt(2)
    v_add_f32 v4, v4, v12
    v_add_f32 v5, v5, v13
    v_add_f32 v6, v6, v14
    v_add_f32 v7, v7, v15
    v_add_f32 v8, v8, v16
    v_add_f32 v9, v9, v17
    v_add_f32 v10, v10, v18
    v_add_f32 v11, v11, v19
    v_permlane16_swap_b32 v4, v8
    v_permlane16_swap_b32 v5, v9
    v_permlane16_swap_b32 v6, v10
    v_permlane16_swap_b32 v7, v11
    v_fmac_f32 v68, v4, v212
    v_fmac_f32 v69, v5, v213
    v_fmac_f32 v70, v6, v214
    v_fmac_f32 v71, v7, v215
    v_fmac_f32 v72, v8, v216
    v_fmac_f32 v73, v9, v217
    v_fmac_f32 v74, v10, v218
    v_fmac_f32 v75, v11, v219
    v_cvt_pk_bf16_f32 v196, v68, v69
    v_cvt_pk_bf16_f32 v197, v70, v71
    v_cvt_pk_bf16_f32 v198, v72, v73
    v_cvt_pk_bf16_f32 v199, v74, v75
    buffer_store_dwordx4 v[196:199], v204, s[40:43], 0 offen nt
    s_waitcnt lgkmcnt(0)
    v_add_f32 v20, v20, v28
    v_add_f32 v21, v21, v29
    v_add_f32 v22, v22, v30
    v_add_f32 v23, v23, v31
    v_add_f32 v24, v24, v32
    v_add_f32 v25, v25, v33
    v_add_f32 v26, v26, v34
    v_add_f32 v27, v27, v35
    v_permlane16_swap_b32 v20, v24
    v_permlane16_swap_b32 v21, v25
    v_permlane16_swap_b32 v22, v26
    v_permlane16_swap_b32 v23, v27
    v_fmac_f32 v76, v20, v220
    v_fmac_f32 v77, v21, v221
    v_fmac_f32 v78, v22, v222
    v_fmac_f32 v79, v23, v223
    v_fmac_f32 v80, v24, v224
    v_fmac_f32 v81, v25, v225
    v_fmac_f32 v82, v26, v226
    v_fmac_f32 v83, v27, v227
    v_cvt_pk_bf16_f32 v200, v76, v77
    v_cvt_pk_bf16_f32 v201, v78, v79
    v_cvt_pk_bf16_f32 v202, v80, v81
    v_cvt_pk_bf16_f32 v203, v82, v83
    buffer_store_dwordx4 v[200:203], v204, s[40:43], s64 offen nt
recurrent_scan__softmax_full_mha__moe_arch_mod__prompt_kernel_done:
    s_endpgm
recurrent_scan__softmax_full_mha__moe_arch_mod__prompt_kernel_colsum:
    ds_read_b64_tr_b16 v[68:69], v10 offset:0
    ds_read_b64_tr_b16 v[70:71], v10 offset:512
    ds_read_b64_tr_b16 v[72:73], v10 offset:4096
    ds_read_b64_tr_b16 v[74:75], v10 offset:4608
    ds_read_b64_tr_b16 v[76:77], v11 offset:0
    ds_read_b64_tr_b16 v[78:79], v11 offset:512
    ds_read_b64_tr_b16 v[80:81], v11 offset:4096
    ds_read_b64_tr_b16 v[82:83], v11 offset:4608
    ds_read_b64_tr_b16 v[84:85], v12 offset:0
    ds_read_b64_tr_b16 v[86:87], v12 offset:512
    ds_read_b64_tr_b16 v[88:89], v12 offset:4096
    ds_read_b64_tr_b16 v[90:91], v12 offset:4608
    s_lshl_b32 s64, s44, 4
    s_add_u32 s64, s64, s45
    s_lshl_b32 s64, s64, 2
    s_add_u32 s64, s64, s48
    s_mul_i32 s64, s64, 192
    s_add_u32 s64, s64, 21561344
    v_lshlrev_b32 v47, 2, v0
    s_waitcnt lgkmcnt(0)
    v_mfma_f32_16x16x32_bf16 v[28:31], v[56:59], v[68:71], 0
    v_mfma_f32_16x16x32_bf16 v[32:35], v[56:59], v[76:79], 0
    v_mfma_f32_16x16x32_bf16 v[36:39], v[56:59], v[84:87], 0
    v_mfma_f32_16x16x32_bf16 v[28:31], v[56:59], v[72:75], v[28:31]
    v_mfma_f32_16x16x32_bf16 v[32:35], v[56:59], v[80:83], v[32:35]
    v_mfma_f32_16x16x32_bf16 v[36:39], v[56:59], v[88:91], v[36:39]
    s_nop 7
    s_mov_b64 exec, 0xffff0000
    v_mov_b32 v28, v32
    s_bfm_b64 exec, 16, 32
    v_mov_b32 v28, v36
    s_bfm_b64 exec, 48, 0
    buffer_store_dword v28, v47, s[12:15], s64 offen sc1
    s_mov_b64 exec, -1
    s_setpc_b64 s[70:71]
recurrent_scan__softmax_full_mha__moe_arch_mod__prompt_kernel_p1_5_spin:
    s_mov_b32 s75, 0
recurrent_scan__softmax_full_mha__moe_arch_mod__prompt_kernel_p1_5_again:
    buffer_load_dword v46, v45, s[20:23], 0 offen sc1
    s_add_u32 s75, s75, 1
    s_cmp_gt_u32 s75, 400000
    s_cbranch_scc1 recurrent_scan__softmax_full_mha__moe_arch_mod__prompt_kernel_p1_5_ok
    s_waitcnt vmcnt(0)
    v_cmp_gt_u32 vcc, 16, v46
    s_cmp_lg_u64 vcc, 0
    s_cbranch_scc1 recurrent_scan__softmax_full_mha__moe_arch_mod__prompt_kernel_p1_5_again
    s_branch recurrent_scan__softmax_full_mha__moe_arch_mod__prompt_kernel_p1_5_ok
recurrent_scan__softmax_full_mha__moe_arch_mod__prompt_kernel_p2_7_spin:
    s_mov_b32 s75, 0
recurrent_scan__softmax_full_mha__moe_arch_mod__prompt_kernel_p2_7_again:
    v_mov_b32 v53, 0
    s_mov_b64 exec, 1
    buffer_atomic_or v53, v52, s[12:15], 0 offen sc0 sc1
    s_mov_b64 exec, -1
    s_add_u32 s75, s75, 1
    s_cmp_gt_u32 s75, 400000
    s_cbranch_scc1 recurrent_scan__softmax_full_mha__moe_arch_mod__prompt_kernel_p2_7_ok
    s_waitcnt vmcnt(0)
    v_cmp_gt_u32 vcc, 16, v53
    s_and_b32 vcc_lo, vcc_lo, 1
    s_cbranch_scc1 recurrent_scan__softmax_full_mha__moe_arch_mod__prompt_kernel_p2_7_again
    s_branch recurrent_scan__softmax_full_mha__moe_arch_mod__prompt_kernel_p2_7_ok
recurrent_scan__softmax_full_mha__moe_arch_mod__prompt_kernel_kvspin:
    s_mov_b32 s75, 0
recurrent_scan__softmax_full_mha__moe_arch_mod__prompt_kernel_kvagain:
    v_mov_b32 v246, 0
    s_mov_b64 exec, 1
    buffer_atomic_or v246, v247, s[12:15], 0 offen sc0 sc1
    s_mov_b64 exec, -1
    s_add_u32 s75, s75, 1
    s_cmp_gt_u32 s75, 400000
    s_cselect_b32 s54, s55, s54
    s_cbranch_scc1 recurrent_scan__softmax_full_mha__moe_arch_mod__prompt_kernel_kvout
    s_waitcnt vmcnt(0)
    v_readfirstlane_b32 s54, v246
    s_nop 0
    s_mul_i32 s54, s54, 0x10001
    s_lshr_b32 s54, s54, s45
    s_and_b32 s54, s54, s55
    s_cbranch_scc0 recurrent_scan__softmax_full_mha__moe_arch_mod__prompt_kernel_kvagain
recurrent_scan__softmax_full_mha__moe_arch_mod__prompt_kernel_kvout:
    s_setpc_b64 s[56:57]
recurrent_scan__softmax_full_mha__moe_arch_mod__prompt_kernel_hp_39_spin:
    s_mov_b32 s75, 0
recurrent_scan__softmax_full_mha__moe_arch_mod__prompt_kernel_hp_39_again:
    v_mov_b32 v253, 0
    s_mov_b64 exec, 15
    buffer_atomic_or v253, v252, s[12:15], 0 offen sc0 sc1
    s_mov_b64 exec, -1
    s_add_u32 s75, s75, 1
    s_cmp_gt_u32 s75, 400000
    s_cbranch_scc1 recurrent_scan__softmax_full_mha__moe_arch_mod__prompt_kernel_hp_39_ok
    s_waitcnt vmcnt(0)
    v_cmp_gt_u32 vcc, 32, v253
    s_and_b32 vcc_lo, vcc_lo, 15
    s_cbranch_scc1 recurrent_scan__softmax_full_mha__moe_arch_mod__prompt_kernel_hp_39_again
    s_branch recurrent_scan__softmax_full_mha__moe_arch_mod__prompt_kernel_hp_39_ok
recurrent_scan__softmax_full_mha__moe_arch_mod__prompt_kernel_rdet:
    v_lshrrev_b32 v248, 11, v204
    v_add_u32 v248, 0, v248
    v_mov_b32 v240, 0x7fff0000
    v_mov_b32 v238, 0
    v_and_b32 v249, 0x7ff, v204
    v_lshlrev_b32 v249, 1, v249
    v_add_u32 v249, 21233664, v249
    v_readlane_b32 s72, v210, 8
    v_cmp_eq_u32 vcc, s64, v248
    v_add_u32 v252, 0, v249
    v_mov_b32 v253, s72
    v_cndmask_b32 v240, v240, v252, vcc
    v_cndmask_b32 v238, v238, v253, vcc
    v_readlane_b32 s72, v210, 9
    v_cmp_eq_u32 vcc, s65, v248
    v_add_u32 v252, 4096, v249
    v_mov_b32 v253, s72
    v_cndmask_b32 v240, v240, v252, vcc
    v_cndmask_b32 v238, v238, v253, vcc
    v_readlane_b32 s72, v210, 10
    v_cmp_eq_u32 vcc, s66, v248
    v_add_u32 v252, 8192, v249
    v_mov_b32 v253, s72
    v_cndmask_b32 v240, v240, v252, vcc
    v_cndmask_b32 v238, v238, v253, vcc
    v_readlane_b32 s72, v210, 11
    v_cmp_eq_u32 vcc, s67, v248
    v_add_u32 v252, 12288, v249
    v_mov_b32 v253, s72
    v_cndmask_b32 v240, v240, v252, vcc
    v_cndmask_b32 v238, v238, v253, vcc
    v_readlane_b32 s72, v210, 12
    v_cmp_eq_u32 vcc, s68, v248
    v_add_u32 v252, 16384, v249
    v_mov_b32 v253, s72
    v_cndmask_b32 v240, v240, v252, vcc
    v_cndmask_b32 v238, v238, v253, vcc
    v_readlane_b32 s72, v210, 13
    v_cmp_eq_u32 vcc, s69, v248
    v_add_u32 v252, 20480, v249
    v_mov_b32 v253, s72
    v_cndmask_b32 v240, v240, v252, vcc
    v_cndmask_b32 v238, v238, v253, vcc
    v_readlane_b32 s72, v210, 14
    v_cmp_eq_u32 vcc, s70, v248
    v_add_u32 v252, 24576, v249
    v_mov_b32 v253, s72
    v_cndmask_b32 v240, v240, v252, vcc
    v_cndmask_b32 v238, v238, v253, vcc
    v_readlane_b32 s72, v210, 15
    v_cmp_eq_u32 vcc, s71, v248
    v_add_u32 v252, 28672, v249
    v_mov_b32 v253, s72
    v_cndmask_b32 v240, v240, v252, vcc
    v_cndmask_b32 v238, v238, v253, vcc
    v_lshrrev_b32 v248, 11, v204
    v_add_u32 v248, 16, v248
    v_mov_b32 v241, 0x7fff0000
    v_mov_b32 v239, 0
    v_and_b32 v249, 0x7ff, v204
    v_lshlrev_b32 v249, 1, v249
    v_add_u32 v249, 21233664, v249
    v_readlane_b32 s72, v210, 8
    v_cmp_eq_u32 vcc, s64, v248
    v_add_u32 v252, 0, v249
    v_mov_b32 v253, s72
    v_cndmask_b32 v241, v241, v252, vcc
    v_cndmask_b32 v239, v239, v253, vcc
    v_readlane_b32 s72, v210, 9
    v_cmp_eq_u32 vcc, s65, v248
    v_add_u32 v252, 4096, v249
    v_mov_b32 v253, s72
    v_cndmask_b32 v241, v241, v252, vcc
    v_cndmask_b32 v239, v239, v253, vcc
    v_readlane_b32 s72, v210, 10
    v_cmp_eq_u32 vcc, s66, v248
    v_add_u32 v252, 8192, v249
    v_mov_b32 v253, s72
    v_cndmask_b32 v241, v241, v252, vcc
    v_cndmask_b32 v239, v239, v253, vcc
    v_readlane_b32 s72, v210, 11
    v_cmp_eq_u32 vcc, s67, v248
    v_add_u32 v252, 12288, v249
    v_mov_b32 v253, s72
    v_cndmask_b32 v241, v241, v252, vcc
    v_cndmask_b32 v239, v239, v253, vcc
    v_readlane_b32 s72, v210, 12
    v_cmp_eq_u32 vcc, s68, v248
    v_add_u32 v252, 16384, v249
    v_mov_b32 v253, s72
    v_cndmask_b32 v241, v241, v252, vcc
    v_cndmask_b32 v239, v239, v253, vcc
    v_readlane_b32 s72, v210, 13
    v_cmp_eq_u32 vcc, s69, v248
    v_add_u32 v252, 20480, v249
    v_mov_b32 v253, s72
    v_cndmask_b32 v241, v241, v252, vcc
    v_cndmask_b32 v239, v239, v253, vcc
    v_readlane_b32 s72, v210, 14
    v_cmp_eq_u32 vcc, s70, v248
    v_add_u32 v252, 24576, v249
    v_mov_b32 v253, s72
    v_cndmask_b32 v241, v241, v252, vcc
    v_cndmask_b32 v239, v239, v253, vcc
    v_readlane_b32 s72, v210, 15
    v_cmp_eq_u32 vcc, s71, v248
    v_add_u32 v252, 28672, v249
    v_mov_b32 v253, s72
    v_cndmask_b32 v241, v241, v252, vcc
    v_cndmask_b32 v239, v239, v253, vcc
    s_lshl_b32 s72, s44, 7
    s_add_u32 s72, s72, 21479424
    v_mov_b32 v252, s72
    v_mov_b32 v253, 0
    s_mov_b64 exec, 1
    buffer_atomic_or v253, v252, s[12:15], 0 offen sc0 sc1
    s_mov_b64 exec, -1
    s_branch recurrent_scan__softmax_full_mha__moe_arch_mod__prompt_kernel_rdet_done
recurrent_scan__softmax_full_mha__moe_arch_mod__prompt_kernel_yp_1_spin:
    s_mov_b32 s75, 0
recurrent_scan__softmax_full_mha__moe_arch_mod__prompt_kernel_yp_1_again:
    v_mov_b32 v253, 0
    s_mov_b64 exec, 1
    buffer_atomic_or v253, v252, s[12:15], 0 offen sc0 sc1
    s_mov_b64 exec, -1
    s_add_u32 s75, s75, 1
    s_cmp_gt_u32 s75, 400000
    s_cbranch_scc1 recurrent_scan__softmax_full_mha__moe_arch_mod__prompt_kernel_yp_1_ok
    s_waitcnt vmcnt(0)
    v_cmp_gt_u32 vcc, 128, v253
    s_and_b32 vcc_lo, vcc_lo, 1
    s_cbranch_scc1 recurrent_scan__softmax_full_mha__moe_arch_mod__prompt_kernel_yp_1_again
    s_branch recurrent_scan__softmax_full_mha__moe_arch_mod__prompt_kernel_yp_1_ok
recurrent_scan__softmax_full_mha__moe_arch_mod__prompt_kernel_rfet:
    s_waitcnt vmcnt(0)
    v_cmp_gt_u32 vcc, 128, v253
    s_and_b32 vcc_lo, vcc_lo, 1
    s_cbranch_scc1 recurrent_scan__softmax_full_mha__moe_arch_mod__prompt_kernel_yp_1_spin
recurrent_scan__softmax_full_mha__moe_arch_mod__prompt_kernel_yp_1_ok:
    buffer_load_dwordx4 v[212:215], v240, s[12:15], 0 offen offset:0 sc1
    buffer_load_dwordx4 v[216:219], v240, s[12:15], 0 offen offset:16 sc1
    buffer_load_dwordx4 v[220:223], v241, s[12:15], 0 offen offset:0 sc1
    buffer_load_dwordx4 v[224:227], v241, s[12:15], 0 offen offset:16 sc1
    s_branch recurrent_scan__softmax_full_mha__moe_arch_mod__prompt_kernel_rfet_done
recurrent_scan__softmax_full_mha__moe_arch_mod__prompt_kernel_slow0_:
    s_mov_b64 s[74:75], -1
    s_branch recurrent_scan__softmax_full_mha__moe_arch_mod__prompt_kernel_slow
recurrent_scan__softmax_full_mha__moe_arch_mod__prompt_kernel_slow:
    s_waitcnt vmcnt(0)
    s_cmp_eq_u32 s48, 0
    s_cbranch_scc1 recurrent_scan__softmax_full_mha__moe_arch_mod__prompt_kernel_slow0
    v_mov_b32 v4, v12
    v_mov_b32 v5, v13
    v_mov_b32 v6, v14
    v_mov_b32 v7, v15
    v_mov_b32 v8, v16
    v_mov_b32 v9, v17
    v_mov_b32 v10, v18
    v_mov_b32 v11, v19
recurrent_scan__softmax_full_mha__moe_arch_mod__prompt_kernel_slow0:
    v_mov_b32 v124, 0xff800000
    s_mov_b32 s64, 0
recurrent_scan__softmax_full_mha__moe_arch_mod__prompt_kernel_slow1:
    s_lshl_b32 s65, s64, 12
    s_add_u32 s65, s65, s49
    buffer_load_dwordx4 v[20:23], v1, s[12:15], s65 offen
    buffer_load_dwordx4 v[24:27], v1, s[12:15], s65 offen offset:1024
    s_waitcnt vmcnt(0)
    v_mfma_f32_32x32x16_bf16 v[92:107], v[20:23], v[4:7], 0
    v_mfma_f32_32x32x16_bf16 v[92:107], v[24:27], v[8:11], v[92:107]
    s_nop 15
    v_max3_f32 v124, v124, v92, v93
    v_max3_f32 v124, v124, v94, v95
    v_max3_f32 v124, v124, v96, v97
    v_max3_f32 v124, v124, v98, v99
    v_max3_f32 v124, v124, v100, v101
    v_max3_f32 v124, v124, v102, v103
    v_max3_f32 v124, v124, v104, v105
    v_max3_f32 v124, v124, v106, v107
    s_add_u32 s64, s64, 1
    s_cmp_lt_u32 s64, 64
    s_cbranch_scc1 recurrent_scan__softmax_full_mha__moe_arch_mod__prompt_kernel_slow1
    v_mov_b32 v125, v124
    s_nop 1
    v_permlane32_swap_b32 v124, v125
    s_nop 1
    v_max_f32 v124, v124, v125
    v_sub_f32 v108, 0, v124
    v_mov_b32 v60, 0
    v_sub_f32 v109, 0, v124
    v_mov_b32 v61, 0
    v_sub_f32 v110, 0, v124
    v_mov_b32 v62, 0
    v_sub_f32 v111, 0, v124
    v_mov_b32 v63, 0
    v_sub_f32 v112, 0, v124
    v_mov_b32 v64, 0
    v_sub_f32 v113, 0, v124
    v_mov_b32 v65, 0
    v_sub_f32 v114, 0, v124
    v_mov_b32 v66, 0
    v_sub_f32 v115, 0, v124
    v_mov_b32 v67, 0
    v_sub_f32 v116, 0, v124
    v_mov_b32 v68, 0
    v_sub_f32 v117, 0, v124
    v_mov_b32 v69, 0
    v_sub_f32 v118, 0, v124
    v_mov_b32 v70, 0
    v_sub_f32 v119, 0, v124
    v_mov_b32 v71, 0
    v_sub_f32 v120, 0, v124
    v_mov_b32 v72, 0
    v_sub_f32 v121, 0, v124
    v_mov_b32 v73, 0
    v_sub_f32 v122, 0, v124
    v_mov_b32 v74, 0
    v_sub_f32 v123, 0, v124
    v_mov_b32 v75, 0
    v_mov_b32 v52, 0
    v_mov_b32 v53, 0
    v_mov_b32 v54, 0
    v_mov_b32 v55, 0
    s_mov_b32 s64, 0
recurrent_scan__softmax_full_mha__moe_arch_mod__prompt_kernel_slow2:
    s_lshl_b32 s65, s64, 12
    s_add_u32 s65, s65, s49
    buffer_load_dwordx4 v[20:23], v1, s[12:15], s65 offen offset:0
    buffer_load_dwordx4 v[24:27], v1, s[12:15], s65 offen offset:1024
    buffer_load_dwordx4 v[28:31], v1, s[12:15], s65 offen offset:2048
    buffer_load_dwordx4 v[32:35], v1, s[12:15], s65 offen offset:3072
    s_waitcnt vmcnt(0)
    v_mfma_f32_32x32x16_bf16 v[92:107], v[20:23], v[4:7], v[108:123]
    v_mfma_f32_32x32x16_bf16 v[92:107], v[24:27], v[8:11], v[92:107]
    s_nop 15
    v_exp_f32 v92, v92
    v_exp_f32 v93, v93
    v_exp_f32 v94, v94
    v_exp_f32 v95, v95
    v_exp_f32 v96, v96
    v_exp_f32 v97, v97
    v_exp_f32 v98, v98
    v_exp_f32 v99, v99
    v_exp_f32 v100, v100
    v_exp_f32 v101, v101
    v_exp_f32 v102, v102
    v_exp_f32 v103, v103
    v_exp_f32 v104, v104
    v_exp_f32 v105, v105
    v_exp_f32 v106, v106
    v_exp_f32 v107, v107
    s_nop 0
    v_cvt_pk_bf16_f32 v36, v92, v93
    v_cvt_pk_bf16_f32 v37, v94, v95
    v_cvt_pk_bf16_f32 v38, v96, v97
    v_cvt_pk_bf16_f32 v39, v98, v99
    v_cvt_pk_bf16_f32 v40, v100, v101
    v_cvt_pk_bf16_f32 v41, v102, v103
    v_cvt_pk_bf16_f32 v42, v104, v105
    v_cvt_pk_bf16_f32 v43, v106, v107
    s_nop 1
    v_mfma_f32_32x32x16_bf16 v[60:75], v[28:31], v[36:39], v[60:75]
    v_mfma_f32_32x32x16_bf16 v[60:75], v[32:35], v[40:43], v[60:75]
    v_smfmac_f32_16x16x64_bf16 v[52:55], v[44:47], v[36:43], v48
    s_add_u32 s64, s64, 1
    s_cmp_lt_u32 s64, 64
    s_cbranch_scc1 recurrent_scan__softmax_full_mha__moe_arch_mod__prompt_kernel_slow2
    s_nop 15
    v_add_f32 v52, v52, v53
    s_branch recurrent_scan__softmax_full_mha__moe_arch_mod__prompt_kernel_fin
recurrent_scan__softmax_full_mha__moe_arch_mod__prompt_kernel_ospin:
    s_mov_b32 s75, 0
recurrent_scan__softmax_full_mha__moe_arch_mod__prompt_kernel_oagain:
    v_mov_b32 v236, 0
    s_mov_b64 exec, 1
    buffer_atomic_or v236, v237, s[12:15], 0 offen sc0 sc1
    s_mov_b64 exec, -1
    s_add_u32 s75, s75, 1
    s_cmp_gt_u32 s75, 400000
    s_cselect_b32 s72, s73, s72
    s_cbranch_scc1 recurrent_scan__softmax_full_mha__moe_arch_mod__prompt_kernel_oout
    s_waitcnt vmcnt(0)
    v_readfirstlane_b32 s52, v236
    s_lshl_b32 s74, s60, 2
    s_mul_i32 s52, s52, 0x10001
    s_lshr_b32 s52, s52, s74
    s_lshr_b32 s74, s52, 1
    s_and_b32 s72, s52, s74
    s_lshr_b32 s74, s72, 2
    s_and_b32 s72, s72, s74
    s_and_b32 s72, s72, s73
    s_cbranch_scc0 recurrent_scan__softmax_full_mha__moe_arch_mod__prompt_kernel_oagain
recurrent_scan__softmax_full_mha__moe_arch_mod__prompt_kernel_oout:
    s_setpc_b64 s[44:45]
recurrent_scan__softmax_full_mha__moe_arch_mod__prompt_kernel_routed:
    v_cvt_pk_bf16_f32 v247, v212, v213
    v_lshlrev_b32 v212, 16, v247
    v_and_b32 v213, 0xffff0000, v247
    v_mul_f32 v212, v212, v238
    v_mul_f32 v213, v213, v238
    v_cvt_pk_bf16_f32 v247, v212, v213
    v_lshlrev_b32 v248, 16, v196
    v_and_b32 v249, 0xffff0000, v196
    v_sub_f32 v248, v248, v206
    v_sub_f32 v249, v249, v206
    v_cvt_pk_bf16_f32 v246, v248, v249
    v_lshlrev_b32 v248, 16, v246
    v_and_b32 v249, 0xffff0000, v246
    v_mul_f32 v248, v248, v207
    v_mul_f32 v249, v249, v207
    v_cvt_pk_bf16_f32 v246, v248, v249
    v_lshlrev_b32 v248, 16, v246
    v_and_b32 v249, 0xffff0000, v246
    v_lshlrev_b32 v212, 16, v247
    v_and_b32 v213, 0xffff0000, v247
    v_add_f32 v212, v212, v248
    v_add_f32 v213, v213, v249
    v_cvt_pk_bf16_f32 v247, v212, v213
    v_lshlrev_b32 v212, 16, v247
    v_and_b32 v213, 0xffff0000, v247
    v_cvt_pk_bf16_f32 v247, v214, v215
    v_lshlrev_b32 v214, 16, v247
    v_and_b32 v215, 0xffff0000, v247
    v_mul_f32 v214, v214, v238
    v_mul_f32 v215, v215, v238
    v_cvt_pk_bf16_f32 v247, v214, v215
    v_lshlrev_b32 v248, 16, v197
    v_and_b32 v249, 0xffff0000, v197
    v_sub_f32 v248, v248, v206
    v_sub_f32 v249, v249, v206
    v_cvt_pk_bf16_f32 v246, v248, v249
    v_lshlrev_b32 v248, 16, v246
    v_and_b32 v249, 0xffff0000, v246
    v_mul_f32 v248, v248, v207
    v_mul_f32 v249, v249, v207
    v_cvt_pk_bf16_f32 v246, v248, v249
    v_lshlrev_b32 v248, 16, v246
    v_and_b32 v249, 0xffff0000, v246
    v_lshlrev_b32 v214, 16, v247
    v_and_b32 v215, 0xffff0000, v247
    v_add_f32 v214, v214, v248
    v_add_f32 v215, v215, v249
    v_cvt_pk_bf16_f32 v247, v214, v215
    v_lshlrev_b32 v214, 16, v247
    v_and_b32 v215, 0xffff0000, v247
    v_cvt_pk_bf16_f32 v247, v216, v217
    v_lshlrev_b32 v216, 16, v247
    v_and_b32 v217, 0xffff0000, v247
    v_mul_f32 v216, v216, v238
    v_mul_f32 v217, v217, v238
    v_cvt_pk_bf16_f32 v247, v216, v217
    v_lshlrev_b32 v248, 16, v198
    v_and_b32 v249, 0xffff0000, v198
    v_sub_f32 v248, v248, v206
    v_sub_f32 v249, v249, v206
    v_cvt_pk_bf16_f32 v246, v248, v249
    v_lshlrev_b32 v248, 16, v246
    v_and_b32 v249, 0xffff0000, v246
    v_mul_f32 v248, v248, v207
    v_mul_f32 v249, v249, v207
    v_cvt_pk_bf16_f32 v246, v248, v249
    v_lshlrev_b32 v248, 16, v246
    v_and_b32 v249, 0xffff0000, v246
    v_lshlrev_b32 v216, 16, v247
    v_and_b32 v217, 0xffff0000, v247
    v_add_f32 v216, v216, v248
    v_add_f32 v217, v217, v249
    v_cvt_pk_bf16_f32 v247, v216, v217
    v_lshlrev_b32 v216, 16, v247
    v_and_b32 v217, 0xffff0000, v247
    v_cvt_pk_bf16_f32 v247, v218, v219
    v_lshlrev_b32 v218, 16, v247
    v_and_b32 v219, 0xffff0000, v247
    v_mul_f32 v218, v218, v238
    v_mul_f32 v219, v219, v238
    v_cvt_pk_bf16_f32 v247, v218, v219
    v_lshlrev_b32 v248, 16, v199
    v_and_b32 v249, 0xffff0000, v199
    v_sub_f32 v248, v248, v206
    v_sub_f32 v249, v249, v206
    v_cvt_pk_bf16_f32 v246, v248, v249
    v_lshlrev_b32 v248, 16, v246
    v_and_b32 v249, 0xffff0000, v246
    v_mul_f32 v248, v248, v207
    v_mul_f32 v249, v249, v207
    v_cvt_pk_bf16_f32 v246, v248, v249
    v_lshlrev_b32 v248, 16, v246
    v_and_b32 v249, 0xffff0000, v246
    v_lshlrev_b32 v218, 16, v247
    v_and_b32 v219, 0xffff0000, v247
    v_add_f32 v218, v218, v248
    v_add_f32 v219, v219, v249
    v_cvt_pk_bf16_f32 v247, v218, v219
    v_lshlrev_b32 v218, 16, v247
    v_and_b32 v219, 0xffff0000, v247
    v_cvt_pk_bf16_f32 v247, v220, v221
    v_lshlrev_b32 v220, 16, v247
    v_and_b32 v221, 0xffff0000, v247
    v_mul_f32 v220, v220, v239
    v_mul_f32 v221, v221, v239
    v_cvt_pk_bf16_f32 v247, v220, v221
    v_lshlrev_b32 v248, 16, v200
    v_and_b32 v249, 0xffff0000, v200
    v_sub_f32 v248, v248, v208
    v_sub_f32 v249, v249, v208
    v_cvt_pk_bf16_f32 v246, v248, v249
    v_lshlrev_b32 v248, 16, v246
    v_and_b32 v249, 0xffff0000, v246
    v_mul_f32 v248, v248, v209
    v_mul_f32 v249, v249, v209
    v_cvt_pk_bf16_f32 v246, v248, v249
    v_lshlrev_b32 v248, 16, v246
    v_and_b32 v249, 0xffff0000, v246
    v_lshlrev_b32 v220, 16, v247
    v_and_b32 v221, 0xffff0000, v247
    v_add_f32 v220, v220, v248
    v_add_f32 v221, v221, v249
    v_cvt_pk_bf16_f32 v247, v220, v221
    v_lshlrev_b32 v220, 16, v247
    v_and_b32 v221, 0xffff0000, v247
    v_cvt_pk_bf16_f32 v247, v222, v223
    v_lshlrev_b32 v222, 16, v247
    v_and_b32 v223, 0xffff0000, v247
    v_mul_f32 v222, v222, v239
    v_mul_f32 v223, v223, v239
    v_cvt_pk_bf16_f32 v247, v222, v223
    v_lshlrev_b32 v248, 16, v201
    v_and_b32 v249, 0xffff0000, v201
    v_sub_f32 v248, v248, v208
    v_sub_f32 v249, v249, v208
    v_cvt_pk_bf16_f32 v246, v248, v249
    v_lshlrev_b32 v248, 16, v246
    v_and_b32 v249, 0xffff0000, v246
    v_mul_f32 v248, v248, v209
    v_mul_f32 v249, v249, v209
    v_cvt_pk_bf16_f32 v246, v248, v249
    v_lshlrev_b32 v248, 16, v246
    v_and_b32 v249, 0xffff0000, v246
    v_lshlrev_b32 v222, 16, v247
    v_and_b32 v223, 0xffff0000, v247
    v_add_f32 v222, v222, v248
    v_add_f32 v223, v223, v249
    v_cvt_pk_bf16_f32 v247, v222, v223
    v_lshlrev_b32 v222, 16, v247
    v_and_b32 v223, 0xffff0000, v247
    v_cvt_pk_bf16_f32 v247, v224, v225
    v_lshlrev_b32 v224, 16, v247
    v_and_b32 v225, 0xffff0000, v247
    v_mul_f32 v224, v224, v239
    v_mul_f32 v225, v225, v239
    v_cvt_pk_bf16_f32 v247, v224, v225
    v_lshlrev_b32 v248, 16, v202
    v_and_b32 v249, 0xffff0000, v202
    v_sub_f32 v248, v248, v208
    v_sub_f32 v249, v249, v208
    v_cvt_pk_bf16_f32 v246, v248, v249
    v_lshlrev_b32 v248, 16, v246
    v_and_b32 v249, 0xffff0000, v246
    v_mul_f32 v248, v248, v209
    v_mul_f32 v249, v249, v209
    v_cvt_pk_bf16_f32 v246, v248, v249
    v_lshlrev_b32 v248, 16, v246
    v_and_b32 v249, 0xffff0000, v246
    v_lshlrev_b32 v224, 16, v247
    v_and_b32 v225, 0xffff0000, v247
    v_add_f32 v224, v224, v248
    v_add_f32 v225, v225, v249
    v_cvt_pk_bf16_f32 v247, v224, v225
    v_lshlrev_b32 v224, 16, v247
    v_and_b32 v225, 0xffff0000, v247
    v_cvt_pk_bf16_f32 v247, v226, v227
    v_lshlrev_b32 v226, 16, v247
    v_and_b32 v227, 0xffff0000, v247
    v_mul_f32 v226, v226, v239
    v_mul_f32 v227, v227, v239
    v_cvt_pk_bf16_f32 v247, v226, v227
    v_lshlrev_b32 v248, 16, v203
    v_and_b32 v249, 0xffff0000, v203
    v_sub_f32 v248, v248, v208
    v_sub_f32 v249, v249, v208
    v_cvt_pk_bf16_f32 v246, v248, v249
    v_lshlrev_b32 v248, 16, v246
    v_and_b32 v249, 0xffff0000, v246
    v_mul_f32 v248, v248, v209
    v_mul_f32 v249, v249, v209
    v_cvt_pk_bf16_f32 v246, v248, v249
    v_lshlrev_b32 v248, 16, v246
    v_and_b32 v249, 0xffff0000, v246
    v_lshlrev_b32 v226, 16, v247
    v_and_b32 v227, 0xffff0000, v247
    v_add_f32 v226, v226, v248
    v_add_f32 v227, v227, v249
    v_cvt_pk_bf16_f32 v247, v226, v227
    v_lshlrev_b32 v226, 16, v247
    v_and_b32 v227, 0xffff0000, v247
    s_branch recurrent_scan__softmax_full_mha__moe_arch_mod__prompt_kernel_routed_done
recurrent_scan__softmax_full_mha__moe_arch_mod__prompt_kernel_end:
    s_endpgm
.section .rodata,"a"
.p2align 6
.amdhsa_kernel recurrent_scan__softmax_full_mha__moe_arch_mod__prompt_kernel
  .amdhsa_next_free_vgpr 256
  .amdhsa_next_free_sgpr 102
  .amdhsa_accum_offset 256
  .amdhsa_group_segment_fixed_size 0
  .amdhsa_kernarg_size 88
  .amdhsa_user_sgpr_count 2
  .amdhsa_user_sgpr_kernarg_segment_ptr 1
  .amdhsa_system_sgpr_workgroup_id_x 1
  .amdhsa_float_denorm_mode_32 3
.end_amdhsa_kernel
```
